```python
import torch

def _softmax(x, axis=-1):
    return torch.softmax(x, dim=axis)
def _gelu(x):
    return torch.nn.functional.gelu(x, approximate="tanh")
def _silu(x):
    return torch.nn.functional.silu(x)
def _sigmoid(x):
    return torch.sigmoid(x)
def _layernorm(x, axis=-1, eps=1e-5):
    m = x.mean(dim=axis, keepdim=True)
    v = x.var(dim=axis, keepdim=True, unbiased=False)
    return (x - m) / torch.sqrt(v + eps)
def _scatter_add(tgt, idx, src, axis=0):
    return tgt.clone().index_add_(axis, idx, src)
def _segment_sum(src, seg, n):
    out = torch.zeros((n,) + src.shape[1:], dtype=src.dtype)
    return out.index_add_(0, seg, src)
def _pad(x, pw):
    flat = tuple(v for pair in reversed(pw) for v in pair)
    return torch.nn.functional.pad(x, flat)

kernel_name = 'gated_mix__spectral_gfnet__mha_block__prompt'

def setup_inputs():

    _w = (lambda a: (lambda t: t.to(torch.bfloat16) if t.is_floating_point() else t)(torch.as_tensor(a)))
    def _A_setup():
        B, S, D = 1, 2048, 448
        Df = D // 2 + 1
        return {
            "x": _w((lambda *s: torch.randn(*s, dtype=torch.bfloat16) * 0.05)(B, S, D)),
            "w_r": _w((lambda *s: torch.randn(*s, dtype=torch.bfloat16) * 6.4)(S, Df) * 0.02),
            "w_i": _w((lambda *s: torch.randn(*s, dtype=torch.bfloat16) * 6.4)(S, Df) * 0.02),
        }
    _A_in = _A_setup()

    def _B_setup():
        B, S, D, H = 1, 2048, 448, 16
        return {
            "x": _w((lambda *s: torch.randn(*s, dtype=torch.bfloat16) * 0.05)(B, S, D)),
            "wqkv": _w((lambda *s: torch.randn(*s, dtype=torch.bfloat16) * 0.8)(D, 3 * D)),
            "wo": _w((lambda *s: torch.randn(*s, dtype=torch.bfloat16) * 0.05)(D, D)),
        }
    _B_in = _B_setup()

    return {
        "A_x": _A_in["x"],
        "A_w_r": _A_in["w_r"],
        "A_w_i": _A_in["w_i"],
        "B_x": _B_in["x"],
        "B_wqkv": _B_in["wqkv"],
        "B_wo": _B_in["wo"],
        "gate_w": _w((lambda *s: torch.randn(*s, dtype=torch.bfloat16) * 0.05)(448) * 16.0),
    }

def reference(A_x, A_w_r, A_w_i, B_x, B_wqkv, B_wo, gate_w):
    def _A_ref(x, w_r, w_i):
        B, S, D = x.shape
        X = (lambda x, axes=(-2,-1): torch.fft.rfft2(x.float(), dim=axes))(x, axes=(-2, -1))
        W = w_r + 1j * w_i
        X = X * W
        y = (lambda x, s, axes=(-2,-1): torch.fft.irfft2(x, s=s, dim=axes).to(torch.bfloat16))(X, (S, D), axes=(-2, -1))
        return y

    def _B_ref(x, wqkv, wo):
        B, S, D = x.shape
        H = 16
        Dh = D // H
        qkv = (lambda x, *d: x.permute(*d))((x @ wqkv).reshape(B, S, 3, H, Dh), 2, 0, 3, 1, 4)
        q, k, v = qkv[0], qkv[1], qkv[2]
        scores = torch.einsum("bhqd,bhkd->bhqk", q, k) * (Dh ** -0.5)
        p = _softmax(scores, axis=-1)
        o = torch.einsum("bhqk,bhkd->bhqd", p, v)
        return (lambda x, *d: x.permute(*d))(o, 0, 2, 1, 3).reshape(B, S, D) @ wo

    x = A_x
    g = _sigmoid((x * gate_w).sum(-1, keepdims=True))
    a = _A_ref(x, A_w_r, A_w_i)
    b = _B_ref(x, B_wqkv, B_wo)
    return g * a + (1 - g) * b
```

```asm
; @launch kernel=k1_kernel grid=(256,1,1) block=(512,1,1) lds=153600
; @launch kernel=k2_kernel grid=(256,1,1) block=(512,1,1) lds=57600
; @launch kernel=k3_kernel grid=(224,1,1) block=(1024,1,1) lds=131072
.amdgcn_target "amdgcn-amd-amdhsa--gfx950"
.text
  .globl k1_kernel
  .p2align 8
  .type k1_kernel,@function
k1_kernel:
  s_cmp_ge_u32 s2, 256
  s_cbranch_scc1 k1_end
  s_load_dwordx4 s[4:7], s[0:1], 0
  s_load_dwordx2 s[12:13], s[0:1], 16
  s_load_dwordx4 s[8:11], s[0:1], 32
  s_load_dwordx2 s[18:19], s[0:1], 72
  s_load_dwordx2 s[14:15], s[0:1], 48
  s_and_b32 s20, s2, 7
  s_lshr_b32 s21, s2, 3
  s_lshr_b32 s22, s20, 1
  s_and_b32 s23, s21, 3
  s_lshl_b32 s23, s23, 2
  s_add_u32 s22, s22, s23
  s_and_b32 s23, s20, 1
  s_lshl_b32 s23, s23, 3
  s_lshr_b32 s24, s21, 2
  s_add_u32 s23, s23, s24
  s_and_b32 s25, s23, 3
  s_lshr_b32 s26, s23, 3
  s_lshl_b32 s26, s26, 2
  s_or_b32 s25, s25, s26
  s_bfe_u32 s26, s23, 0x10002
  s_lshl_b32 s26, s26, 3
  s_or_b32 s25, s25, s26
  s_cmp_ge_u32 s22, 12
  s_cselect_b32 s23, s25, s23
  v_lshrrev_b32 v1, 6, v0
  v_and_b32 v2, 63, v0
  v_readfirstlane_b32 s69, v1
  v_and_b32 v3, 15, v2
  v_lshrrev_b32 v4, 4, v2
  s_mov_b32 s24, s69
  s_cmp_lt_u32 s69, 4
  s_cbranch_scc1 k1_consumer
  s_sub_u32 s24, s69, 4
  s_lshl_b32 s25, s23, 7
  s_lshr_b32 s26, s23, 2
  s_and_b32 s26, s26, 1
  s_lshl_b32 s26, s26, 10
  s_and_b32 s27, s23, 3
  s_lshl_b32 s27, s27, 8
  s_add_u32 s26, s26, s27
  s_lshr_b32 s27, s23, 3
  s_lshl_b32 s27, s27, 4
  s_add_u32 s26, s26, s27
  s_cmp_ge_u32 s22, 12
  s_cselect_b32 s25, s26, s25
  s_mov_b32 s26, 7168
  s_cmov_b32 s26, 896
  s_mov_b32 s27, 896
  s_cmov_b32 s27, 28672
  s_mov_b32 s34, 1204224
  s_cmov_b32 s34, 401408
  s_mov_b32 s36, 2688
  s_cmov_b32 s36, 896
  s_cselect_b32 s37, 12, 0
  s_mul_i32 s25, s25, 896
  s_mul_i32 s28, s24, s26
  s_add_u32 s25, s25, s28
  s_lshl_b32 s26, s26, 2
  v_lshrrev_b32 v5, 3, v2
  v_mul_lo_u32 v5, v5, s27
  s_and_b32 s28, s24, 1
  s_lshl_b32 s28, s28, 2
  v_add_u32 v6, s28, v4
  v_and_b32 v7, 7, v2
  v_xor_b32 v6, v6, v7
  v_lshl_add_u32 v5, v6, 4, v5
  s_mov_b32 s35, 0x00020000
  s_sub_u32 s37, s22, s37
  s_mul_i32 s37, s37, 224
  s_mov_b32 s58, 1835008
  s_mov_b32 s59, 0x00020000
  v_mul_u32_u24 v7, 147, v2
  v_lshrrev_b32 v7, 11, v7
  v_mul_u32_u24 v8, 14, v7
  v_sub_u32 v8, v2, v8
  v_mul_lo_u32 v7, v7, s36
  v_lshl_add_u32 v7, v8, 4, v7
  s_lshr_b32 s38, s24, 1
  s_and_b32 s38, s38, 1
  s_xor_b32 s38, s38, s24
  s_mul_i32 s38, s38, s36
  s_lshl_b32 s38, s38, 2
  s_add_u32 s38, s38, s37
  s_lshl_b32 s39, s36, 4
  s_mul_i32 s40, s24, 896
  s_add_u32 s40, s40, 81920
  s_lshl_b32 s41, s24, 10
  s_getpc_b64 s[28:29]
  s_add_u32 s28, s28, tab_F@rel32@lo+4
  s_addc_u32 s29, s29, tab_F@rel32@hi+12
  s_waitcnt lgkmcnt(0)
  s_cmp_ge_u32 s22, 12
  s_cselect_b32 s32, s28, s8
  s_cselect_b32 s33, s29, s9
  s_mov_b32 s56, s4
  s_mov_b32 s57, s5
  s_add_u32 m0, s41, 0
  s_add_u32 s42, s25, 0
  buffer_load_dwordx4 v5, s[56:59], s42 offen lds
  s_add_u32 m0, s41, 4096
  s_add_u32 s42, s42, s26
  buffer_load_dwordx4 v5, s[56:59], s42 offen lds
  s_add_u32 m0, s41, 8192
  s_add_u32 s42, s42, s26
  buffer_load_dwordx4 v5, s[56:59], s42 offen lds
  s_add_u32 m0, s41, 12288
  s_add_u32 s42, s42, s26
  buffer_load_dwordx4 v5, s[56:59], s42 offen lds
  s_mov_b32 exec_hi, 0x00ffffff
  s_add_u32 m0, s40, 0
  s_nop 0
  buffer_load_dwordx4 v7, s[32:35], s38 offen lds
  s_add_u32 s38, s38, s39
  s_add_u32 m0, s40, 3584
  s_nop 0
  buffer_load_dwordx4 v7, s[32:35], s38 offen lds
  s_add_u32 s38, s38, s39
  s_add_u32 m0, s40, 7168
  s_nop 0
  buffer_load_dwordx4 v7, s[32:35], s38 offen lds
  s_add_u32 s38, s38, s39
  s_add_u32 m0, s40, 10752
  s_nop 0
  buffer_load_dwordx4 v7, s[32:35], s38 offen lds
  s_add_u32 s38, s38, s39
  s_mov_b32 exec_hi, -1
  s_add_u32 m0, s41, 16384
  s_add_u32 s42, s25, 128
  buffer_load_dwordx4 v5, s[56:59], s42 offen lds
  s_add_u32 m0, s41, 20480
  s_add_u32 s42, s42, s26
  buffer_load_dwordx4 v5, s[56:59], s42 offen lds
  s_add_u32 m0, s41, 24576
  s_add_u32 s42, s42, s26
  buffer_load_dwordx4 v5, s[56:59], s42 offen lds
  s_add_u32 m0, s41, 28672
  s_add_u32 s42, s42, s26
  buffer_load_dwordx4 v5, s[56:59], s42 offen lds
  s_mov_b32 exec_hi, 0x00ffffff
  s_add_u32 m0, s40, 14336
  s_nop 0
  buffer_load_dwordx4 v7, s[32:35], s38 offen lds
  s_add_u32 s38, s38, s39
  s_add_u32 m0, s40, 17920
  s_nop 0
  buffer_load_dwordx4 v7, s[32:35], s38 offen lds
  s_add_u32 s38, s38, s39
  s_add_u32 m0, s40, 21504
  s_nop 0
  buffer_load_dwordx4 v7, s[32:35], s38 offen lds
  s_add_u32 s38, s38, s39
  s_add_u32 m0, s40, 25088
  s_nop 0
  buffer_load_dwordx4 v7, s[32:35], s38 offen lds
  s_add_u32 s38, s38, s39
  s_mov_b32 exec_hi, -1
  s_add_u32 m0, s41, 32768
  s_add_u32 s42, s25, 256
  buffer_load_dwordx4 v5, s[56:59], s42 offen lds
  s_add_u32 m0, s41, 36864
  s_add_u32 s42, s42, s26
  buffer_load_dwordx4 v5, s[56:59], s42 offen lds
  s_add_u32 m0, s41, 40960
  s_add_u32 s42, s42, s26
  buffer_load_dwordx4 v5, s[56:59], s42 offen lds
  s_add_u32 m0, s41, 45056
  s_add_u32 s42, s42, s26
  buffer_load_dwordx4 v5, s[56:59], s42 offen lds
  s_mov_b32 exec_hi, 0x00ffffff
  s_add_u32 m0, s40, 28672
  s_nop 0
  buffer_load_dwordx4 v7, s[32:35], s38 offen lds
  s_add_u32 s38, s38, s39
  s_add_u32 m0, s40, 32256
  s_nop 0
  buffer_load_dwordx4 v7, s[32:35], s38 offen lds
  s_add_u32 s38, s38, s39
  s_add_u32 m0, s40, 35840
  s_nop 0
  buffer_load_dwordx4 v7, s[32:35], s38 offen lds
  s_add_u32 s38, s38, s39
  s_add_u32 m0, s40, 39424
  s_nop 0
  buffer_load_dwordx4 v7, s[32:35], s38 offen lds
  s_add_u32 s38, s38, s39
  s_mov_b32 exec_hi, -1
  v_lshlrev_b32 v18, 3, v3
  global_load_dwordx2 v[48:49], v18, s[14:15] offset:0
  global_load_dwordx2 v[50:51], v18, s[14:15] offset:128
  global_load_dwordx2 v[52:53], v18, s[14:15] offset:256
  global_load_dwordx2 v[54:55], v18, s[14:15] offset:384
  global_load_dwordx2 v[56:57], v18, s[14:15] offset:512
  global_load_dwordx2 v[58:59], v18, s[14:15] offset:640
  global_load_dwordx2 v[60:61], v18, s[14:15] offset:768
  s_and_b32 s62, s22, 7
  s_lshl_b32 s62, s62, 4
  s_and_b32 s63, s24, 3
  s_lshl_b32 s63, s63, 2
  s_add_u32 s62, s62, s63
  v_add_u32 v19, s62, v4
  v_bfe_u32 v20, v19, 1, 3
  v_lshrrev_b32 v21, 1, v3
  v_xor_b32 v20, v20, v21
  v_lshlrev_b32 v20, 4, v20
  v_lshl_add_u32 v20, v19, 7, v20
  v_and_b32 v21, 1, v3
  v_lshl_add_u32 v20, v21, 3, v20
  v_add_u32 v21, 49152, v20
  v_mov_b32 v22, 0
  s_waitcnt vmcnt(23)
  s_barrier
  ds_read_b64 v[24:25], v20 offset:0
  s_add_u32 m0, s41, 49152
  s_add_u32 s42, s25, 384
  buffer_load_dwordx4 v5, s[56:59], s42 offen lds
  s_add_u32 m0, s41, 53248
  s_add_u32 s42, s42, s26
  buffer_load_dwordx4 v5, s[56:59], s42 offen lds
  s_add_u32 m0, s41, 57344
  s_add_u32 s42, s42, s26
  buffer_load_dwordx4 v5, s[56:59], s42 offen lds
  s_add_u32 m0, s41, 61440
  s_add_u32 s42, s42, s26
  buffer_load_dwordx4 v5, s[56:59], s42 offen lds
  s_mov_b32 exec_hi, 0x00ffffff
  s_add_u32 m0, s40, 43008
  s_nop 0
  buffer_load_dwordx4 v7, s[32:35], s38 offen lds
  s_add_u32 s38, s38, s39
  s_add_u32 m0, s40, 46592
  s_nop 0
  buffer_load_dwordx4 v7, s[32:35], s38 offen lds
  s_add_u32 s38, s38, s39
  s_add_u32 m0, s40, 50176
  s_nop 0
  buffer_load_dwordx4 v7, s[32:35], s38 offen lds
  s_add_u32 s38, s38, s39
  s_add_u32 m0, s40, 53760
  s_nop 0
  buffer_load_dwordx4 v7, s[32:35], s38 offen lds
  s_add_u32 s38, s38, s39
  s_mov_b32 exec_hi, -1
  s_waitcnt vmcnt(8)
  s_waitcnt lgkmcnt(0)
  v_dot2_f32_bf16 v22, v24, v48, v22
  v_dot2_f32_bf16 v22, v25, v49, v22
  s_barrier
  ds_read_b64 v[24:25], v20 offset:16384
  s_add_u32 m0, s41, 65536
  s_add_u32 s42, s25, 512
  buffer_load_dwordx4 v5, s[56:59], s42 offen lds
  s_add_u32 m0, s41, 69632
  s_add_u32 s42, s42, s26
  buffer_load_dwordx4 v5, s[56:59], s42 offen lds
  s_add_u32 m0, s41, 73728
  s_add_u32 s42, s42, s26
  buffer_load_dwordx4 v5, s[56:59], s42 offen lds
  s_add_u32 m0, s41, 77824
  s_add_u32 s42, s42, s26
  buffer_load_dwordx4 v5, s[56:59], s42 offen lds
  s_mov_b32 exec_hi, 0x00ffffff
  s_add_u32 m0, s40, 57344
  s_nop 0
  buffer_load_dwordx4 v7, s[32:35], s38 offen lds
  s_add_u32 s38, s38, s39
  s_add_u32 m0, s40, 60928
  s_nop 0
  buffer_load_dwordx4 v7, s[32:35], s38 offen lds
  s_add_u32 s38, s38, s39
  s_add_u32 m0, s40, 64512
  s_nop 0
  buffer_load_dwordx4 v7, s[32:35], s38 offen lds
  s_add_u32 s38, s38, s39
  s_add_u32 m0, s40, 68096
  s_nop 0
  buffer_load_dwordx4 v7, s[32:35], s38 offen lds
  s_add_u32 s38, s38, s39
  s_mov_b32 exec_hi, -1
  s_waitcnt lgkmcnt(0)
  v_dot2_f32_bf16 v22, v24, v50, v22
  v_dot2_f32_bf16 v22, v25, v51, v22
  s_barrier
  ds_read_b64 v[24:25], v20 offset:32768
  s_add_u32 m0, s41, 0
  s_add_u32 s42, s25, 640
  buffer_load_dwordx4 v5, s[56:59], s42 offen lds
  s_add_u32 m0, s41, 4096
  s_add_u32 s42, s42, s26
  buffer_load_dwordx4 v5, s[56:59], s42 offen lds
  s_add_u32 m0, s41, 8192
  s_add_u32 s42, s42, s26
  buffer_load_dwordx4 v5, s[56:59], s42 offen lds
  s_add_u32 m0, s41, 12288
  s_add_u32 s42, s42, s26
  buffer_load_dwordx4 v5, s[56:59], s42 offen lds
  s_mov_b32 exec_hi, 0x00ffffff
  s_add_u32 m0, s40, 0
  s_nop 0
  buffer_load_dwordx4 v7, s[32:35], s38 offen lds
  s_add_u32 s38, s38, s39
  s_add_u32 m0, s40, 3584
  s_nop 0
  buffer_load_dwordx4 v7, s[32:35], s38 offen lds
  s_add_u32 s38, s38, s39
  s_add_u32 m0, s40, 7168
  s_nop 0
  buffer_load_dwordx4 v7, s[32:35], s38 offen lds
  s_add_u32 s38, s38, s39
  s_add_u32 m0, s40, 10752
  s_nop 0
  buffer_load_dwordx4 v7, s[32:35], s38 offen lds
  s_add_u32 s38, s38, s39
  s_mov_b32 exec_hi, -1
  s_waitcnt lgkmcnt(0)
  v_dot2_f32_bf16 v22, v24, v52, v22
  v_dot2_f32_bf16 v22, v25, v53, v22
  s_waitcnt vmcnt(16)
  s_barrier
  ds_read_b64 v[24:25], v21 offset:0
  s_add_u32 m0, s41, 16384
  s_add_u32 s42, s25, 768
  buffer_load_dwordx4 v5, s[56:59], s42 offen lds
  s_add_u32 m0, s41, 20480
  s_add_u32 s42, s42, s26
  buffer_load_dwordx4 v5, s[56:59], s42 offen lds
  s_add_u32 m0, s41, 24576
  s_add_u32 s42, s42, s26
  buffer_load_dwordx4 v5, s[56:59], s42 offen lds
  s_add_u32 m0, s41, 28672
  s_add_u32 s42, s42, s26
  buffer_load_dwordx4 v5, s[56:59], s42 offen lds
  s_mov_b32 exec_hi, 0x00ffffff
  s_add_u32 m0, s40, 14336
  s_nop 0
  buffer_load_dwordx4 v7, s[32:35], s38 offen lds
  s_add_u32 s38, s38, s39
  s_add_u32 m0, s40, 17920
  s_nop 0
  buffer_load_dwordx4 v7, s[32:35], s38 offen lds
  s_add_u32 s38, s38, s39
  s_add_u32 m0, s40, 21504
  s_nop 0
  buffer_load_dwordx4 v7, s[32:35], s38 offen lds
  s_add_u32 s38, s38, s39
  s_add_u32 m0, s40, 25088
  s_nop 0
  buffer_load_dwordx4 v7, s[32:35], s38 offen lds
  s_add_u32 s38, s38, s39
  s_mov_b32 exec_hi, -1
  s_waitcnt lgkmcnt(0)
  v_dot2_f32_bf16 v22, v24, v54, v22
  v_dot2_f32_bf16 v22, v25, v55, v22
  s_waitcnt vmcnt(16)
  s_barrier
  ds_read_b64 v[24:25], v21 offset:16384
  s_waitcnt lgkmcnt(0)
  v_dot2_f32_bf16 v22, v24, v56, v22
  v_dot2_f32_bf16 v22, v25, v57, v22
  s_waitcnt vmcnt(8)
  s_barrier
  ds_read_b64 v[24:25], v20 offset:0
  s_waitcnt lgkmcnt(0)
  v_dot2_f32_bf16 v22, v24, v58, v22
  v_dot2_f32_bf16 v22, v25, v59, v22
  s_waitcnt vmcnt(0)
  s_barrier
  ds_read_b64 v[24:25], v20 offset:16384
  s_waitcnt lgkmcnt(0)
  v_dot2_f32_bf16 v22, v24, v60, v22
  v_dot2_f32_bf16 v22, v25, v61, v22
  s_barrier
  s_cmp_ge_u32 s22, 8
  s_cbranch_scc1 k1_prod_end
  s_cmp_ge_u32 s24, 4
  s_cbranch_scc1 k1_prod_end
  s_nop 1
  v_add_f32_dpp v22, v22, v22 row_ror:1 row_mask:0xf bank_mask:0xf
  s_nop 1
  v_add_f32_dpp v22, v22, v22 row_ror:2 row_mask:0xf bank_mask:0xf
  s_nop 1
  v_add_f32_dpp v22, v22, v22 row_ror:4 row_mask:0xf bank_mask:0xf
  s_nop 1
  v_add_f32_dpp v22, v22, v22 row_ror:8 row_mask:0xf bank_mask:0xf
  s_nop 1
  s_mov_b32 s27, 0xbfb8aa3b
  v_mul_f32 v22, s27, v22
  v_exp_f32 v22, v22
  s_lshl_b32 s26, s23, 9
  s_add_u32 s26, s26, 11010048
  v_add_f32 v22, 1.0, v22
  v_rcp_f32 v22, v22
  s_add_u32 s32, s18, s26
  s_addc_u32 s33, s19, 0
  v_lshlrev_b32 v19, 2, v19
  global_store_dword v19, v22, s[32:33]
k1_prod_end:
  s_lshl_b32 s26, s21, 2
  s_add_u32 s26, s26, s24
  s_lshl_b32 s26, s26, 10
  v_lshlrev_b32 v8, 4, v2
  s_getpc_b64 s[52:53]
  s_add_u32 s52, s52, tab_B64@rel32@lo+4
  s_addc_u32 s53, s53, tab_B64@rel32@hi+12
  s_mov_b32 s54, tab_end-tab_B64
  s_mov_b32 s55, 0x00020000
  buffer_load_dwordx4 v[24:27], v8, s[52:55], s26 offen
  s_getpc_b64 s[56:57]
  s_add_u32 s56, s56, k2_kernel@rel32@lo+4
  s_addc_u32 s57, s57, k2_kernel@rel32@hi+12
  s_mov_b32 s58, k3_kernel-k2_kernel
  s_mov_b32 s59, 0x00020000
  buffer_load_dwordx4 v[28:31], v8, s[56:59], s26 offen
  s_endpgm
k1_consumer:
  s_waitcnt lgkmcnt(0)
  s_lshl_b32 s44, s2, 2
  s_add_u32 s44, s44, s24
  s_and_b32 s45, s44, 7
  s_lshr_b32 s46, s44, 3
  s_and_b32 s46, s46, 3
  s_lshr_b32 s44, s44, 5
  s_lshl_b32 s44, s44, 1
  s_lshl_b32 s46, s46, 6
  v_add_u32 v16, s46, v2
  v_lshlrev_b32 v17, 13, v16
  v_cmp_gt_u32 vcc, 0xe1, v16
  s_mov_b64 s[64:65], vcc
  v_lshlrev_b32 v16, 1, v16
  s_lshl_b32 s46, s45, 8
  s_add_u32 s46, s46, s44
  s_mul_i32 s46, s46, 450
  s_mov_b32 s48, s6
  s_mov_b32 s49, s7
  s_mov_b32 s50, 921600
  s_mov_b32 s51, 0x00020000
  s_mov_b32 s52, s12
  s_mov_b32 s53, s13
  s_mov_b32 s54, 921600
  s_mov_b32 s55, 0x00020000
  s_lshl_b32 s45, s45, 10
  s_lshl_b32 s44, s44, 4
  s_add_u32 s45, s45, s44
  s_add_u32 s45, s45, 8388608
  s_add_u32 s60, s18, s45
  s_addc_u32 s61, s19, 0
  s_mov_b64 exec, s[64:65]
  s_add_u32 s47, s46, 0
  buffer_load_ushort v104, v16, s[48:51], s47 offen
  buffer_load_ushort v112, v16, s[52:55], s47 offen
  s_add_u32 s47, s46, 28800
  buffer_load_ushort v105, v16, s[48:51], s47 offen
  buffer_load_ushort v113, v16, s[52:55], s47 offen
  s_add_u32 s47, s46, 57600
  buffer_load_ushort v106, v16, s[48:51], s47 offen
  buffer_load_ushort v114, v16, s[52:55], s47 offen
  s_add_u32 s47, s46, 86400
  buffer_load_ushort v107, v16, s[48:51], s47 offen
  buffer_load_ushort v115, v16, s[52:55], s47 offen
  s_add_u32 s47, s46, 450
  buffer_load_ushort v108, v16, s[48:51], s47 offen
  buffer_load_ushort v116, v16, s[52:55], s47 offen
  s_add_u32 s47, s46, 29250
  buffer_load_ushort v109, v16, s[48:51], s47 offen
  buffer_load_ushort v117, v16, s[52:55], s47 offen
  s_add_u32 s47, s46, 58050
  buffer_load_ushort v110, v16, s[48:51], s47 offen
  buffer_load_ushort v118, v16, s[52:55], s47 offen
  s_add_u32 s47, s46, 86850
  buffer_load_ushort v111, v16, s[48:51], s47 offen
  buffer_load_ushort v119, v16, s[52:55], s47 offen
  s_mov_b64 exec, -1
  s_lshr_b32 s26, s21, 2
  s_mul_i32 s26, s26, 3
  s_and_b32 s27, s21, 3
  s_add_u32 s26, s26, s27
  s_lshl_b32 s26, s26, 3
  s_add_u32 s26, s26, s20
  s_lshl_b32 s26, s26, 2
  s_add_u32 s26, s26, s24
  s_cmp_ge_u32 s22, 12
  s_cmov_b32 s26, 1000
  s_cmp_ge_u32 s26, 392
  s_cbranch_scc1 k1_nowo
  v_mul_u32_u24 v6, 8*896, v4
  v_lshl_add_u32 v6, v3, 1, v6
  v_add_u32 v7, 4*896, v6
  s_mul_i32 s27, s26, 4682
  s_lshr_b32 s27, s27, 16
  s_mul_i32 s28, s27, 14
  s_sub_u32 s28, s26, s28
  s_mul_i32 s28, s28, 28672
  s_lshl_b32 s27, s27, 5
  s_add_u32 s28, s28, s27
  s_add_u32 s30, s10, s28
  s_addc_u32 s31, s11, 0
  global_load_ushort v160, v6, s[30:31] offset:0
  global_load_ushort v161, v6, s[30:31] offset:896
  global_load_ushort v162, v6, s[30:31] offset:1792
  global_load_ushort v163, v6, s[30:31] offset:2688
  global_load_ushort v164, v7, s[30:31] offset:0
  global_load_ushort v165, v7, s[30:31] offset:896
  global_load_ushort v166, v7, s[30:31] offset:1792
  global_load_ushort v167, v7, s[30:31] offset:2688
k1_nowo:
  v_and_b32 v8, 1, v4
  v_lshl_add_u32 v9, v4, 1, v8
  v_xor_b32 v8, 1, v8
  v_lshl_add_u32 v10, v4, 1, v8
  v_mul_u32_u24 v9, 896, v9
  v_mul_u32_u24 v10, 896, v10
  v_lshrrev_b32 v8, 2, v3
  v_mul_u32_u24 v8, 224, v8
  v_and_b32 v11, 3, v3
  v_lshl_add_u32 v8, v11, 3, v8
  v_add_u32 v8, 81920, v8
  v_add_u32 v20, v9, v8
  v_add_u32 v21, v10, v8
  v_lshrrev_b32 v8, 1, v3
  v_xor_b32 v8, v8, v4
  v_lshlrev_b32 v11, 7, v3
  s_lshl_b32 s43, s24, 12
  v_add_u32 v11, s43, v11
  v_lshl_add_u32 v22, v8, 4, v11
  v_xor_b32 v23, 64, v22
  v_mov_b32 v9, v20
  v_mov_b32 v10, v21
  v_mov_b32 v12, v22
  v_mov_b32 v13, v23
  v_mov_b32 v48, 0
  v_mov_b32 v49, 0
  v_mov_b32 v50, 0
  v_mov_b32 v51, 0
  v_mov_b32 v52, 0
  v_mov_b32 v53, 0
  v_mov_b32 v54, 0
  v_mov_b32 v55, 0
  v_mov_b32 v56, 0
  v_mov_b32 v57, 0
  v_mov_b32 v58, 0
  v_mov_b32 v59, 0
  v_mov_b32 v60, 0
  v_mov_b32 v61, 0
  v_mov_b32 v62, 0
  v_mov_b32 v63, 0
  v_mov_b32 v64, 0
  v_mov_b32 v65, 0
  v_mov_b32 v66, 0
  v_mov_b32 v67, 0
  v_mov_b32 v68, 0
  v_mov_b32 v69, 0
  v_mov_b32 v70, 0
  v_mov_b32 v71, 0
  v_mov_b32 v72, 0
  v_mov_b32 v73, 0
  v_mov_b32 v74, 0
  v_mov_b32 v75, 0
  v_mov_b32 v76, 0
  v_mov_b32 v77, 0
  v_mov_b32 v78, 0
  v_mov_b32 v79, 0
  v_mov_b32 v80, 0
  v_mov_b32 v81, 0
  v_mov_b32 v82, 0
  v_mov_b32 v83, 0
  v_mov_b32 v84, 0
  v_mov_b32 v85, 0
  v_mov_b32 v86, 0
  v_mov_b32 v87, 0
  v_mov_b32 v88, 0
  v_mov_b32 v89, 0
  v_mov_b32 v90, 0
  v_mov_b32 v91, 0
  v_mov_b32 v92, 0
  v_mov_b32 v93, 0
  v_mov_b32 v94, 0
  v_mov_b32 v95, 0
  v_mov_b32 v96, 0
  v_mov_b32 v97, 0
  v_mov_b32 v98, 0
  v_mov_b32 v99, 0
  v_mov_b32 v100, 0
  v_mov_b32 v101, 0
  v_mov_b32 v102, 0
  v_mov_b32 v103, 0
  s_mov_b32 s44, 0
  s_mov_b32 s45, 7
  s_mul_i32 s43, s24, 9216
  s_add_u32 s43, s43, 32768
  s_waitcnt vmcnt(0)
  v_lshl_or_b32 v104, v112, 16, v104
  v_lshl_or_b32 v105, v113, 16, v105
  v_lshl_or_b32 v106, v114, 16, v106
  v_lshl_or_b32 v107, v115, 16, v107
  v_lshl_or_b32 v108, v116, 16, v108
  v_lshl_or_b32 v109, v117, 16, v109
  v_lshl_or_b32 v110, v118, 16, v110
  v_lshl_or_b32 v111, v119, 16, v111
  s_mov_b64 exec, s[64:65]
  global_store_dwordx4 v17, v[104:107], s[60:61] offset:0
  global_store_dwordx4 v17, v[108:111], s[60:61] offset:16
  s_mov_b64 exec, -1
  s_cmp_ge_u32 s26, 392
  s_cbranch_scc1 k1_nowo2
  s_lshl_b32 s27, s26, 10
  s_add_u32 s27, s27, 10485760
  s_add_u32 s30, s18, s27
  s_addc_u32 s31, s19, 0
  v_lshlrev_b32 v6, 4, v2
  v_lshl_or_b32 v160, v161, 16, v160
  v_lshl_or_b32 v161, v163, 16, v162
  v_lshl_or_b32 v162, v165, 16, v164
  v_lshl_or_b32 v163, v167, 16, v166
  global_store_dwordx4 v6, v[160:163], s[30:31]
k1_nowo2:
  s_nop 1
  s_cmp_ge_u32 s22, 8
  s_cbranch_scc1 k1_normal
  s_barrier
  ds_read_b128 v[32:35], v12 offset:0
  ds_read_b128 v[36:39], v12 offset:2048
  ds_read_b64_tr_b16 v[104:105], v9 offset:0
  ds_read_b64_tr_b16 v[106:107], v10 offset:0
  ds_read_b64_tr_b16 v[108:109], v9 offset:32
  ds_read_b64_tr_b16 v[110:111], v10 offset:32
  ds_read_b64_tr_b16 v[112:113], v9 offset:64
  ds_read_b64_tr_b16 v[114:115], v10 offset:64
  ds_read_b64_tr_b16 v[116:117], v9 offset:96
  ds_read_b64_tr_b16 v[118:119], v10 offset:96
  ds_read_b64_tr_b16 v[120:121], v9 offset:128
  ds_read_b64_tr_b16 v[122:123], v10 offset:128
  ds_read_b64_tr_b16 v[124:125], v9 offset:160
  ds_read_b64_tr_b16 v[126:127], v10 offset:160
  ds_read_b64_tr_b16 v[128:129], v9 offset:192
  ds_read_b64_tr_b16 v[130:131], v10 offset:192
k1_loop_t:
  s_waitcnt lgkmcnt(12)
  v_mfma_f32_16x16x32_bf16 v[48:51], v[104:107], v[32:35], v[48:51]
  v_mfma_f32_16x16x32_bf16 v[76:79], v[104:107], v[36:39], v[76:79]
  ds_read_b128 v[40:43], v13 offset:0
  ds_read_b128 v[44:47], v13 offset:2048
  ds_read_b64_tr_b16 v[132:133], v9 offset:7168
  ds_read_b64_tr_b16 v[134:135], v10 offset:7168
  s_waitcnt lgkmcnt(14)
  v_mfma_f32_16x16x32_bf16 v[52:55], v[108:111], v[32:35], v[52:55]
  v_mfma_f32_16x16x32_bf16 v[80:83], v[108:111], v[36:39], v[80:83]
  ds_read_b64_tr_b16 v[136:137], v9 offset:7200
  ds_read_b64_tr_b16 v[138:139], v10 offset:7200
  s_waitcnt lgkmcnt(14)
  v_mfma_f32_16x16x32_bf16 v[56:59], v[112:115], v[32:35], v[56:59]
  v_mfma_f32_16x16x32_bf16 v[84:87], v[112:115], v[36:39], v[84:87]
  ds_read_b64_tr_b16 v[140:141], v9 offset:7232
  ds_read_b64_tr_b16 v[142:143], v10 offset:7232
  s_waitcnt lgkmcnt(14)
  v_mfma_f32_16x16x32_bf16 v[60:63], v[116:119], v[32:35], v[60:63]
  v_mfma_f32_16x16x32_bf16 v[88:91], v[116:119], v[36:39], v[88:91]
  ds_read_b64_tr_b16 v[144:145], v9 offset:7264
  ds_read_b64_tr_b16 v[146:147], v10 offset:7264
  s_waitcnt lgkmcnt(14)
  v_mfma_f32_16x16x32_bf16 v[64:67], v[120:123], v[32:35], v[64:67]
  v_mfma_f32_16x16x32_bf16 v[92:95], v[120:123], v[36:39], v[92:95]
  ds_read_b64_tr_b16 v[148:149], v9 offset:7296
  ds_read_b64_tr_b16 v[150:151], v10 offset:7296
  s_waitcnt lgkmcnt(14)
  v_mfma_f32_16x16x32_bf16 v[68:71], v[124:127], v[32:35], v[68:71]
  v_mfma_f32_16x16x32_bf16 v[96:99], v[124:127], v[36:39], v[96:99]
  ds_read_b64_tr_b16 v[152:153], v9 offset:7328
  ds_read_b64_tr_b16 v[154:155], v10 offset:7328
  s_waitcnt lgkmcnt(14)
  v_mfma_f32_16x16x32_bf16 v[72:75], v[128:131], v[32:35], v[72:75]
  v_mfma_f32_16x16x32_bf16 v[100:103], v[128:131], v[36:39], v[100:103]
  ds_read_b64_tr_b16 v[156:157], v9 offset:7360
  ds_read_b64_tr_b16 v[158:159], v10 offset:7360
  s_add_u32 s44, s44, 1
  s_cmp_eq_u32 s44, 5
  s_cmov_b32 s44, 0
  s_mul_i32 s46, s44, 16384
  s_mul_i32 s47, s44, 14336
  v_add_u32 v12, s46, v22
  v_add_u32 v13, s46, v23
  v_add_u32 v9, s47, v20
  v_add_u32 v10, s47, v21
  s_barrier
  s_waitcnt lgkmcnt(12)
  v_mfma_f32_16x16x32_bf16 v[48:51], v[132:135], v[40:43], v[48:51]
  v_mfma_f32_16x16x32_bf16 v[76:79], v[132:135], v[44:47], v[76:79]
  ds_read_b128 v[32:35], v12 offset:0
  ds_read_b128 v[36:39], v12 offset:2048
  ds_read_b64_tr_b16 v[104:105], v9 offset:0
  ds_read_b64_tr_b16 v[106:107], v10 offset:0
  s_waitcnt lgkmcnt(14)
  v_mfma_f32_16x16x32_bf16 v[52:55], v[136:139], v[40:43], v[52:55]
  v_mfma_f32_16x16x32_bf16 v[80:83], v[136:139], v[44:47], v[80:83]
  ds_read_b64_tr_b16 v[108:109], v9 offset:32
  ds_read_b64_tr_b16 v[110:111], v10 offset:32
  s_waitcnt lgkmcnt(14)
  v_mfma_f32_16x16x32_bf16 v[56:59], v[140:143], v[40:43], v[56:59]
  v_mfma_f32_16x16x32_bf16 v[84:87], v[140:143], v[44:47], v[84:87]
  ds_read_b64_tr_b16 v[112:113], v9 offset:64
  ds_read_b64_tr_b16 v[114:115], v10 offset:64
  s_waitcnt lgkmcnt(14)
  v_mfma_f32_16x16x32_bf16 v[60:63], v[144:147], v[40:43], v[60:63]
  v_mfma_f32_16x16x32_bf16 v[88:91], v[144:147], v[44:47], v[88:91]
  ds_read_b64_tr_b16 v[116:117], v9 offset:96
  ds_read_b64_tr_b16 v[118:119], v10 offset:96
  s_waitcnt lgkmcnt(14)
  v_mfma_f32_16x16x32_bf16 v[64:67], v[148:151], v[40:43], v[64:67]
  v_mfma_f32_16x16x32_bf16 v[92:95], v[148:151], v[44:47], v[92:95]
  ds_read_b64_tr_b16 v[120:121], v9 offset:128
  ds_read_b64_tr_b16 v[122:123], v10 offset:128
  s_waitcnt lgkmcnt(14)
  v_mfma_f32_16x16x32_bf16 v[68:71], v[152:155], v[40:43], v[68:71]
  v_mfma_f32_16x16x32_bf16 v[96:99], v[152:155], v[44:47], v[96:99]
  ds_read_b64_tr_b16 v[124:125], v9 offset:160
  ds_read_b64_tr_b16 v[126:127], v10 offset:160
  s_waitcnt lgkmcnt(14)
  v_mfma_f32_16x16x32_bf16 v[72:75], v[156:159], v[40:43], v[72:75]
  v_mfma_f32_16x16x32_bf16 v[100:103], v[156:159], v[44:47], v[100:103]
  ds_read_b64_tr_b16 v[128:129], v9 offset:192
  ds_read_b64_tr_b16 v[130:131], v10 offset:192
  s_sub_u32 s45, s45, 1
  s_cmp_lg_u32 s45, 0
  s_cbranch_scc1 k1_loop_t
  s_waitcnt lgkmcnt(0)
  s_nop 3
  s_cmp_ge_u32 s22, 4
  s_mov_b32 s64, 0
  s_cmov_b32 s64, 2097152
  s_cbranch_scc1 k1_noscale
  s_mov_b32 s66, 0x3e8b97f6
  s_mov_b32 s67, 0x3e8b97f6
  v_pk_mul_f32 v[48:49], v[48:49], s[66:67]
  v_pk_mul_f32 v[50:51], v[50:51], s[66:67]
  v_pk_mul_f32 v[52:53], v[52:53], s[66:67]
  v_pk_mul_f32 v[54:55], v[54:55], s[66:67]
  v_pk_mul_f32 v[56:57], v[56:57], s[66:67]
  v_pk_mul_f32 v[58:59], v[58:59], s[66:67]
  v_pk_mul_f32 v[60:61], v[60:61], s[66:67]
  v_pk_mul_f32 v[62:63], v[62:63], s[66:67]
  v_pk_mul_f32 v[64:65], v[64:65], s[66:67]
  v_pk_mul_f32 v[66:67], v[66:67], s[66:67]
  v_pk_mul_f32 v[68:69], v[68:69], s[66:67]
  v_pk_mul_f32 v[70:71], v[70:71], s[66:67]
  v_pk_mul_f32 v[72:73], v[72:73], s[66:67]
  v_pk_mul_f32 v[74:75], v[74:75], s[66:67]
  v_pk_mul_f32 v[76:77], v[76:77], s[66:67]
  v_pk_mul_f32 v[78:79], v[78:79], s[66:67]
  v_pk_mul_f32 v[80:81], v[80:81], s[66:67]
  v_pk_mul_f32 v[82:83], v[82:83], s[66:67]
  v_pk_mul_f32 v[84:85], v[84:85], s[66:67]
  v_pk_mul_f32 v[86:87], v[86:87], s[66:67]
  v_pk_mul_f32 v[88:89], v[88:89], s[66:67]
  v_pk_mul_f32 v[90:91], v[90:91], s[66:67]
  v_pk_mul_f32 v[92:93], v[92:93], s[66:67]
  v_pk_mul_f32 v[94:95], v[94:95], s[66:67]
  v_pk_mul_f32 v[96:97], v[96:97], s[66:67]
  v_pk_mul_f32 v[98:99], v[98:99], s[66:67]
  v_pk_mul_f32 v[100:101], v[100:101], s[66:67]
  v_pk_mul_f32 v[102:103], v[102:103], s[66:67]
k1_noscale:
  v_mul_u32_u24 v5, 240, v3
  v_lshl_add_u32 v5, v4, 3, v5
  v_add_u32 v5, s43, v5
  v_cvt_pk_bf16_f32 v48, v48, v49
  v_cvt_pk_bf16_f32 v49, v50, v51
  ds_write_b64 v5, v[48:49] offset:0
  v_cvt_pk_bf16_f32 v76, v76, v77
  v_cvt_pk_bf16_f32 v77, v78, v79
  ds_write_b64 v5, v[76:77] offset:3840
  v_cvt_pk_bf16_f32 v52, v52, v53
  v_cvt_pk_bf16_f32 v53, v54, v55
  ds_write_b64 v5, v[52:53] offset:32
  v_cvt_pk_bf16_f32 v80, v80, v81
  v_cvt_pk_bf16_f32 v81, v82, v83
  ds_write_b64 v5, v[80:81] offset:3872
  v_cvt_pk_bf16_f32 v56, v56, v57
  v_cvt_pk_bf16_f32 v57, v58, v59
  ds_write_b64 v5, v[56:57] offset:64
  v_cvt_pk_bf16_f32 v84, v84, v85
  v_cvt_pk_bf16_f32 v85, v86, v87
  ds_write_b64 v5, v[84:85] offset:3904
  v_cvt_pk_bf16_f32 v60, v60, v61
  v_cvt_pk_bf16_f32 v61, v62, v63
  ds_write_b64 v5, v[60:61] offset:96
  v_cvt_pk_bf16_f32 v88, v88, v89
  v_cvt_pk_bf16_f32 v89, v90, v91
  ds_write_b64 v5, v[88:89] offset:3936
  v_cvt_pk_bf16_f32 v64, v64, v65
  v_cvt_pk_bf16_f32 v65, v66, v67
  ds_write_b64 v5, v[64:65] offset:128
  v_cvt_pk_bf16_f32 v92, v92, v93
  v_cvt_pk_bf16_f32 v93, v94, v95
  ds_write_b64 v5, v[92:93] offset:3968
  v_cvt_pk_bf16_f32 v68, v68, v69
  v_cvt_pk_bf16_f32 v69, v70, v71
  ds_write_b64 v5, v[68:69] offset:160
  v_cvt_pk_bf16_f32 v96, v96, v97
  v_cvt_pk_bf16_f32 v97, v98, v99
  ds_write_b64 v5, v[96:97] offset:4000
  v_cvt_pk_bf16_f32 v72, v72, v73
  v_cvt_pk_bf16_f32 v73, v74, v75
  ds_write_b64 v5, v[72:73] offset:192
  v_cvt_pk_bf16_f32 v100, v100, v101
  v_cvt_pk_bf16_f32 v101, v102, v103
  ds_write_b64 v5, v[100:101] offset:4032
  s_and_b32 s62, s22, 3
  s_lshl_b32 s62, s62, 19
  s_add_u32 s64, s64, s62
  s_lshl_b32 s62, s23, 2
  s_add_u32 s62, s62, s24
  s_lshl_b32 s62, s62, 11
  s_add_u32 s64, s64, s62
  s_add_u32 s62, s18, s64
  s_addc_u32 s63, s19, 0
  v_lshlrev_b32 v19, 4, v2
  v_and_b32 v18, 31, v2
  v_mul_u32_u24 v18, 240, v18
  v_lshrrev_b32 v6, 5, v2
  v_lshl_add_u32 v18, v6, 4, v18
  v_add_u32 v18, s43, v18
  s_waitcnt lgkmcnt(0)
  ds_read2_b64 v[104:107], v18 offset0:0 offset1:1
  ds_read2_b64 v[108:111], v18 offset0:4 offset1:5
  ds_read2_b64 v[112:115], v18 offset0:7 offset1:8
  ds_read2_b64 v[116:119], v18 offset0:11 offset1:12
  ds_read2_b64 v[120:123], v18 offset0:14 offset1:15
  ds_read2_b64 v[124:127], v18 offset0:18 offset1:19
  ds_read2_b64 v[128:131], v18 offset0:21 offset1:22
  ds_read2_b64 v[132:135], v18 offset0:25 offset1:26
  s_waitcnt lgkmcnt(7)
  global_store_dwordx4 v19, v[104:107], s[62:63] offset:0
  s_waitcnt lgkmcnt(6)
  s_mov_b32 exec_lo, 0
  v_mov_b32 v110, 0
  v_mov_b32 v111, 0
  s_mov_b32 exec_lo, -1
  global_store_dwordx4 v19, v[108:111], s[62:63] offset:1024
  v_add_u32 v19, 0x20000, v19
  s_waitcnt lgkmcnt(5)
  global_store_dwordx4 v19, v[112:115], s[62:63] offset:0
  s_waitcnt lgkmcnt(4)
  s_mov_b32 exec_lo, 0
  v_mov_b32 v118, 0
  v_mov_b32 v119, 0
  s_mov_b32 exec_lo, -1
  global_store_dwordx4 v19, v[116:119], s[62:63] offset:1024
  v_add_u32 v19, 0x20000, v19
  s_waitcnt lgkmcnt(3)
  global_store_dwordx4 v19, v[120:123], s[62:63] offset:0
  s_waitcnt lgkmcnt(2)
  s_mov_b32 exec_lo, 0
  v_mov_b32 v126, 0
  v_mov_b32 v127, 0
  s_mov_b32 exec_lo, -1
  global_store_dwordx4 v19, v[124:127], s[62:63] offset:1024
  v_add_u32 v19, 0x20000, v19
  s_waitcnt lgkmcnt(1)
  global_store_dwordx4 v19, v[128:131], s[62:63] offset:0
  s_waitcnt lgkmcnt(0)
  s_mov_b32 exec_lo, 0
  v_mov_b32 v134, 0
  v_mov_b32 v135, 0
  s_mov_b32 exec_lo, -1
  global_store_dwordx4 v19, v[132:135], s[62:63] offset:1024
  s_endpgm
k1_normal:
  s_barrier
  ds_read_b128 v[32:35], v12 offset:0
  ds_read_b128 v[36:39], v12 offset:2048
  ds_read_b64_tr_b16 v[104:105], v9 offset:0
  ds_read_b64_tr_b16 v[106:107], v10 offset:0
  ds_read_b64_tr_b16 v[108:109], v9 offset:32
  ds_read_b64_tr_b16 v[110:111], v10 offset:32
  ds_read_b64_tr_b16 v[112:113], v9 offset:64
  ds_read_b64_tr_b16 v[114:115], v10 offset:64
  ds_read_b64_tr_b16 v[116:117], v9 offset:96
  ds_read_b64_tr_b16 v[118:119], v10 offset:96
  ds_read_b64_tr_b16 v[120:121], v9 offset:128
  ds_read_b64_tr_b16 v[122:123], v10 offset:128
  ds_read_b64_tr_b16 v[124:125], v9 offset:160
  ds_read_b64_tr_b16 v[126:127], v10 offset:160
  ds_read_b64_tr_b16 v[128:129], v9 offset:192
  ds_read_b64_tr_b16 v[130:131], v10 offset:192
k1_loop_n:
  s_waitcnt lgkmcnt(12)
  v_mfma_f32_16x16x32_bf16 v[48:51], v[32:35], v[104:107], v[48:51]
  v_mfma_f32_16x16x32_bf16 v[76:79], v[36:39], v[104:107], v[76:79]
  ds_read_b128 v[40:43], v13 offset:0
  ds_read_b128 v[44:47], v13 offset:2048
  ds_read_b64_tr_b16 v[132:133], v9 offset:7168
  ds_read_b64_tr_b16 v[134:135], v10 offset:7168
  s_waitcnt lgkmcnt(14)
  v_mfma_f32_16x16x32_bf16 v[52:55], v[32:35], v[108:111], v[52:55]
  v_mfma_f32_16x16x32_bf16 v[80:83], v[36:39], v[108:111], v[80:83]
  ds_read_b64_tr_b16 v[136:137], v9 offset:7200
  ds_read_b64_tr_b16 v[138:139], v10 offset:7200
  s_waitcnt lgkmcnt(14)
  v_mfma_f32_16x16x32_bf16 v[56:59], v[32:35], v[112:115], v[56:59]
  v_mfma_f32_16x16x32_bf16 v[84:87], v[36:39], v[112:115], v[84:87]
  ds_read_b64_tr_b16 v[140:141], v9 offset:7232
  ds_read_b64_tr_b16 v[142:143], v10 offset:7232
  s_waitcnt lgkmcnt(14)
  v_mfma_f32_16x16x32_bf16 v[60:63], v[32:35], v[116:119], v[60:63]
  v_mfma_f32_16x16x32_bf16 v[88:91], v[36:39], v[116:119], v[88:91]
  ds_read_b64_tr_b16 v[144:145], v9 offset:7264
  ds_read_b64_tr_b16 v[146:147], v10 offset:7264
  s_waitcnt lgkmcnt(14)
  v_mfma_f32_16x16x32_bf16 v[64:67], v[32:35], v[120:123], v[64:67]
  v_mfma_f32_16x16x32_bf16 v[92:95], v[36:39], v[120:123], v[92:95]
  ds_read_b64_tr_b16 v[148:149], v9 offset:7296
  ds_read_b64_tr_b16 v[150:151], v10 offset:7296
  s_waitcnt lgkmcnt(14)
  v_mfma_f32_16x16x32_bf16 v[68:71], v[32:35], v[124:127], v[68:71]
  v_mfma_f32_16x16x32_bf16 v[96:99], v[36:39], v[124:127], v[96:99]
  ds_read_b64_tr_b16 v[152:153], v9 offset:7328
  ds_read_b64_tr_b16 v[154:155], v10 offset:7328
  s_waitcnt lgkmcnt(14)
  v_mfma_f32_16x16x32_bf16 v[72:75], v[32:35], v[128:131], v[72:75]
  v_mfma_f32_16x16x32_bf16 v[100:103], v[36:39], v[128:131], v[100:103]
  ds_read_b64_tr_b16 v[156:157], v9 offset:7360
  ds_read_b64_tr_b16 v[158:159], v10 offset:7360
  s_add_u32 s44, s44, 1
  s_cmp_eq_u32 s44, 5
  s_cmov_b32 s44, 0
  s_mul_i32 s46, s44, 16384
  s_mul_i32 s47, s44, 14336
  v_add_u32 v12, s46, v22
  v_add_u32 v13, s46, v23
  v_add_u32 v9, s47, v20
  v_add_u32 v10, s47, v21
  s_barrier
  s_waitcnt lgkmcnt(12)
  v_mfma_f32_16x16x32_bf16 v[48:51], v[40:43], v[132:135], v[48:51]
  v_mfma_f32_16x16x32_bf16 v[76:79], v[44:47], v[132:135], v[76:79]
  ds_read_b128 v[32:35], v12 offset:0
  ds_read_b128 v[36:39], v12 offset:2048
  ds_read_b64_tr_b16 v[104:105], v9 offset:0
  ds_read_b64_tr_b16 v[106:107], v10 offset:0
  s_waitcnt lgkmcnt(14)
  v_mfma_f32_16x16x32_bf16 v[52:55], v[40:43], v[136:139], v[52:55]
  v_mfma_f32_16x16x32_bf16 v[80:83], v[44:47], v[136:139], v[80:83]
  ds_read_b64_tr_b16 v[108:109], v9 offset:32
  ds_read_b64_tr_b16 v[110:111], v10 offset:32
  s_waitcnt lgkmcnt(14)
  v_mfma_f32_16x16x32_bf16 v[56:59], v[40:43], v[140:143], v[56:59]
  v_mfma_f32_16x16x32_bf16 v[84:87], v[44:47], v[140:143], v[84:87]
  ds_read_b64_tr_b16 v[112:113], v9 offset:64
  ds_read_b64_tr_b16 v[114:115], v10 offset:64
  s_waitcnt lgkmcnt(14)
  v_mfma_f32_16x16x32_bf16 v[60:63], v[40:43], v[144:147], v[60:63]
  v_mfma_f32_16x16x32_bf16 v[88:91], v[44:47], v[144:147], v[88:91]
  ds_read_b64_tr_b16 v[116:117], v9 offset:96
  ds_read_b64_tr_b16 v[118:119], v10 offset:96
  s_waitcnt lgkmcnt(14)
  v_mfma_f32_16x16x32_bf16 v[64:67], v[40:43], v[148:151], v[64:67]
  v_mfma_f32_16x16x32_bf16 v[92:95], v[44:47], v[148:151], v[92:95]
  ds_read_b64_tr_b16 v[120:121], v9 offset:128
  ds_read_b64_tr_b16 v[122:123], v10 offset:128
  s_waitcnt lgkmcnt(14)
  v_mfma_f32_16x16x32_bf16 v[68:71], v[40:43], v[152:155], v[68:71]
  v_mfma_f32_16x16x32_bf16 v[96:99], v[44:47], v[152:155], v[96:99]
  ds_read_b64_tr_b16 v[124:125], v9 offset:160
  ds_read_b64_tr_b16 v[126:127], v10 offset:160
  s_waitcnt lgkmcnt(14)
  v_mfma_f32_16x16x32_bf16 v[72:75], v[40:43], v[156:159], v[72:75]
  v_mfma_f32_16x16x32_bf16 v[100:103], v[44:47], v[156:159], v[100:103]
  ds_read_b64_tr_b16 v[128:129], v9 offset:192
  ds_read_b64_tr_b16 v[130:131], v10 offset:192
  s_sub_u32 s45, s45, 1
  s_cmp_lg_u32 s45, 0
  s_cbranch_scc1 k1_loop_n
  s_waitcnt lgkmcnt(0)
  s_nop 3
  s_cmp_ge_u32 s22, 12
  s_cbranch_scc1 k1_f
  s_mov_b32 s64, 4194304
  v_mul_u32_u24 v5, 80, v3
  v_lshl_add_u32 v5, v4, 3, v5
  v_add_u32 v5, s43, v5
  v_cvt_pk_bf16_f32 v48, v48, v49
  v_cvt_pk_bf16_f32 v49, v50, v51
  ds_write_b64 v5, v[48:49] offset:0
  v_cvt_pk_bf16_f32 v76, v76, v77
  v_cvt_pk_bf16_f32 v77, v78, v79
  ds_write_b64 v5, v[76:77] offset:32
  v_cvt_pk_bf16_f32 v52, v52, v53
  v_cvt_pk_bf16_f32 v53, v54, v55
  ds_write_b64 v5, v[52:53] offset:1280
  v_cvt_pk_bf16_f32 v80, v80, v81
  v_cvt_pk_bf16_f32 v81, v82, v83
  ds_write_b64 v5, v[80:81] offset:1312
  v_cvt_pk_bf16_f32 v56, v56, v57
  v_cvt_pk_bf16_f32 v57, v58, v59
  ds_write_b64 v5, v[56:57] offset:2560
  v_cvt_pk_bf16_f32 v84, v84, v85
  v_cvt_pk_bf16_f32 v85, v86, v87
  ds_write_b64 v5, v[84:85] offset:2592
  v_cvt_pk_bf16_f32 v60, v60, v61
  v_cvt_pk_bf16_f32 v61, v62, v63
  ds_write_b64 v5, v[60:61] offset:3840
  v_cvt_pk_bf16_f32 v88, v88, v89
  v_cvt_pk_bf16_f32 v89, v90, v91
  ds_write_b64 v5, v[88:89] offset:3872
  v_cvt_pk_bf16_f32 v64, v64, v65
  v_cvt_pk_bf16_f32 v65, v66, v67
  ds_write_b64 v5, v[64:65] offset:5120
  v_cvt_pk_bf16_f32 v92, v92, v93
  v_cvt_pk_bf16_f32 v93, v94, v95
  ds_write_b64 v5, v[92:93] offset:5152
  v_cvt_pk_bf16_f32 v68, v68, v69
  v_cvt_pk_bf16_f32 v69, v70, v71
  ds_write_b64 v5, v[68:69] offset:6400
  v_cvt_pk_bf16_f32 v96, v96, v97
  v_cvt_pk_bf16_f32 v97, v98, v99
  ds_write_b64 v5, v[96:97] offset:6432
  v_cvt_pk_bf16_f32 v72, v72, v73
  v_cvt_pk_bf16_f32 v73, v74, v75
  ds_write_b64 v5, v[72:73] offset:7680
  v_cvt_pk_bf16_f32 v100, v100, v101
  v_cvt_pk_bf16_f32 v101, v102, v103
  ds_write_b64 v5, v[100:101] offset:7712
  s_and_b32 s62, s22, 3
  s_lshl_b32 s62, s62, 19
  s_add_u32 s64, s64, s62
  s_lshl_b32 s62, s23, 2
  s_add_u32 s62, s62, s24
  s_lshl_b32 s62, s62, 11
  s_add_u32 s64, s64, s62
  s_add_u32 s62, s18, s64
  s_addc_u32 s63, s19, 0
  v_lshlrev_b32 v19, 4, v2
  v_and_b32 v18, 31, v2
  v_mul_u32_u24 v18, 80, v18
  v_lshrrev_b32 v6, 5, v2
  v_lshl_add_u32 v18, v6, 4, v18
  v_add_u32 v18, s43, v18
  v_mov_b32 v104, 0x3f803f80
  v_mov_b32 v105, 0x3f803f80
  v_mov_b32 v106, 0x3f803f80
  v_mov_b32 v107, 0x3f803f80
  v_mov_b32 v108, 0x3f803f80
  v_mov_b32 v109, 0x3f803f80
  v_mov_b32 v110, 0x3f803f80
  v_mov_b32 v111, 0x3f803f80
  v_mov_b32 v112, 0x3f803f80
  v_mov_b32 v113, 0x3f803f80
  v_mov_b32 v114, 0x3f803f80
  v_mov_b32 v115, 0x3f803f80
  v_mov_b32 v116, 0x3f803f80
  v_mov_b32 v117, 0x3f803f80
  v_mov_b32 v118, 0x3f803f80
  v_mov_b32 v119, 0x3f803f80
  v_mov_b32 v120, 0x3f803f80
  v_mov_b32 v121, 0x3f803f80
  v_mov_b32 v122, 0x3f803f80
  v_mov_b32 v123, 0x3f803f80
  v_mov_b32 v124, 0x3f803f80
  v_mov_b32 v125, 0x3f803f80
  v_mov_b32 v126, 0x3f803f80
  v_mov_b32 v127, 0x3f803f80
  v_mov_b32 v128, 0x3f803f80
  v_mov_b32 v129, 0x3f803f80
  v_mov_b32 v130, 0x3f803f80
  v_mov_b32 v131, 0x3f803f80
  v_mov_b32 v132, 0x3f803f80
  v_mov_b32 v133, 0x3f803f80
  v_mov_b32 v134, 0x3f803f80
  v_mov_b32 v135, 0x3f803f80
  s_waitcnt lgkmcnt(0)
  s_mov_b32 exec_lo, 0x0fffffff
  s_mov_b32 exec_hi, 0x0fffffff
  ds_read_b128 v[104:107], v18 offset:0
  ds_read_b128 v[108:111], v18 offset:32
  ds_read_b128 v[112:115], v18 offset:2240
  ds_read_b128 v[116:119], v18 offset:2272
  ds_read_b128 v[120:123], v18 offset:4480
  ds_read_b128 v[124:127], v18 offset:4512
  ds_read_b128 v[128:131], v18 offset:6720
  ds_read_b128 v[132:135], v18 offset:6752
  s_mov_b64 exec, -1
  s_waitcnt lgkmcnt(7)
  global_store_dwordx4 v19, v[104:107], s[62:63] offset:0
  s_waitcnt lgkmcnt(6)
  global_store_dwordx4 v19, v[108:111], s[62:63] offset:1024
  v_add_u32 v19, 0x20000, v19
  s_waitcnt lgkmcnt(5)
  global_store_dwordx4 v19, v[112:115], s[62:63] offset:0
  s_waitcnt lgkmcnt(4)
  global_store_dwordx4 v19, v[116:119], s[62:63] offset:1024
  v_add_u32 v19, 0x20000, v19
  s_waitcnt lgkmcnt(3)
  global_store_dwordx4 v19, v[120:123], s[62:63] offset:0
  s_waitcnt lgkmcnt(2)
  global_store_dwordx4 v19, v[124:127], s[62:63] offset:1024
  v_add_u32 v19, 0x20000, v19
  s_waitcnt lgkmcnt(1)
  global_store_dwordx4 v19, v[128:131], s[62:63] offset:0
  s_waitcnt lgkmcnt(0)
  global_store_dwordx4 v19, v[132:135], s[62:63] offset:1024
  s_endpgm
k1_f:
  v_lshlrev_b32 v5, 6, v3
  v_lshl_add_u32 v5, v4, 3, v5
  v_add_u32 v5, s43, v5
  v_cvt_pk_bf16_f32 v48, v48, v49
  v_cvt_pk_bf16_f32 v49, v50, v51
  ds_write_b64 v5, v[48:49] offset:0
  v_cvt_pk_bf16_f32 v76, v76, v77
  v_cvt_pk_bf16_f32 v77, v78, v79
  ds_write_b64 v5, v[76:77] offset:32
  v_cvt_pk_bf16_f32 v52, v52, v53
  v_cvt_pk_bf16_f32 v53, v54, v55
  ds_write_b64 v5, v[52:53] offset:1024
  v_cvt_pk_bf16_f32 v80, v80, v81
  v_cvt_pk_bf16_f32 v81, v82, v83
  ds_write_b64 v5, v[80:81] offset:1056
  v_cvt_pk_bf16_f32 v56, v56, v57
  v_cvt_pk_bf16_f32 v57, v58, v59
  ds_write_b64 v5, v[56:57] offset:2048
  v_cvt_pk_bf16_f32 v84, v84, v85
  v_cvt_pk_bf16_f32 v85, v86, v87
  ds_write_b64 v5, v[84:85] offset:2080
  v_cvt_pk_bf16_f32 v60, v60, v61
  v_cvt_pk_bf16_f32 v61, v62, v63
  ds_write_b64 v5, v[60:61] offset:3072
  v_cvt_pk_bf16_f32 v88, v88, v89
  v_cvt_pk_bf16_f32 v89, v90, v91
  ds_write_b64 v5, v[88:89] offset:3104
  v_cvt_pk_bf16_f32 v64, v64, v65
  v_cvt_pk_bf16_f32 v65, v66, v67
  ds_write_b64 v5, v[64:65] offset:4096
  v_cvt_pk_bf16_f32 v92, v92, v93
  v_cvt_pk_bf16_f32 v93, v94, v95
  ds_write_b64 v5, v[92:93] offset:4128
  v_cvt_pk_bf16_f32 v68, v68, v69
  v_cvt_pk_bf16_f32 v69, v70, v71
  ds_write_b64 v5, v[68:69] offset:5120
  v_cvt_pk_bf16_f32 v96, v96, v97
  v_cvt_pk_bf16_f32 v97, v98, v99
  ds_write_b64 v5, v[96:97] offset:5152
  v_cvt_pk_bf16_f32 v72, v72, v73
  v_cvt_pk_bf16_f32 v73, v74, v75
  ds_write_b64 v5, v[72:73] offset:6144
  v_cvt_pk_bf16_f32 v100, v100, v101
  v_cvt_pk_bf16_f32 v101, v102, v103
  ds_write_b64 v5, v[100:101] offset:6176
  s_sub_u32 s64, s22, 12
  s_mul_i32 s64, s64, 458752
  s_add_u32 s64, s64, 6291456
  s_lshl_b32 s62, s23, 8
  s_add_u32 s64, s64, s62
  s_lshl_b32 s62, s24, 6
  s_add_u32 s64, s64, s62
  s_add_u32 s62, s18, s64
  s_addc_u32 s63, s19, 0
  v_lshlrev_b32 v18, 4, v2
  v_add_u32 v18, s43, v18
  v_lshrrev_b32 v19, 2, v2
  v_lshlrev_b32 v19, 12, v19
  v_and_b32 v6, 3, v2
  v_lshl_add_u32 v19, v6, 4, v19
  s_waitcnt lgkmcnt(0)
  ds_read_b128 v[104:107], v18 offset:0
  ds_read_b128 v[108:111], v18 offset:1024
  ds_read_b128 v[112:115], v18 offset:2048
  ds_read_b128 v[116:119], v18 offset:3072
  ds_read_b128 v[120:123], v18 offset:4096
  ds_read_b128 v[124:127], v18 offset:5120
  ds_read_b128 v[128:131], v18 offset:6144
  s_waitcnt lgkmcnt(6)
  global_store_dwordx4 v19, v[104:107], s[62:63]
  v_add_u32 v19, 0x10000, v19
  s_waitcnt lgkmcnt(5)
  global_store_dwordx4 v19, v[108:111], s[62:63]
  v_add_u32 v19, 0x10000, v19
  s_waitcnt lgkmcnt(4)
  global_store_dwordx4 v19, v[112:115], s[62:63]
  v_add_u32 v19, 0x10000, v19
  s_waitcnt lgkmcnt(3)
  global_store_dwordx4 v19, v[116:119], s[62:63]
  v_add_u32 v19, 0x10000, v19
  s_waitcnt lgkmcnt(2)
  global_store_dwordx4 v19, v[120:123], s[62:63]
  v_add_u32 v19, 0x10000, v19
  s_waitcnt lgkmcnt(1)
  global_store_dwordx4 v19, v[124:127], s[62:63]
  v_add_u32 v19, 0x10000, v19
  s_waitcnt lgkmcnt(0)
  global_store_dwordx4 v19, v[128:131], s[62:63]
k1_end:
  s_endpgm
k1_code_end:
  .globl k2_kernel
  .p2align 8
  .type k2_kernel,@function
k2_kernel:
  s_cmp_ge_u32 s2, 256
  s_cbranch_scc1 k2_end
  s_load_dwordx2 s[18:19], s[0:1], 72
  v_lshrrev_b32 v1, 6, v0
  v_and_b32 v2, 63, v0
  v_readfirstlane_b32 s24, v1
  v_lshlrev_b32 v3, 4, v2
  v_mov_b32 v6, 57344
  v_mov_b32 v7, 0
  ds_write_b32 v6, v7
  s_waitcnt lgkmcnt(0)
  s_barrier
  s_cmp_ge_u32 s24, 4
  s_cbranch_scc1 k2_fft
  s_and_b32 s20, s2, 7
  s_lshr_b32 s21, s2, 3
  s_lshl_b32 s22, s20, 1
  s_and_b32 s23, s21, 1
  s_add_u32 s22, s22, s23
  s_lshr_b32 s23, s21, 1
  v_and_b32 v4, 0x33f, v3
  v_bfe_u32 v5, v3, 6, 1
  v_lshl_or_b32 v4, v5, 7, v4
  v_bfe_u32 v5, v3, 7, 1
  v_lshl_or_b32 v4, v5, 6, v4
  s_lshl_b32 s25, s22, 17
  s_lshl_b32 s26, s24, 15
  s_add_u32 s26, s26, s25
  s_add_u32 s27, s26, 2097152
  s_add_u32 s26, s26, 4194304
  s_waitcnt lgkmcnt(0)
  s_add_u32 s28, s18, s27
  s_addc_u32 s29, s19, 0
  s_add_u32 s30, s18, s26
  s_addc_u32 s31, s19, 0
  s_lshl_b32 s32, s23, 13
  s_add_u32 s32, s32, s25
  s_add_u32 s33, s24, 1
  s_and_b32 s33, s33, 3
  s_lshl_b32 s33, s33, 11
  s_add_u32 s33, s33, s32
  s_add_u32 s34, s18, s33
  s_addc_u32 s35, s19, 0
  global_load_dwordx4 v[16:19], v3, s[34:35]
  global_load_dwordx4 v[20:23], v3, s[34:35] offset:1024
  global_load_dwordx4 v[152:155], v4, s[28:29] offset:0
  global_load_dwordx4 v[156:159], v4, s[28:29] offset:1024
  global_load_dwordx4 v[160:163], v3, s[30:31] offset:0
  global_load_dwordx4 v[164:167], v3, s[30:31] offset:1024
  s_add_u32 s33, s24, 2
  s_and_b32 s33, s33, 3
  s_lshl_b32 s33, s33, 11
  s_add_u32 s33, s33, s32
  s_add_u32 s34, s18, s33
  s_addc_u32 s35, s19, 0
  global_load_dwordx4 v[24:27], v3, s[34:35]
  global_load_dwordx4 v[28:31], v3, s[34:35] offset:1024
  s_add_u32 s33, s24, 3
  s_and_b32 s33, s33, 3
  s_lshl_b32 s33, s33, 11
  s_add_u32 s33, s33, s32
  s_add_u32 s34, s18, s33
  s_addc_u32 s35, s19, 0
  global_load_dwordx4 v[32:35], v3, s[34:35]
  global_load_dwordx4 v[36:39], v3, s[34:35] offset:1024
  s_add_u32 s33, s24, 4
  s_and_b32 s33, s33, 3
  s_lshl_b32 s33, s33, 11
  s_add_u32 s33, s33, s32
  s_add_u32 s34, s18, s33
  s_addc_u32 s35, s19, 0
  global_load_dwordx4 v[40:43], v3, s[34:35]
  global_load_dwordx4 v[44:47], v3, s[34:35] offset:1024
  global_load_dwordx4 v[168:171], v4, s[28:29] offset:2048
  global_load_dwordx4 v[172:175], v4, s[28:29] offset:3072
  global_load_dwordx4 v[176:179], v3, s[30:31] offset:2048
  global_load_dwordx4 v[180:183], v3, s[30:31] offset:3072
  s_add_u32 s28, s28, 4096
  s_addc_u32 s29, s29, 0
  s_add_u32 s30, s30, 4096
  s_addc_u32 s31, s31, 0
  global_load_dwordx4 v[184:187], v4, s[28:29] offset:0
  global_load_dwordx4 v[188:191], v4, s[28:29] offset:1024
  global_load_dwordx4 v[192:195], v3, s[30:31] offset:0
  global_load_dwordx4 v[196:199], v3, s[30:31] offset:1024
  s_add_u32 s28, s28, 2048
  s_addc_u32 s29, s29, 0
  s_add_u32 s30, s30, 2048
  s_addc_u32 s31, s31, 0
  v_mov_b32 v48, 0
  v_mov_b32 v49, 0
  v_mov_b32 v50, 0
  v_mov_b32 v51, 0
  v_mov_b32 v52, 0
  v_mov_b32 v53, 0
  v_mov_b32 v54, 0
  v_mov_b32 v55, 0
  v_mov_b32 v56, 0
  v_mov_b32 v57, 0
  v_mov_b32 v58, 0
  v_mov_b32 v59, 0
  v_mov_b32 v60, 0
  v_mov_b32 v61, 0
  v_mov_b32 v62, 0
  v_mov_b32 v63, 0
  v_mov_b32 v64, 0
  v_mov_b32 v65, 0
  v_mov_b32 v66, 0
  v_mov_b32 v67, 0
  v_mov_b32 v68, 0
  v_mov_b32 v69, 0
  v_mov_b32 v70, 0
  v_mov_b32 v71, 0
  v_mov_b32 v72, 0
  v_mov_b32 v73, 0
  v_mov_b32 v74, 0
  v_mov_b32 v75, 0
  v_mov_b32 v76, 0
  v_mov_b32 v77, 0
  v_mov_b32 v78, 0
  v_mov_b32 v79, 0
  v_mov_b32 v80, 0
  v_mov_b32 v81, 0
  v_mov_b32 v82, 0
  v_mov_b32 v83, 0
  v_mov_b32 v84, 0
  v_mov_b32 v85, 0
  v_mov_b32 v86, 0
  v_mov_b32 v87, 0
  v_mov_b32 v88, 0
  v_mov_b32 v89, 0
  v_mov_b32 v90, 0
  v_mov_b32 v91, 0
  v_mov_b32 v92, 0
  v_mov_b32 v93, 0
  v_mov_b32 v94, 0
  v_mov_b32 v95, 0
  v_mov_b32 v96, 0
  v_mov_b32 v97, 0
  v_mov_b32 v98, 0
  v_mov_b32 v99, 0
  v_mov_b32 v100, 0
  v_mov_b32 v101, 0
  v_mov_b32 v102, 0
  v_mov_b32 v103, 0
  v_mov_b32 v104, 0
  v_mov_b32 v105, 0
  v_mov_b32 v106, 0
  v_mov_b32 v107, 0
  v_mov_b32 v108, 0
  v_mov_b32 v109, 0
  v_mov_b32 v110, 0
  v_mov_b32 v111, 0
  v_mov_b32 v144, 0
  v_mov_b32 v145, 0
  v_mov_b32 v146, 0
  v_mov_b32 v147, 0
  v_mov_b32 v148, 0
  v_mov_b32 v149, 0
  v_mov_b32 v150, 0
  v_mov_b32 v151, 0
  v_mov_b32 v208, 0
  v_mov_b32 v209, 0
  v_mov_b32 v210, 0
  v_mov_b32 v211, 0
  v_mov_b32 v212, 0
  v_mov_b32 v213, 0
  v_mov_b32 v214, 0
  v_mov_b32 v215, 0
  s_waitcnt vmcnt(14)
  v_mfma_f32_32x32x16_bf16 v[112:127], v[152:155], v[16:19], 0
  v_mfma_f32_32x32x16_bf16 v[112:127], v[156:159], v[20:23], v[112:127]
  s_waitcnt vmcnt(8)
  s_mov_b32 s36, 3
  s_add_u32 s33, s24, 1
  s_and_b32 s33, s33, 3
  s_mul_i32 s33, s33, 12288
  v_add_u32 v5, s33, v3
  s_add_u32 s33, s24, 2
  s_and_b32 s33, s33, 3
  s_mul_i32 s33, s33, 12288
  v_add_u32 v6, s33, v3
  s_add_u32 s33, s24, 3
  s_and_b32 s33, s33, 3
  s_mul_i32 s33, s33, 12288
  v_add_u32 v7, s33, v3
  s_nop 3
k2_loop:
  v_mfma_f32_32x32x16_bf16 v[128:143], v[152:155], v[24:27], 0
  v_exp_f32 v112, v112
  v_exp_f32 v113, v113
  v_exp_f32 v114, v114
  v_exp_f32 v115, v115
  v_mfma_f32_32x32x16_bf16 v[96:111], v[212:215], v[148:151], v[96:111]
  global_load_dwordx4 v[200:203], v4, s[28:29] offset:0
  global_load_dwordx4 v[204:207], v4, s[28:29] offset:1024
  global_load_dwordx4 v[208:211], v3, s[30:31] offset:0
  global_load_dwordx4 v[212:215], v3, s[30:31] offset:1024
  s_add_u32 s28, s28, 2048
  s_addc_u32 s29, s29, 0
  s_add_u32 s30, s30, 2048
  s_addc_u32 s31, s31, 0
  v_exp_f32 v116, v116
  v_exp_f32 v117, v117
  v_exp_f32 v118, v118
  v_exp_f32 v119, v119
  v_cvt_pk_bf16_f32 v144, v112, v113
  v_cvt_pk_bf16_f32 v145, v114, v115
  v_cvt_pk_bf16_f32 v146, v116, v117
  v_cvt_pk_bf16_f32 v147, v118, v119
  v_mfma_f32_32x32x16_bf16 v[128:143], v[156:159], v[28:31], v[128:143]
  v_exp_f32 v120, v120
  v_exp_f32 v121, v121
  v_exp_f32 v122, v122
  v_exp_f32 v123, v123
  v_mfma_f32_32x32x16_bf16 v[48:63], v[160:163], v[144:147], v[48:63]
  v_exp_f32 v124, v124
  v_exp_f32 v125, v125
  v_exp_f32 v126, v126
  v_exp_f32 v127, v127
  v_cvt_pk_bf16_f32 v148, v120, v121
  v_cvt_pk_bf16_f32 v149, v122, v123
  v_cvt_pk_bf16_f32 v150, v124, v125
  v_cvt_pk_bf16_f32 v151, v126, v127
  v_mfma_f32_32x32x16_bf16 v[112:127], v[152:155], v[32:35], 0
  v_exp_f32 v128, v128
  v_exp_f32 v129, v129
  v_exp_f32 v130, v130
  v_exp_f32 v131, v131
  v_mfma_f32_32x32x16_bf16 v[48:63], v[164:167], v[148:151], v[48:63]
  v_exp_f32 v132, v132
  v_exp_f32 v133, v133
  v_exp_f32 v134, v134
  v_exp_f32 v135, v135
  v_cvt_pk_bf16_f32 v144, v128, v129
  v_cvt_pk_bf16_f32 v145, v130, v131
  v_cvt_pk_bf16_f32 v146, v132, v133
  v_cvt_pk_bf16_f32 v147, v134, v135
  v_mfma_f32_32x32x16_bf16 v[112:127], v[156:159], v[36:39], v[112:127]
  v_exp_f32 v136, v136
  v_exp_f32 v137, v137
  v_exp_f32 v138, v138
  v_exp_f32 v139, v139
  v_mfma_f32_32x32x16_bf16 v[64:79], v[160:163], v[144:147], v[64:79]
  v_exp_f32 v140, v140
  v_exp_f32 v141, v141
  v_exp_f32 v142, v142
  v_exp_f32 v143, v143
  v_cvt_pk_bf16_f32 v148, v136, v137
  v_cvt_pk_bf16_f32 v149, v138, v139
  v_cvt_pk_bf16_f32 v150, v140, v141
  v_cvt_pk_bf16_f32 v151, v142, v143
  v_mfma_f32_32x32x16_bf16 v[128:143], v[152:155], v[40:43], 0
  v_exp_f32 v112, v112
  v_exp_f32 v113, v113
  v_exp_f32 v114, v114
  v_exp_f32 v115, v115
  v_mfma_f32_32x32x16_bf16 v[64:79], v[164:167], v[148:151], v[64:79]
  v_exp_f32 v116, v116
  v_exp_f32 v117, v117
  v_exp_f32 v118, v118
  v_exp_f32 v119, v119
  v_cvt_pk_bf16_f32 v144, v112, v113
  v_cvt_pk_bf16_f32 v145, v114, v115
  v_cvt_pk_bf16_f32 v146, v116, v117
  v_cvt_pk_bf16_f32 v147, v118, v119
  v_mfma_f32_32x32x16_bf16 v[128:143], v[156:159], v[44:47], v[128:143]
  v_exp_f32 v120, v120
  v_exp_f32 v121, v121
  v_exp_f32 v122, v122
  v_exp_f32 v123, v123
  v_mfma_f32_32x32x16_bf16 v[80:95], v[160:163], v[144:147], v[80:95]
  v_exp_f32 v124, v124
  v_exp_f32 v125, v125
  v_exp_f32 v126, v126
  v_exp_f32 v127, v127
  v_cvt_pk_bf16_f32 v148, v120, v121
  v_cvt_pk_bf16_f32 v149, v122, v123
  v_cvt_pk_bf16_f32 v150, v124, v125
  v_cvt_pk_bf16_f32 v151, v126, v127
  s_waitcnt vmcnt(8)
  v_mfma_f32_32x32x16_bf16 v[112:127], v[168:171], v[16:19], 0
  v_exp_f32 v128, v128
  v_exp_f32 v129, v129
  v_exp_f32 v130, v130
  v_exp_f32 v131, v131
  v_mfma_f32_32x32x16_bf16 v[80:95], v[164:167], v[148:151], v[80:95]
  v_exp_f32 v132, v132
  v_exp_f32 v133, v133
  v_exp_f32 v134, v134
  v_exp_f32 v135, v135
  v_cvt_pk_bf16_f32 v144, v128, v129
  v_cvt_pk_bf16_f32 v145, v130, v131
  v_cvt_pk_bf16_f32 v146, v132, v133
  v_cvt_pk_bf16_f32 v147, v134, v135
  v_mfma_f32_32x32x16_bf16 v[112:127], v[172:175], v[20:23], v[112:127]
  v_exp_f32 v136, v136
  v_exp_f32 v137, v137
  v_exp_f32 v138, v138
  v_exp_f32 v139, v139
  v_mfma_f32_32x32x16_bf16 v[96:111], v[160:163], v[144:147], v[96:111]
  v_exp_f32 v140, v140
  v_exp_f32 v141, v141
  v_exp_f32 v142, v142
  v_exp_f32 v143, v143
  v_cvt_pk_bf16_f32 v148, v136, v137
  v_cvt_pk_bf16_f32 v149, v138, v139
  v_cvt_pk_bf16_f32 v150, v140, v141
  v_cvt_pk_bf16_f32 v151, v142, v143
  v_mfma_f32_32x32x16_bf16 v[128:143], v[168:171], v[24:27], 0
  v_exp_f32 v112, v112
  v_exp_f32 v113, v113
  v_exp_f32 v114, v114
  v_exp_f32 v115, v115
  v_mfma_f32_32x32x16_bf16 v[96:111], v[164:167], v[148:151], v[96:111]
  global_load_dwordx4 v[152:155], v4, s[28:29] offset:0
  global_load_dwordx4 v[156:159], v4, s[28:29] offset:1024
  global_load_dwordx4 v[160:163], v3, s[30:31] offset:0
  global_load_dwordx4 v[164:167], v3, s[30:31] offset:1024
  s_add_u32 s28, s28, 2048
  s_addc_u32 s29, s29, 0
  s_add_u32 s30, s30, 2048
  s_addc_u32 s31, s31, 0
  v_exp_f32 v116, v116
  v_exp_f32 v117, v117
  v_exp_f32 v118, v118
  v_exp_f32 v119, v119
  v_cvt_pk_bf16_f32 v144, v112, v113
  v_cvt_pk_bf16_f32 v145, v114, v115
  v_cvt_pk_bf16_f32 v146, v116, v117
  v_cvt_pk_bf16_f32 v147, v118, v119
  v_mfma_f32_32x32x16_bf16 v[128:143], v[172:175], v[28:31], v[128:143]
  v_exp_f32 v120, v120
  v_exp_f32 v121, v121
  v_exp_f32 v122, v122
  v_exp_f32 v123, v123
  v_mfma_f32_32x32x16_bf16 v[48:63], v[176:179], v[144:147], v[48:63]
  v_exp_f32 v124, v124
  v_exp_f32 v125, v125
  v_exp_f32 v126, v126
  v_exp_f32 v127, v127
  v_cvt_pk_bf16_f32 v148, v120, v121
  v_cvt_pk_bf16_f32 v149, v122, v123
  v_cvt_pk_bf16_f32 v150, v124, v125
  v_cvt_pk_bf16_f32 v151, v126, v127
  v_mfma_f32_32x32x16_bf16 v[112:127], v[168:171], v[32:35], 0
  v_exp_f32 v128, v128
  v_exp_f32 v129, v129
  v_exp_f32 v130, v130
  v_exp_f32 v131, v131
  v_mfma_f32_32x32x16_bf16 v[48:63], v[180:183], v[148:151], v[48:63]
  v_exp_f32 v132, v132
  v_exp_f32 v133, v133
  v_exp_f32 v134, v134
  v_exp_f32 v135, v135
  v_cvt_pk_bf16_f32 v144, v128, v129
  v_cvt_pk_bf16_f32 v145, v130, v131
  v_cvt_pk_bf16_f32 v146, v132, v133
  v_cvt_pk_bf16_f32 v147, v134, v135
  v_mfma_f32_32x32x16_bf16 v[112:127], v[172:175], v[36:39], v[112:127]
  v_exp_f32 v136, v136
  v_exp_f32 v137, v137
  v_exp_f32 v138, v138
  v_exp_f32 v139, v139
  v_mfma_f32_32x32x16_bf16 v[64:79], v[176:179], v[144:147], v[64:79]
  v_exp_f32 v140, v140
  v_exp_f32 v141, v141
  v_exp_f32 v142, v142
  v_exp_f32 v143, v143
  v_cvt_pk_bf16_f32 v148, v136, v137
  v_cvt_pk_bf16_f32 v149, v138, v139
  v_cvt_pk_bf16_f32 v150, v140, v141
  v_cvt_pk_bf16_f32 v151, v142, v143
  v_mfma_f32_32x32x16_bf16 v[128:143], v[168:171], v[40:43], 0
  v_exp_f32 v112, v112
  v_exp_f32 v113, v113
  v_exp_f32 v114, v114
  v_exp_f32 v115, v115
  v_mfma_f32_32x32x16_bf16 v[64:79], v[180:183], v[148:151], v[64:79]
  v_exp_f32 v116, v116
  v_exp_f32 v117, v117
  v_exp_f32 v118, v118
  v_exp_f32 v119, v119
  v_cvt_pk_bf16_f32 v144, v112, v113
  v_cvt_pk_bf16_f32 v145, v114, v115
  v_cvt_pk_bf16_f32 v146, v116, v117
  v_cvt_pk_bf16_f32 v147, v118, v119
  v_mfma_f32_32x32x16_bf16 v[128:143], v[172:175], v[44:47], v[128:143]
  v_exp_f32 v120, v120
  v_exp_f32 v121, v121
  v_exp_f32 v122, v122
  v_exp_f32 v123, v123
  v_mfma_f32_32x32x16_bf16 v[80:95], v[176:179], v[144:147], v[80:95]
  v_exp_f32 v124, v124
  v_exp_f32 v125, v125
  v_exp_f32 v126, v126
  v_exp_f32 v127, v127
  v_cvt_pk_bf16_f32 v148, v120, v121
  v_cvt_pk_bf16_f32 v149, v122, v123
  v_cvt_pk_bf16_f32 v150, v124, v125
  v_cvt_pk_bf16_f32 v151, v126, v127
  s_waitcnt vmcnt(8)
  v_mfma_f32_32x32x16_bf16 v[112:127], v[184:187], v[16:19], 0
  v_exp_f32 v128, v128
  v_exp_f32 v129, v129
  v_exp_f32 v130, v130
  v_exp_f32 v131, v131
  v_mfma_f32_32x32x16_bf16 v[80:95], v[180:183], v[148:151], v[80:95]
  v_exp_f32 v132, v132
  v_exp_f32 v133, v133
  v_exp_f32 v134, v134
  v_exp_f32 v135, v135
  v_cvt_pk_bf16_f32 v144, v128, v129
  v_cvt_pk_bf16_f32 v145, v130, v131
  v_cvt_pk_bf16_f32 v146, v132, v133
  v_cvt_pk_bf16_f32 v147, v134, v135
  v_mfma_f32_32x32x16_bf16 v[112:127], v[188:191], v[20:23], v[112:127]
  v_exp_f32 v136, v136
  v_exp_f32 v137, v137
  v_exp_f32 v138, v138
  v_exp_f32 v139, v139
  v_mfma_f32_32x32x16_bf16 v[96:111], v[176:179], v[144:147], v[96:111]
  v_exp_f32 v140, v140
  v_exp_f32 v141, v141
  v_exp_f32 v142, v142
  v_exp_f32 v143, v143
  v_cvt_pk_bf16_f32 v148, v136, v137
  v_cvt_pk_bf16_f32 v149, v138, v139
  v_cvt_pk_bf16_f32 v150, v140, v141
  v_cvt_pk_bf16_f32 v151, v142, v143
  v_mfma_f32_32x32x16_bf16 v[128:143], v[184:187], v[24:27], 0
  v_exp_f32 v112, v112
  v_exp_f32 v113, v113
  v_exp_f32 v114, v114
  v_exp_f32 v115, v115
  v_mfma_f32_32x32x16_bf16 v[96:111], v[180:183], v[148:151], v[96:111]
  global_load_dwordx4 v[168:171], v4, s[28:29] offset:0
  global_load_dwordx4 v[172:175], v4, s[28:29] offset:1024
  global_load_dwordx4 v[176:179], v3, s[30:31] offset:0
  global_load_dwordx4 v[180:183], v3, s[30:31] offset:1024
  s_add_u32 s28, s28, 2048
  s_addc_u32 s29, s29, 0
  s_add_u32 s30, s30, 2048
  s_addc_u32 s31, s31, 0
  v_exp_f32 v116, v116
  v_exp_f32 v117, v117
  v_exp_f32 v118, v118
  v_exp_f32 v119, v119
  v_cvt_pk_bf16_f32 v144, v112, v113
  v_cvt_pk_bf16_f32 v145, v114, v115
  v_cvt_pk_bf16_f32 v146, v116, v117
  v_cvt_pk_bf16_f32 v147, v118, v119
  v_mfma_f32_32x32x16_bf16 v[128:143], v[188:191], v[28:31], v[128:143]
  v_exp_f32 v120, v120
  v_exp_f32 v121, v121
  v_exp_f32 v122, v122
  v_exp_f32 v123, v123
  v_mfma_f32_32x32x16_bf16 v[48:63], v[192:195], v[144:147], v[48:63]
  v_exp_f32 v124, v124
  v_exp_f32 v125, v125
  v_exp_f32 v126, v126
  v_exp_f32 v127, v127
  v_cvt_pk_bf16_f32 v148, v120, v121
  v_cvt_pk_bf16_f32 v149, v122, v123
  v_cvt_pk_bf16_f32 v150, v124, v125
  v_cvt_pk_bf16_f32 v151, v126, v127
  v_mfma_f32_32x32x16_bf16 v[112:127], v[184:187], v[32:35], 0
  v_exp_f32 v128, v128
  v_exp_f32 v129, v129
  v_exp_f32 v130, v130
  v_exp_f32 v131, v131
  v_mfma_f32_32x32x16_bf16 v[48:63], v[196:199], v[148:151], v[48:63]
  v_exp_f32 v132, v132
  v_exp_f32 v133, v133
  v_exp_f32 v134, v134
  v_exp_f32 v135, v135
  v_cvt_pk_bf16_f32 v144, v128, v129
  v_cvt_pk_bf16_f32 v145, v130, v131
  v_cvt_pk_bf16_f32 v146, v132, v133
  v_cvt_pk_bf16_f32 v147, v134, v135
  v_mfma_f32_32x32x16_bf16 v[112:127], v[188:191], v[36:39], v[112:127]
  v_exp_f32 v136, v136
  v_exp_f32 v137, v137
  v_exp_f32 v138, v138
  v_exp_f32 v139, v139
  v_mfma_f32_32x32x16_bf16 v[64:79], v[192:195], v[144:147], v[64:79]
  v_exp_f32 v140, v140
  v_exp_f32 v141, v141
  v_exp_f32 v142, v142
  v_exp_f32 v143, v143
  v_cvt_pk_bf16_f32 v148, v136, v137
  v_cvt_pk_bf16_f32 v149, v138, v139
  v_cvt_pk_bf16_f32 v150, v140, v141
  v_cvt_pk_bf16_f32 v151, v142, v143
  v_mfma_f32_32x32x16_bf16 v[128:143], v[184:187], v[40:43], 0
  v_exp_f32 v112, v112
  v_exp_f32 v113, v113
  v_exp_f32 v114, v114
  v_exp_f32 v115, v115
  v_mfma_f32_32x32x16_bf16 v[64:79], v[196:199], v[148:151], v[64:79]
  v_exp_f32 v116, v116
  v_exp_f32 v117, v117
  v_exp_f32 v118, v118
  v_exp_f32 v119, v119
  v_cvt_pk_bf16_f32 v144, v112, v113
  v_cvt_pk_bf16_f32 v145, v114, v115
  v_cvt_pk_bf16_f32 v146, v116, v117
  v_cvt_pk_bf16_f32 v147, v118, v119
  v_mfma_f32_32x32x16_bf16 v[128:143], v[188:191], v[44:47], v[128:143]
  v_exp_f32 v120, v120
  v_exp_f32 v121, v121
  v_exp_f32 v122, v122
  v_exp_f32 v123, v123
  v_mfma_f32_32x32x16_bf16 v[80:95], v[192:195], v[144:147], v[80:95]
  v_exp_f32 v124, v124
  v_exp_f32 v125, v125
  v_exp_f32 v126, v126
  v_exp_f32 v127, v127
  v_cvt_pk_bf16_f32 v148, v120, v121
  v_cvt_pk_bf16_f32 v149, v122, v123
  v_cvt_pk_bf16_f32 v150, v124, v125
  v_cvt_pk_bf16_f32 v151, v126, v127
  s_waitcnt vmcnt(8)
  v_mfma_f32_32x32x16_bf16 v[112:127], v[200:203], v[16:19], 0
  v_exp_f32 v128, v128
  v_exp_f32 v129, v129
  v_exp_f32 v130, v130
  v_exp_f32 v131, v131
  v_mfma_f32_32x32x16_bf16 v[80:95], v[196:199], v[148:151], v[80:95]
  v_exp_f32 v132, v132
  v_exp_f32 v133, v133
  v_exp_f32 v134, v134
  v_exp_f32 v135, v135
  v_cvt_pk_bf16_f32 v144, v128, v129
  v_cvt_pk_bf16_f32 v145, v130, v131
  v_cvt_pk_bf16_f32 v146, v132, v133
  v_cvt_pk_bf16_f32 v147, v134, v135
  v_mfma_f32_32x32x16_bf16 v[112:127], v[204:207], v[20:23], v[112:127]
  v_exp_f32 v136, v136
  v_exp_f32 v137, v137
  v_exp_f32 v138, v138
  v_exp_f32 v139, v139
  v_mfma_f32_32x32x16_bf16 v[96:111], v[192:195], v[144:147], v[96:111]
  v_exp_f32 v140, v140
  v_exp_f32 v141, v141
  v_exp_f32 v142, v142
  v_exp_f32 v143, v143
  v_cvt_pk_bf16_f32 v148, v136, v137
  v_cvt_pk_bf16_f32 v149, v138, v139
  v_cvt_pk_bf16_f32 v150, v140, v141
  v_cvt_pk_bf16_f32 v151, v142, v143
  v_mfma_f32_32x32x16_bf16 v[128:143], v[200:203], v[24:27], 0
  v_exp_f32 v112, v112
  v_exp_f32 v113, v113
  v_exp_f32 v114, v114
  v_exp_f32 v115, v115
  v_mfma_f32_32x32x16_bf16 v[96:111], v[196:199], v[148:151], v[96:111]
  global_load_dwordx4 v[184:187], v4, s[28:29] offset:0
  global_load_dwordx4 v[188:191], v4, s[28:29] offset:1024
  global_load_dwordx4 v[192:195], v3, s[30:31] offset:0
  global_load_dwordx4 v[196:199], v3, s[30:31] offset:1024
  s_add_u32 s28, s28, 2048
  s_addc_u32 s29, s29, 0
  s_add_u32 s30, s30, 2048
  s_addc_u32 s31, s31, 0
  v_exp_f32 v116, v116
  v_exp_f32 v117, v117
  v_exp_f32 v118, v118
  v_exp_f32 v119, v119
  v_cvt_pk_bf16_f32 v144, v112, v113
  v_cvt_pk_bf16_f32 v145, v114, v115
  v_cvt_pk_bf16_f32 v146, v116, v117
  v_cvt_pk_bf16_f32 v147, v118, v119
  v_mfma_f32_32x32x16_bf16 v[128:143], v[204:207], v[28:31], v[128:143]
  v_exp_f32 v120, v120
  v_exp_f32 v121, v121
  v_exp_f32 v122, v122
  v_exp_f32 v123, v123
  v_mfma_f32_32x32x16_bf16 v[48:63], v[208:211], v[144:147], v[48:63]
  v_exp_f32 v124, v124
  v_exp_f32 v125, v125
  v_exp_f32 v126, v126
  v_exp_f32 v127, v127
  v_cvt_pk_bf16_f32 v148, v120, v121
  v_cvt_pk_bf16_f32 v149, v122, v123
  v_cvt_pk_bf16_f32 v150, v124, v125
  v_cvt_pk_bf16_f32 v151, v126, v127
  v_mfma_f32_32x32x16_bf16 v[112:127], v[200:203], v[32:35], 0
  v_exp_f32 v128, v128
  v_exp_f32 v129, v129
  v_exp_f32 v130, v130
  v_exp_f32 v131, v131
  v_mfma_f32_32x32x16_bf16 v[48:63], v[212:215], v[148:151], v[48:63]
  v_exp_f32 v132, v132
  v_exp_f32 v133, v133
  v_exp_f32 v134, v134
  v_exp_f32 v135, v135
  v_cvt_pk_bf16_f32 v144, v128, v129
  v_cvt_pk_bf16_f32 v145, v130, v131
  v_cvt_pk_bf16_f32 v146, v132, v133
  v_cvt_pk_bf16_f32 v147, v134, v135
  v_mfma_f32_32x32x16_bf16 v[112:127], v[204:207], v[36:39], v[112:127]
  v_exp_f32 v136, v136
  v_exp_f32 v137, v137
  v_exp_f32 v138, v138
  v_exp_f32 v139, v139
  v_mfma_f32_32x32x16_bf16 v[64:79], v[208:211], v[144:147], v[64:79]
  v_exp_f32 v140, v140
  v_exp_f32 v141, v141
  v_exp_f32 v142, v142
  v_exp_f32 v143, v143
  v_cvt_pk_bf16_f32 v148, v136, v137
  v_cvt_pk_bf16_f32 v149, v138, v139
  v_cvt_pk_bf16_f32 v150, v140, v141
  v_cvt_pk_bf16_f32 v151, v142, v143
  v_mfma_f32_32x32x16_bf16 v[128:143], v[200:203], v[40:43], 0
  v_exp_f32 v112, v112
  v_exp_f32 v113, v113
  v_exp_f32 v114, v114
  v_exp_f32 v115, v115
  v_mfma_f32_32x32x16_bf16 v[64:79], v[212:215], v[148:151], v[64:79]
  v_exp_f32 v116, v116
  v_exp_f32 v117, v117
  v_exp_f32 v118, v118
  v_exp_f32 v119, v119
  v_cvt_pk_bf16_f32 v144, v112, v113
  v_cvt_pk_bf16_f32 v145, v114, v115
  v_cvt_pk_bf16_f32 v146, v116, v117
  v_cvt_pk_bf16_f32 v147, v118, v119
  v_mfma_f32_32x32x16_bf16 v[128:143], v[204:207], v[44:47], v[128:143]
  v_exp_f32 v120, v120
  v_exp_f32 v121, v121
  v_exp_f32 v122, v122
  v_exp_f32 v123, v123
  v_mfma_f32_32x32x16_bf16 v[80:95], v[208:211], v[144:147], v[80:95]
  v_exp_f32 v124, v124
  v_exp_f32 v125, v125
  v_exp_f32 v126, v126
  v_exp_f32 v127, v127
  v_cvt_pk_bf16_f32 v148, v120, v121
  v_cvt_pk_bf16_f32 v149, v122, v123
  v_cvt_pk_bf16_f32 v150, v124, v125
  v_cvt_pk_bf16_f32 v151, v126, v127
  s_waitcnt vmcnt(8)
  v_mfma_f32_32x32x16_bf16 v[112:127], v[152:155], v[16:19], 0
  v_exp_f32 v128, v128
  v_exp_f32 v129, v129
  v_exp_f32 v130, v130
  v_exp_f32 v131, v131
  v_mfma_f32_32x32x16_bf16 v[80:95], v[212:215], v[148:151], v[80:95]
  v_exp_f32 v132, v132
  v_exp_f32 v133, v133
  v_exp_f32 v134, v134
  v_exp_f32 v135, v135
  v_cvt_pk_bf16_f32 v144, v128, v129
  v_cvt_pk_bf16_f32 v145, v130, v131
  v_cvt_pk_bf16_f32 v146, v132, v133
  v_cvt_pk_bf16_f32 v147, v134, v135
  v_mfma_f32_32x32x16_bf16 v[112:127], v[156:159], v[20:23], v[112:127]
  v_exp_f32 v136, v136
  v_exp_f32 v137, v137
  v_exp_f32 v138, v138
  v_exp_f32 v139, v139
  v_mfma_f32_32x32x16_bf16 v[96:111], v[208:211], v[144:147], v[96:111]
  v_exp_f32 v140, v140
  v_exp_f32 v141, v141
  v_exp_f32 v142, v142
  v_exp_f32 v143, v143
  v_cvt_pk_bf16_f32 v148, v136, v137
  v_cvt_pk_bf16_f32 v149, v138, v139
  v_cvt_pk_bf16_f32 v150, v140, v141
  v_cvt_pk_bf16_f32 v151, v142, v143
  s_sub_u32 s36, s36, 1
  s_cmp_lg_u32 s36, 0
  s_cbranch_scc1 k2_loop
  v_mfma_f32_32x32x16_bf16 v[128:143], v[152:155], v[24:27], 0
  v_exp_f32 v112, v112
  v_exp_f32 v113, v113
  v_exp_f32 v114, v114
  v_exp_f32 v115, v115
  v_mfma_f32_32x32x16_bf16 v[96:111], v[212:215], v[148:151], v[96:111]
  global_load_dwordx4 v[200:203], v4, s[28:29] offset:0
  global_load_dwordx4 v[204:207], v4, s[28:29] offset:1024
  global_load_dwordx4 v[208:211], v3, s[30:31] offset:0
  global_load_dwordx4 v[212:215], v3, s[30:31] offset:1024
  s_add_u32 s28, s28, 2048
  s_addc_u32 s29, s29, 0
  s_add_u32 s30, s30, 2048
  s_addc_u32 s31, s31, 0
  v_exp_f32 v116, v116
  v_exp_f32 v117, v117
  v_exp_f32 v118, v118
  v_exp_f32 v119, v119
  v_cvt_pk_bf16_f32 v144, v112, v113
  v_cvt_pk_bf16_f32 v145, v114, v115
  v_cvt_pk_bf16_f32 v146, v116, v117
  v_cvt_pk_bf16_f32 v147, v118, v119
  v_mfma_f32_32x32x16_bf16 v[128:143], v[156:159], v[28:31], v[128:143]
  v_exp_f32 v120, v120
  v_exp_f32 v121, v121
  v_exp_f32 v122, v122
  v_exp_f32 v123, v123
  v_mfma_f32_32x32x16_bf16 v[48:63], v[160:163], v[144:147], v[48:63]
  v_exp_f32 v124, v124
  v_exp_f32 v125, v125
  v_exp_f32 v126, v126
  v_exp_f32 v127, v127
  v_cvt_pk_bf16_f32 v148, v120, v121
  v_cvt_pk_bf16_f32 v149, v122, v123
  v_cvt_pk_bf16_f32 v150, v124, v125
  v_cvt_pk_bf16_f32 v151, v126, v127
  v_mfma_f32_32x32x16_bf16 v[112:127], v[152:155], v[32:35], 0
  v_exp_f32 v128, v128
  v_exp_f32 v129, v129
  v_exp_f32 v130, v130
  v_exp_f32 v131, v131
  v_mfma_f32_32x32x16_bf16 v[48:63], v[164:167], v[148:151], v[48:63]
  v_exp_f32 v132, v132
  v_exp_f32 v133, v133
  v_exp_f32 v134, v134
  v_exp_f32 v135, v135
  v_cvt_pk_bf16_f32 v144, v128, v129
  v_cvt_pk_bf16_f32 v145, v130, v131
  v_cvt_pk_bf16_f32 v146, v132, v133
  v_cvt_pk_bf16_f32 v147, v134, v135
  v_mfma_f32_32x32x16_bf16 v[112:127], v[156:159], v[36:39], v[112:127]
  v_exp_f32 v136, v136
  v_exp_f32 v137, v137
  v_exp_f32 v138, v138
  v_exp_f32 v139, v139
  v_mfma_f32_32x32x16_bf16 v[64:79], v[160:163], v[144:147], v[64:79]
  v_exp_f32 v140, v140
  v_exp_f32 v141, v141
  v_exp_f32 v142, v142
  v_exp_f32 v143, v143
  v_cvt_pk_bf16_f32 v148, v136, v137
  v_cvt_pk_bf16_f32 v149, v138, v139
  v_cvt_pk_bf16_f32 v150, v140, v141
  v_cvt_pk_bf16_f32 v151, v142, v143
  v_mfma_f32_32x32x16_bf16 v[128:143], v[152:155], v[40:43], 0
  v_exp_f32 v112, v112
  v_exp_f32 v113, v113
  v_exp_f32 v114, v114
  v_exp_f32 v115, v115
  v_mfma_f32_32x32x16_bf16 v[64:79], v[164:167], v[148:151], v[64:79]
  v_exp_f32 v116, v116
  v_exp_f32 v117, v117
  v_exp_f32 v118, v118
  v_exp_f32 v119, v119
  v_cvt_pk_bf16_f32 v144, v112, v113
  v_cvt_pk_bf16_f32 v145, v114, v115
  v_cvt_pk_bf16_f32 v146, v116, v117
  v_cvt_pk_bf16_f32 v147, v118, v119
  v_mfma_f32_32x32x16_bf16 v[128:143], v[156:159], v[44:47], v[128:143]
  v_exp_f32 v120, v120
  v_exp_f32 v121, v121
  v_exp_f32 v122, v122
  v_exp_f32 v123, v123
  v_mfma_f32_32x32x16_bf16 v[80:95], v[160:163], v[144:147], v[80:95]
  v_exp_f32 v124, v124
  v_exp_f32 v125, v125
  v_exp_f32 v126, v126
  v_exp_f32 v127, v127
  v_cvt_pk_bf16_f32 v148, v120, v121
  v_cvt_pk_bf16_f32 v149, v122, v123
  v_cvt_pk_bf16_f32 v150, v124, v125
  v_cvt_pk_bf16_f32 v151, v126, v127
  s_waitcnt vmcnt(8)
  v_mfma_f32_32x32x16_bf16 v[112:127], v[168:171], v[16:19], 0
  v_exp_f32 v128, v128
  v_exp_f32 v129, v129
  v_exp_f32 v130, v130
  v_exp_f32 v131, v131
  v_mfma_f32_32x32x16_bf16 v[80:95], v[164:167], v[148:151], v[80:95]
  v_exp_f32 v132, v132
  v_exp_f32 v133, v133
  v_exp_f32 v134, v134
  v_exp_f32 v135, v135
  v_cvt_pk_bf16_f32 v144, v128, v129
  v_cvt_pk_bf16_f32 v145, v130, v131
  v_cvt_pk_bf16_f32 v146, v132, v133
  v_cvt_pk_bf16_f32 v147, v134, v135
  v_mfma_f32_32x32x16_bf16 v[112:127], v[172:175], v[20:23], v[112:127]
  v_exp_f32 v136, v136
  v_exp_f32 v137, v137
  v_exp_f32 v138, v138
  v_exp_f32 v139, v139
  v_mfma_f32_32x32x16_bf16 v[96:111], v[160:163], v[144:147], v[96:111]
  v_exp_f32 v140, v140
  v_exp_f32 v141, v141
  v_exp_f32 v142, v142
  v_exp_f32 v143, v143
  v_cvt_pk_bf16_f32 v148, v136, v137
  v_cvt_pk_bf16_f32 v149, v138, v139
  v_cvt_pk_bf16_f32 v150, v140, v141
  v_cvt_pk_bf16_f32 v151, v142, v143
  v_mfma_f32_32x32x16_bf16 v[128:143], v[168:171], v[24:27], 0
  v_exp_f32 v112, v112
  v_exp_f32 v113, v113
  v_exp_f32 v114, v114
  v_exp_f32 v115, v115
  v_mfma_f32_32x32x16_bf16 v[96:111], v[164:167], v[148:151], v[96:111]
  v_exp_f32 v116, v116
  v_exp_f32 v117, v117
  v_exp_f32 v118, v118
  v_exp_f32 v119, v119
  v_cvt_pk_bf16_f32 v144, v112, v113
  v_cvt_pk_bf16_f32 v145, v114, v115
  v_cvt_pk_bf16_f32 v146, v116, v117
  v_cvt_pk_bf16_f32 v147, v118, v119
  v_mfma_f32_32x32x16_bf16 v[128:143], v[172:175], v[28:31], v[128:143]
  v_exp_f32 v120, v120
  v_exp_f32 v121, v121
  v_exp_f32 v122, v122
  v_exp_f32 v123, v123
  v_mfma_f32_32x32x16_bf16 v[48:63], v[176:179], v[144:147], v[48:63]
  v_exp_f32 v124, v124
  v_exp_f32 v125, v125
  v_exp_f32 v126, v126
  v_exp_f32 v127, v127
  v_cvt_pk_bf16_f32 v148, v120, v121
  v_cvt_pk_bf16_f32 v149, v122, v123
  v_cvt_pk_bf16_f32 v150, v124, v125
  v_cvt_pk_bf16_f32 v151, v126, v127
  v_mfma_f32_32x32x16_bf16 v[112:127], v[168:171], v[32:35], 0
  v_exp_f32 v128, v128
  v_exp_f32 v129, v129
  v_exp_f32 v130, v130
  v_exp_f32 v131, v131
  v_mfma_f32_32x32x16_bf16 v[48:63], v[180:183], v[148:151], v[48:63]
  v_exp_f32 v132, v132
  v_exp_f32 v133, v133
  v_exp_f32 v134, v134
  v_exp_f32 v135, v135
  v_cvt_pk_bf16_f32 v144, v128, v129
  v_cvt_pk_bf16_f32 v145, v130, v131
  v_cvt_pk_bf16_f32 v146, v132, v133
  v_cvt_pk_bf16_f32 v147, v134, v135
  v_mfma_f32_32x32x16_bf16 v[112:127], v[172:175], v[36:39], v[112:127]
  v_exp_f32 v136, v136
  v_exp_f32 v137, v137
  v_exp_f32 v138, v138
  v_exp_f32 v139, v139
  v_mfma_f32_32x32x16_bf16 v[64:79], v[176:179], v[144:147], v[64:79]
  v_exp_f32 v140, v140
  v_exp_f32 v141, v141
  v_exp_f32 v142, v142
  v_exp_f32 v143, v143
  v_cvt_pk_bf16_f32 v148, v136, v137
  v_cvt_pk_bf16_f32 v149, v138, v139
  v_cvt_pk_bf16_f32 v150, v140, v141
  v_cvt_pk_bf16_f32 v151, v142, v143
  v_mfma_f32_32x32x16_bf16 v[128:143], v[168:171], v[40:43], 0
  v_exp_f32 v112, v112
  v_exp_f32 v113, v113
  v_exp_f32 v114, v114
  v_exp_f32 v115, v115
  v_mfma_f32_32x32x16_bf16 v[64:79], v[180:183], v[148:151], v[64:79]
  v_exp_f32 v116, v116
  v_exp_f32 v117, v117
  v_exp_f32 v118, v118
  v_exp_f32 v119, v119
  v_cvt_pk_bf16_f32 v144, v112, v113
  v_cvt_pk_bf16_f32 v145, v114, v115
  v_cvt_pk_bf16_f32 v146, v116, v117
  v_cvt_pk_bf16_f32 v147, v118, v119
  v_mfma_f32_32x32x16_bf16 v[128:143], v[172:175], v[44:47], v[128:143]
  v_exp_f32 v120, v120
  v_exp_f32 v121, v121
  v_exp_f32 v122, v122
  v_exp_f32 v123, v123
  v_mfma_f32_32x32x16_bf16 v[80:95], v[176:179], v[144:147], v[80:95]
  v_exp_f32 v124, v124
  v_exp_f32 v125, v125
  v_exp_f32 v126, v126
  v_exp_f32 v127, v127
  v_cvt_pk_bf16_f32 v148, v120, v121
  v_cvt_pk_bf16_f32 v149, v122, v123
  v_cvt_pk_bf16_f32 v150, v124, v125
  v_cvt_pk_bf16_f32 v151, v126, v127
  s_waitcnt vmcnt(4)
  v_mfma_f32_32x32x16_bf16 v[112:127], v[184:187], v[16:19], 0
  v_exp_f32 v128, v128
  v_exp_f32 v129, v129
  v_exp_f32 v130, v130
  v_exp_f32 v131, v131
  v_mfma_f32_32x32x16_bf16 v[80:95], v[180:183], v[148:151], v[80:95]
  v_exp_f32 v132, v132
  v_exp_f32 v133, v133
  v_exp_f32 v134, v134
  v_exp_f32 v135, v135
  v_cvt_pk_bf16_f32 v144, v128, v129
  v_cvt_pk_bf16_f32 v145, v130, v131
  v_cvt_pk_bf16_f32 v146, v132, v133
  v_cvt_pk_bf16_f32 v147, v134, v135
  v_mfma_f32_32x32x16_bf16 v[112:127], v[188:191], v[20:23], v[112:127]
  v_exp_f32 v136, v136
  v_exp_f32 v137, v137
  v_exp_f32 v138, v138
  v_exp_f32 v139, v139
  v_mfma_f32_32x32x16_bf16 v[96:111], v[176:179], v[144:147], v[96:111]
  v_exp_f32 v140, v140
  v_exp_f32 v141, v141
  v_exp_f32 v142, v142
  v_exp_f32 v143, v143
  v_cvt_pk_bf16_f32 v148, v136, v137
  v_cvt_pk_bf16_f32 v149, v138, v139
  v_cvt_pk_bf16_f32 v150, v140, v141
  v_cvt_pk_bf16_f32 v151, v142, v143
  v_mfma_f32_32x32x16_bf16 v[128:143], v[184:187], v[24:27], 0
  v_exp_f32 v112, v112
  v_exp_f32 v113, v113
  v_exp_f32 v114, v114
  v_exp_f32 v115, v115
  v_mfma_f32_32x32x16_bf16 v[96:111], v[180:183], v[148:151], v[96:111]
  v_exp_f32 v116, v116
  v_exp_f32 v117, v117
  v_exp_f32 v118, v118
  v_exp_f32 v119, v119
  v_cvt_pk_bf16_f32 v144, v112, v113
  v_cvt_pk_bf16_f32 v145, v114, v115
  v_cvt_pk_bf16_f32 v146, v116, v117
  v_cvt_pk_bf16_f32 v147, v118, v119
  v_mfma_f32_32x32x16_bf16 v[128:143], v[188:191], v[28:31], v[128:143]
  v_exp_f32 v120, v120
  v_exp_f32 v121, v121
  v_exp_f32 v122, v122
  v_exp_f32 v123, v123
  v_mfma_f32_32x32x16_bf16 v[48:63], v[192:195], v[144:147], v[48:63]
  v_exp_f32 v124, v124
  v_exp_f32 v125, v125
  v_exp_f32 v126, v126
  v_exp_f32 v127, v127
  v_cvt_pk_bf16_f32 v148, v120, v121
  v_cvt_pk_bf16_f32 v149, v122, v123
  v_cvt_pk_bf16_f32 v150, v124, v125
  v_cvt_pk_bf16_f32 v151, v126, v127
  v_mfma_f32_32x32x16_bf16 v[112:127], v[184:187], v[32:35], 0
  v_exp_f32 v128, v128
  v_exp_f32 v129, v129
  v_exp_f32 v130, v130
  v_exp_f32 v131, v131
  v_mfma_f32_32x32x16_bf16 v[48:63], v[196:199], v[148:151], v[48:63]
  v_exp_f32 v132, v132
  v_exp_f32 v133, v133
  v_exp_f32 v134, v134
  v_exp_f32 v135, v135
  v_cvt_pk_bf16_f32 v144, v128, v129
  v_cvt_pk_bf16_f32 v145, v130, v131
  v_cvt_pk_bf16_f32 v146, v132, v133
  v_cvt_pk_bf16_f32 v147, v134, v135
  v_mfma_f32_32x32x16_bf16 v[112:127], v[188:191], v[36:39], v[112:127]
  v_exp_f32 v136, v136
  v_exp_f32 v137, v137
  v_exp_f32 v138, v138
  v_exp_f32 v139, v139
  v_mfma_f32_32x32x16_bf16 v[64:79], v[192:195], v[144:147], v[64:79]
  v_exp_f32 v140, v140
  v_exp_f32 v141, v141
  v_exp_f32 v142, v142
  v_exp_f32 v143, v143
  v_cvt_pk_bf16_f32 v148, v136, v137
  v_cvt_pk_bf16_f32 v149, v138, v139
  v_cvt_pk_bf16_f32 v150, v140, v141
  v_cvt_pk_bf16_f32 v151, v142, v143
  v_mfma_f32_32x32x16_bf16 v[128:143], v[184:187], v[40:43], 0
  v_exp_f32 v112, v112
  v_exp_f32 v113, v113
  v_exp_f32 v114, v114
  v_exp_f32 v115, v115
  v_mfma_f32_32x32x16_bf16 v[64:79], v[196:199], v[148:151], v[64:79]
  v_exp_f32 v116, v116
  v_exp_f32 v117, v117
  v_exp_f32 v118, v118
  v_exp_f32 v119, v119
  v_cvt_pk_bf16_f32 v144, v112, v113
  v_cvt_pk_bf16_f32 v145, v114, v115
  v_cvt_pk_bf16_f32 v146, v116, v117
  v_cvt_pk_bf16_f32 v147, v118, v119
  v_mfma_f32_32x32x16_bf16 v[128:143], v[188:191], v[44:47], v[128:143]
  v_exp_f32 v120, v120
  v_exp_f32 v121, v121
  v_exp_f32 v122, v122
  v_exp_f32 v123, v123
  v_mfma_f32_32x32x16_bf16 v[80:95], v[192:195], v[144:147], v[80:95]
  v_exp_f32 v124, v124
  v_exp_f32 v125, v125
  v_exp_f32 v126, v126
  v_exp_f32 v127, v127
  v_cvt_pk_bf16_f32 v148, v120, v121
  v_cvt_pk_bf16_f32 v149, v122, v123
  v_cvt_pk_bf16_f32 v150, v124, v125
  v_cvt_pk_bf16_f32 v151, v126, v127
  s_waitcnt vmcnt(0)
  v_mfma_f32_32x32x16_bf16 v[112:127], v[200:203], v[16:19], 0
  v_exp_f32 v128, v128
  v_exp_f32 v129, v129
  v_exp_f32 v130, v130
  v_exp_f32 v131, v131
  v_mfma_f32_32x32x16_bf16 v[80:95], v[196:199], v[148:151], v[80:95]
  v_exp_f32 v132, v132
  v_exp_f32 v133, v133
  v_exp_f32 v134, v134
  v_exp_f32 v135, v135
  v_cvt_pk_bf16_f32 v144, v128, v129
  v_cvt_pk_bf16_f32 v145, v130, v131
  v_cvt_pk_bf16_f32 v146, v132, v133
  v_cvt_pk_bf16_f32 v147, v134, v135
  v_mfma_f32_32x32x16_bf16 v[112:127], v[204:207], v[20:23], v[112:127]
  v_exp_f32 v136, v136
  v_exp_f32 v137, v137
  v_exp_f32 v138, v138
  v_exp_f32 v139, v139
  v_mfma_f32_32x32x16_bf16 v[96:111], v[192:195], v[144:147], v[96:111]
  v_exp_f32 v140, v140
  v_exp_f32 v141, v141
  v_exp_f32 v142, v142
  v_exp_f32 v143, v143
  v_cvt_pk_bf16_f32 v148, v136, v137
  v_cvt_pk_bf16_f32 v149, v138, v139
  v_cvt_pk_bf16_f32 v150, v140, v141
  v_cvt_pk_bf16_f32 v151, v142, v143
  v_mfma_f32_32x32x16_bf16 v[128:143], v[200:203], v[24:27], 0
  v_exp_f32 v112, v112
  v_exp_f32 v113, v113
  v_exp_f32 v114, v114
  v_exp_f32 v115, v115
  v_mfma_f32_32x32x16_bf16 v[96:111], v[196:199], v[148:151], v[96:111]
  v_exp_f32 v116, v116
  v_exp_f32 v117, v117
  v_exp_f32 v118, v118
  v_exp_f32 v119, v119
  v_cvt_pk_bf16_f32 v144, v112, v113
  v_cvt_pk_bf16_f32 v145, v114, v115
  v_cvt_pk_bf16_f32 v146, v116, v117
  v_cvt_pk_bf16_f32 v147, v118, v119
  v_mfma_f32_32x32x16_bf16 v[128:143], v[204:207], v[28:31], v[128:143]
  v_exp_f32 v120, v120
  v_exp_f32 v121, v121
  v_exp_f32 v122, v122
  v_exp_f32 v123, v123
  v_mfma_f32_32x32x16_bf16 v[48:63], v[208:211], v[144:147], v[48:63]
  v_exp_f32 v124, v124
  v_exp_f32 v125, v125
  v_exp_f32 v126, v126
  v_exp_f32 v127, v127
  v_cvt_pk_bf16_f32 v148, v120, v121
  v_cvt_pk_bf16_f32 v149, v122, v123
  v_cvt_pk_bf16_f32 v150, v124, v125
  v_cvt_pk_bf16_f32 v151, v126, v127
  v_mfma_f32_32x32x16_bf16 v[112:127], v[200:203], v[32:35], 0
  v_exp_f32 v128, v128
  v_exp_f32 v129, v129
  v_exp_f32 v130, v130
  v_exp_f32 v131, v131
  v_mfma_f32_32x32x16_bf16 v[48:63], v[212:215], v[148:151], v[48:63]
  v_exp_f32 v132, v132
  v_exp_f32 v133, v133
  v_exp_f32 v134, v134
  v_exp_f32 v135, v135
  v_cvt_pk_bf16_f32 v144, v128, v129
  v_cvt_pk_bf16_f32 v145, v130, v131
  v_cvt_pk_bf16_f32 v146, v132, v133
  v_cvt_pk_bf16_f32 v147, v134, v135
  v_mfma_f32_32x32x16_bf16 v[112:127], v[204:207], v[36:39], v[112:127]
  v_exp_f32 v136, v136
  v_exp_f32 v137, v137
  v_exp_f32 v138, v138
  v_exp_f32 v139, v139
  v_mfma_f32_32x32x16_bf16 v[64:79], v[208:211], v[144:147], v[64:79]
  ds_write_b128 v5, v[48:51] offset:8192
  ds_write_b128 v5, v[52:55] offset:9216
  ds_write_b128 v5, v[56:59] offset:10240
  ds_write_b128 v5, v[60:63] offset:11264
  v_exp_f32 v140, v140
  v_exp_f32 v141, v141
  v_exp_f32 v142, v142
  v_exp_f32 v143, v143
  v_cvt_pk_bf16_f32 v148, v136, v137
  v_cvt_pk_bf16_f32 v149, v138, v139
  v_cvt_pk_bf16_f32 v150, v140, v141
  v_cvt_pk_bf16_f32 v151, v142, v143
  v_mfma_f32_32x32x16_bf16 v[128:143], v[200:203], v[40:43], 0
  v_exp_f32 v112, v112
  v_exp_f32 v113, v113
  v_exp_f32 v114, v114
  v_exp_f32 v115, v115
  v_mfma_f32_32x32x16_bf16 v[64:79], v[212:215], v[148:151], v[64:79]
  v_exp_f32 v116, v116
  v_exp_f32 v117, v117
  v_exp_f32 v118, v118
  v_exp_f32 v119, v119
  v_cvt_pk_bf16_f32 v144, v112, v113
  v_cvt_pk_bf16_f32 v145, v114, v115
  v_cvt_pk_bf16_f32 v146, v116, v117
  v_cvt_pk_bf16_f32 v147, v118, v119
  v_mfma_f32_32x32x16_bf16 v[128:143], v[204:207], v[44:47], v[128:143]
  v_exp_f32 v120, v120
  v_exp_f32 v121, v121
  v_exp_f32 v122, v122
  v_exp_f32 v123, v123
  v_mfma_f32_32x32x16_bf16 v[80:95], v[208:211], v[144:147], v[80:95]
  ds_write_b128 v6, v[64:67] offset:4096
  ds_write_b128 v6, v[68:71] offset:5120
  ds_write_b128 v6, v[72:75] offset:6144
  ds_write_b128 v6, v[76:79] offset:7168
  v_exp_f32 v124, v124
  v_exp_f32 v125, v125
  v_exp_f32 v126, v126
  v_exp_f32 v127, v127
  v_cvt_pk_bf16_f32 v148, v120, v121
  v_cvt_pk_bf16_f32 v149, v122, v123
  v_cvt_pk_bf16_f32 v150, v124, v125
  v_cvt_pk_bf16_f32 v151, v126, v127
  v_exp_f32 v128, v128
  v_exp_f32 v129, v129
  v_exp_f32 v130, v130
  v_exp_f32 v131, v131
  v_mfma_f32_32x32x16_bf16 v[80:95], v[212:215], v[148:151], v[80:95]
  v_exp_f32 v132, v132
  v_exp_f32 v133, v133
  v_exp_f32 v134, v134
  v_exp_f32 v135, v135
  v_cvt_pk_bf16_f32 v144, v128, v129
  v_cvt_pk_bf16_f32 v145, v130, v131
  v_cvt_pk_bf16_f32 v146, v132, v133
  v_cvt_pk_bf16_f32 v147, v134, v135
  v_exp_f32 v136, v136
  v_exp_f32 v137, v137
  v_exp_f32 v138, v138
  v_exp_f32 v139, v139
  v_mfma_f32_32x32x16_bf16 v[96:111], v[208:211], v[144:147], v[96:111]
  ds_write_b128 v7, v[80:83] offset:0
  ds_write_b128 v7, v[84:87] offset:1024
  ds_write_b128 v7, v[88:91] offset:2048
  ds_write_b128 v7, v[92:95] offset:3072
  v_exp_f32 v140, v140
  v_exp_f32 v141, v141
  v_exp_f32 v142, v142
  v_exp_f32 v143, v143
  v_cvt_pk_bf16_f32 v148, v136, v137
  v_cvt_pk_bf16_f32 v149, v138, v139
  v_cvt_pk_bf16_f32 v150, v140, v141
  v_cvt_pk_bf16_f32 v151, v142, v143
  s_nop 1
  v_mfma_f32_32x32x16_bf16 v[96:111], v[212:215], v[148:151], v[96:111]
  s_mul_i32 s33, s24, 12288
  v_add_u32 v5, s33, v3
  s_waitcnt lgkmcnt(0)
  s_barrier
  ds_read_b128 v[48:51], v5 offset:0
  ds_read_b128 v[52:55], v5 offset:1024
  ds_read_b128 v[56:59], v5 offset:2048
  ds_read_b128 v[60:63], v5 offset:3072
  ds_read_b128 v[64:67], v5 offset:4096
  ds_read_b128 v[68:71], v5 offset:5120
  ds_read_b128 v[72:75], v5 offset:6144
  ds_read_b128 v[76:79], v5 offset:7168
  ds_read_b128 v[80:83], v5 offset:8192
  ds_read_b128 v[84:87], v5 offset:9216
  ds_read_b128 v[88:91], v5 offset:10240
  ds_read_b128 v[92:95], v5 offset:11264
  s_waitcnt lgkmcnt(11)
  v_add_f32 v96, v96, v48
  v_add_f32 v97, v97, v49
  v_add_f32 v98, v98, v50
  v_add_f32 v99, v99, v51
  s_waitcnt lgkmcnt(10)
  v_add_f32 v100, v100, v52
  v_add_f32 v101, v101, v53
  v_add_f32 v102, v102, v54
  v_add_f32 v103, v103, v55
  s_waitcnt lgkmcnt(9)
  v_add_f32 v104, v104, v56
  v_add_f32 v105, v105, v57
  v_add_f32 v106, v106, v58
  v_add_f32 v107, v107, v59
  s_waitcnt lgkmcnt(8)
  v_add_f32 v108, v108, v60
  v_add_f32 v109, v109, v61
  v_add_f32 v110, v110, v62
  v_add_f32 v111, v111, v63
  s_waitcnt lgkmcnt(7)
  v_add_f32 v96, v96, v64
  v_add_f32 v97, v97, v65
  v_add_f32 v98, v98, v66
  v_add_f32 v99, v99, v67
  s_waitcnt lgkmcnt(6)
  v_add_f32 v100, v100, v68
  v_add_f32 v101, v101, v69
  v_add_f32 v102, v102, v70
  v_add_f32 v103, v103, v71
  s_waitcnt lgkmcnt(5)
  v_add_f32 v104, v104, v72
  v_add_f32 v105, v105, v73
  v_add_f32 v106, v106, v74
  v_add_f32 v107, v107, v75
  s_waitcnt lgkmcnt(4)
  v_add_f32 v108, v108, v76
  v_add_f32 v109, v109, v77
  v_add_f32 v110, v110, v78
  v_add_f32 v111, v111, v79
  s_waitcnt lgkmcnt(3)
  v_add_f32 v96, v96, v80
  v_add_f32 v97, v97, v81
  v_add_f32 v98, v98, v82
  v_add_f32 v99, v99, v83
  s_waitcnt lgkmcnt(2)
  v_add_f32 v100, v100, v84
  v_add_f32 v101, v101, v85
  v_add_f32 v102, v102, v86
  v_add_f32 v103, v103, v87
  s_waitcnt lgkmcnt(1)
  v_add_f32 v104, v104, v88
  v_add_f32 v105, v105, v89
  v_add_f32 v106, v106, v90
  v_add_f32 v107, v107, v91
  s_waitcnt lgkmcnt(0)
  v_add_f32 v108, v108, v92
  v_add_f32 v109, v109, v93
  v_add_f32 v110, v110, v94
  v_add_f32 v111, v111, v95
  v_mov_b32 v6, v108
  v_mov_b32 v7, v108
  s_nop 1
  v_permlane32_swap_b32 v6, v7
  v_max3_f32 v8, |v96|, |v97|, |v98|
  v_max3_f32 v8, v8, |v99|, |v100|
  v_max3_f32 v8, v8, |v101|, |v102|
  v_max3_f32 v8, v8, |v103|, |v104|
  v_max3_f32 v8, v8, |v105|, |v106|
  v_max3_f32 v8, v8, |v107|, |v108|
  v_max3_f32 v8, v8, |v109|, |v110|
  v_max_f32 v8, v8, |v111|
  s_mov_b32 s40, 0x7b800000
  s_mov_b32 s41, 0x30800000
  s_mov_b32 s42, 0x53800000
  v_cmp_gt_f32 s[44:45], s40, v8
  v_cmp_le_f32 s[46:47], s41, v7
  v_cmp_ge_f32 s[48:49], s42, v7
  v_add_f32 v9, v96, v97
  v_add_f32 v9, v9, v98
  v_add_f32 v9, v9, v99
  v_add_f32 v9, v9, v100
  v_add_f32 v9, v9, v101
  v_add_f32 v9, v9, v102
  v_add_f32 v9, v9, v103
  v_add_f32 v9, v9, v104
  v_add_f32 v9, v9, v105
  v_add_f32 v9, v9, v106
  v_add_f32 v9, v9, v107
  v_add_f32 v9, v9, v108
  v_add_f32 v9, v9, v109
  v_add_f32 v9, v9, v110
  v_add_f32 v9, v9, v111
  v_cmp_o_f32 s[50:51], v9, v9
  s_and_b64 s[44:45], s[44:45], s[46:47]
  s_and_b64 s[48:49], s[48:49], s[50:51]
  s_and_b64 s[44:45], s[44:45], s[48:49]
  s_cmp_eq_u64 s[44:45], -1
  s_cbranch_scc0 k2_slow
  v_rcp_f32 v7, v7
  s_lshl_b32 s33, s23, 3
  s_lshl_b32 s34, s24, 1
  s_add_u32 s33, s33, s34
  s_mul_i32 s33, s33, 14336
  s_add_u32 s33, s33, 11534336
  s_add_u32 s34, s18, s33
  s_addc_u32 s35, s19, 0
  v_bfe_u32 v8, v2, 4, 1
  v_mul_u32_u24 v8, 14336, v8
  v_and_b32 v9, 15, v2
  v_lshl_add_u32 v8, v9, 4, v8
  s_mul_i32 s33, s22, 7
  v_lshrrev_b32 v9, 5, v2
  v_add_u32 v9, s33, v9
  v_lshrrev_b32 v10, 1, v9
  v_lshl_add_u32 v8, v10, 8, v8
  v_and_b32 v9, 1, v9
  v_lshl_add_u32 v8, v9, 3, v8
  v_mul_f32 v96, v96, v7
  v_mul_f32 v97, v97, v7
  v_mul_f32 v98, v98, v7
  v_mul_f32 v99, v99, v7
  v_mul_f32 v100, v100, v7
  v_mul_f32 v101, v101, v7
  v_mul_f32 v102, v102, v7
  v_mul_f32 v103, v103, v7
  v_mul_f32 v104, v104, v7
  v_mul_f32 v105, v105, v7
  v_mul_f32 v106, v106, v7
  v_mul_f32 v107, v107, v7
  v_mul_f32 v108, v108, v7
  v_mul_f32 v109, v109, v7
  v_mul_f32 v110, v110, v7
  v_mul_f32 v111, v111, v7
  v_cvt_pk_bf16_f32 v96, v96, v97
  v_cvt_pk_bf16_f32 v97, v98, v99
  global_store_dwordx2 v8, v[96:97], s[34:35] offset:0
  v_cvt_pk_bf16_f32 v100, v100, v101
  v_cvt_pk_bf16_f32 v101, v102, v103
  global_store_dwordx2 v8, v[100:101], s[34:35] offset:256
  v_cvt_pk_bf16_f32 v104, v104, v105
  v_cvt_pk_bf16_f32 v105, v106, v107
  global_store_dwordx2 v8, v[104:105], s[34:35] offset:512
  v_cvt_pk_bf16_f32 v108, v108, v109
  v_cvt_pk_bf16_f32 v109, v110, v111
  s_mov_b32 exec_hi, 0
  global_store_dwordx2 v8, v[108:109], s[34:35] offset:768
  s_endpgm
k2_slow:
  s_waitcnt vmcnt(0)
  s_add_u32 s27, s25, 2097152
  s_add_u32 s26, s25, 4194304
  s_add_u32 s28, s18, s27
  s_addc_u32 s29, s19, 0
  s_add_u32 s30, s18, s26
  s_addc_u32 s31, s19, 0
  v_mov_b32 v10, 0xff800000
  s_mov_b32 s36, 64
k2_slow1:
  global_load_dwordx4 v[152:155], v4, s[28:29]
  global_load_dwordx4 v[156:159], v4, s[28:29] offset:1024
  s_add_u32 s28, s28, 2048
  s_addc_u32 s29, s29, 0
  s_waitcnt vmcnt(0)
  v_mfma_f32_32x32x16_bf16 v[112:127], v[152:155], v[40:43], 0
  v_mfma_f32_32x32x16_bf16 v[112:127], v[156:159], v[44:47], v[112:127]
  s_nop 15
  s_nop 3
  v_max3_f32 v10, v10, v112, v113
  v_max3_f32 v10, v10, v114, v115
  v_max3_f32 v10, v10, v116, v117
  v_max3_f32 v10, v10, v118, v119
  v_max3_f32 v10, v10, v120, v121
  v_max3_f32 v10, v10, v122, v123
  v_max3_f32 v10, v10, v124, v125
  v_max3_f32 v10, v10, v126, v127
  s_sub_u32 s36, s36, 1
  s_cmp_lg_u32 s36, 0
  s_cbranch_scc1 k2_slow1
  v_mov_b32 v11, v10
  v_mov_b32 v12, v10
  s_nop 1
  v_permlane32_swap_b32 v11, v12
  s_nop 1
  v_max_f32 v10, v11, v12
  s_add_u32 s28, s18, s27
  s_addc_u32 s29, s19, 0
  v_mov_b32 v96, 0
  v_mov_b32 v97, 0
  v_mov_b32 v98, 0
  v_mov_b32 v99, 0
  v_mov_b32 v100, 0
  v_mov_b32 v101, 0
  v_mov_b32 v102, 0
  v_mov_b32 v103, 0
  v_mov_b32 v104, 0
  v_mov_b32 v105, 0
  v_mov_b32 v106, 0
  v_mov_b32 v107, 0
  v_mov_b32 v108, 0
  v_mov_b32 v109, 0
  v_mov_b32 v110, 0
  v_mov_b32 v111, 0
  s_mov_b32 s36, 64
k2_slow2:
  global_load_dwordx4 v[152:155], v4, s[28:29] offset:0
  global_load_dwordx4 v[156:159], v4, s[28:29] offset:1024
  global_load_dwordx4 v[160:163], v3, s[30:31] offset:0
  global_load_dwordx4 v[164:167], v3, s[30:31] offset:1024
  s_add_u32 s28, s28, 2048
  s_addc_u32 s29, s29, 0
  s_add_u32 s30, s30, 2048
  s_addc_u32 s31, s31, 0
  s_waitcnt vmcnt(0)
  v_mfma_f32_32x32x16_bf16 v[112:127], v[152:155], v[40:43], 0
  v_mfma_f32_32x32x16_bf16 v[112:127], v[156:159], v[44:47], v[112:127]
  s_nop 15
  s_nop 3
  v_sub_f32 v112, v112, v10
  v_sub_f32 v113, v113, v10
  v_sub_f32 v114, v114, v10
  v_sub_f32 v115, v115, v10
  v_sub_f32 v116, v116, v10
  v_sub_f32 v117, v117, v10
  v_sub_f32 v118, v118, v10
  v_sub_f32 v119, v119, v10
  v_sub_f32 v120, v120, v10
  v_sub_f32 v121, v121, v10
  v_sub_f32 v122, v122, v10
  v_sub_f32 v123, v123, v10
  v_sub_f32 v124, v124, v10
  v_sub_f32 v125, v125, v10
  v_sub_f32 v126, v126, v10
  v_sub_f32 v127, v127, v10
  v_exp_f32 v112, v112
  v_exp_f32 v113, v113
  v_exp_f32 v114, v114
  v_exp_f32 v115, v115
  v_exp_f32 v116, v116
  v_exp_f32 v117, v117
  v_exp_f32 v118, v118
  v_exp_f32 v119, v119
  v_exp_f32 v120, v120
  v_exp_f32 v121, v121
  v_exp_f32 v122, v122
  v_exp_f32 v123, v123
  v_exp_f32 v124, v124
  v_exp_f32 v125, v125
  v_exp_f32 v126, v126
  v_exp_f32 v127, v127
  s_nop 0
  v_cvt_pk_bf16_f32 v144, v112, v113
  v_cvt_pk_bf16_f32 v145, v114, v115
  v_cvt_pk_bf16_f32 v146, v116, v117
  v_cvt_pk_bf16_f32 v147, v118, v119
  v_cvt_pk_bf16_f32 v148, v120, v121
  v_cvt_pk_bf16_f32 v149, v122, v123
  v_cvt_pk_bf16_f32 v150, v124, v125
  v_cvt_pk_bf16_f32 v151, v126, v127
  s_nop 1
  v_mfma_f32_32x32x16_bf16 v[96:111], v[160:163], v[144:147], v[96:111]
  v_mfma_f32_32x32x16_bf16 v[96:111], v[164:167], v[148:151], v[96:111]
  s_sub_u32 s36, s36, 1
  s_cmp_lg_u32 s36, 0
  s_cbranch_scc1 k2_slow2
  s_nop 15
  s_nop 3
  v_mov_b32 v6, v108
  v_mov_b32 v7, v108
  s_nop 1
  v_permlane32_swap_b32 v6, v7
  v_rcp_f32 v7, v7
  s_lshl_b32 s33, s23, 3
  s_lshl_b32 s34, s24, 1
  s_add_u32 s33, s33, s34
  s_mul_i32 s33, s33, 14336
  s_add_u32 s33, s33, 11534336
  s_add_u32 s34, s18, s33
  s_addc_u32 s35, s19, 0
  v_bfe_u32 v8, v2, 4, 1
  v_mul_u32_u24 v8, 14336, v8
  v_and_b32 v9, 15, v2
  v_lshl_add_u32 v8, v9, 4, v8
  s_mul_i32 s33, s22, 7
  v_lshrrev_b32 v9, 5, v2
  v_add_u32 v9, s33, v9
  v_lshrrev_b32 v10, 1, v9
  v_lshl_add_u32 v8, v10, 8, v8
  v_and_b32 v9, 1, v9
  v_lshl_add_u32 v8, v9, 3, v8
  v_mul_f32 v96, v96, v7
  v_mul_f32 v97, v97, v7
  v_mul_f32 v98, v98, v7
  v_mul_f32 v99, v99, v7
  v_mul_f32 v100, v100, v7
  v_mul_f32 v101, v101, v7
  v_mul_f32 v102, v102, v7
  v_mul_f32 v103, v103, v7
  v_mul_f32 v104, v104, v7
  v_mul_f32 v105, v105, v7
  v_mul_f32 v106, v106, v7
  v_mul_f32 v107, v107, v7
  v_mul_f32 v108, v108, v7
  v_mul_f32 v109, v109, v7
  v_mul_f32 v110, v110, v7
  v_mul_f32 v111, v111, v7
  v_cvt_pk_bf16_f32 v96, v96, v97
  v_cvt_pk_bf16_f32 v97, v98, v99
  global_store_dwordx2 v8, v[96:97], s[34:35] offset:0
  v_cvt_pk_bf16_f32 v100, v100, v101
  v_cvt_pk_bf16_f32 v101, v102, v103
  global_store_dwordx2 v8, v[100:101], s[34:35] offset:256
  v_cvt_pk_bf16_f32 v104, v104, v105
  v_cvt_pk_bf16_f32 v105, v106, v107
  global_store_dwordx2 v8, v[104:105], s[34:35] offset:512
  v_cvt_pk_bf16_f32 v108, v108, v109
  v_cvt_pk_bf16_f32 v109, v110, v111
  s_mov_b32 exec_hi, 0
  global_store_dwordx2 v8, v[108:109], s[34:35] offset:768
  s_endpgm
k2_fft:
  s_sub_u32 s24, s24, 4
  v_and_b32 v4, 15, v2
  v_lshrrev_b32 v5, 4, v2
  s_and_b32 s25, s2, 7
  s_mul_i32 s25, s25, 29
  s_lshr_b32 s26, s2, 3
  s_add_u32 s25, s25, s26
  s_cmp_ge_u32 s26, 29
  s_cbranch_scc1 k2_prefetch
  s_cmp_ge_u32 s25, 225
  s_cbranch_scc1 k2_prefetch
  s_setprio 3
  s_getpc_b64 s[26:27]
  s_add_u32 s26, s26, tab_B64@rel32@lo+4
  s_addc_u32 s27, s27, tab_B64@rel32@hi+12
  s_getpc_b64 s[28:29]
  s_add_u32 s28, s28, tab_A32@rel32@lo+4
  s_addc_u32 s29, s29, tab_A32@rel32@hi+12
  s_getpc_b64 s[30:31]
  s_add_u32 s30, s30, tab_TW@rel32@lo+4
  s_addc_u32 s31, s31, tab_TW@rel32@hi+12
  s_mul_i32 s32, s24, 6144
  s_add_u32 s26, s26, s32
  s_addc_u32 s27, s27, 0
  s_lshl_b32 s32, s24, 12
  s_add_u32 s30, s30, s32
  s_addc_u32 s31, s31, 0
  s_lshl_b32 s32, s25, 12
  s_add_u32 s33, s32, 6291456
  s_add_u32 s38, s32, 13631488
  s_waitcnt lgkmcnt(0)
  s_add_u32 s34, s18, s33
  s_addc_u32 s35, s19, 0
  s_add_u32 s36, s34, 917504
  s_addc_u32 s37, s35, 0
  s_add_u32 s40, s18, s38
  s_addc_u32 s41, s19, 0
  s_add_u32 s42, s40, 917504
  s_addc_u32 s43, s41, 0
  global_load_dwordx4 v[16:19], v3, s[34:35] offset:0
  global_load_dwordx4 v[20:23], v3, s[34:35] offset:1024
  global_load_dwordx4 v[24:27], v3, s[34:35] offset:2048
  global_load_dwordx4 v[28:31], v3, s[34:35] offset:3072
  s_mov_b32 s44, 1
  s_cmp_eq_u32 s25, 0
  s_cmov_b32 s44, 0
  s_cmp_eq_u32 s25, 224
  s_cmov_b32 s44, 0
  v_mov_b32 v32, 0
  v_mov_b32 v33, 0
  v_mov_b32 v34, 0
  v_mov_b32 v35, 0
  v_mov_b32 v36, 0
  v_mov_b32 v37, 0
  v_mov_b32 v38, 0
  v_mov_b32 v39, 0
  v_mov_b32 v40, 0
  v_mov_b32 v41, 0
  v_mov_b32 v42, 0
  v_mov_b32 v43, 0
  v_mov_b32 v44, 0
  v_mov_b32 v45, 0
  v_mov_b32 v46, 0
  v_mov_b32 v47, 0
  s_cmp_eq_u32 s44, 0
  s_cbranch_scc1 k2_fft_noim
  global_load_dwordx4 v[32:35], v3, s[36:37] offset:0
  global_load_dwordx4 v[36:39], v3, s[36:37] offset:1024
  global_load_dwordx4 v[40:43], v3, s[36:37] offset:2048
  global_load_dwordx4 v[44:47], v3, s[36:37] offset:3072
k2_fft_noim:
  v_add_u32 v6, 4096, v3
  global_load_dwordx4 v[48:51], v3, s[26:27] offset:0
  global_load_dwordx4 v[52:55], v3, s[26:27] offset:1024
  global_load_dwordx4 v[56:59], v3, s[26:27] offset:2048
  global_load_dwordx4 v[60:63], v3, s[26:27] offset:3072
  global_load_dwordx4 v[64:67], v6, s[26:27] offset:0
  global_load_dwordx4 v[68:71], v6, s[26:27] offset:1024
  global_load_dwordx4 v[88:91], v3, s[30:31] offset:0
  global_load_dwordx4 v[96:99], v3, s[30:31] offset:1024
  global_load_dwordx4 v[92:95], v3, s[30:31] offset:2048
  global_load_dwordx4 v[100:103], v3, s[30:31] offset:3072
  global_load_dwordx4 v[72:75], v3, s[28:29] offset:0
  global_load_dwordx4 v[76:79], v3, s[28:29] offset:1024
  global_load_dwordx4 v[80:83], v3, s[28:29] offset:2048
  global_load_dwordx4 v[84:87], v3, s[28:29] offset:3072
  s_lshl_b32 s32, s25, 13
  s_lshl_b32 s33, s24, 8
  s_add_u32 s32, s32, s33
  s_add_u32 s32, s32, 8388608
  s_add_u32 s46, s18, s32
  s_addc_u32 s47, s19, 0
  v_lshlrev_b32 v7, 10, v5
  v_lshl_add_u32 v7, v4, 4, v7
  v_add_u32 v8, 4096, v7
  global_load_dwordx4 v[104:107], v7, s[46:47]
  global_load_dwordx4 v[108:111], v8, s[46:47]
  s_lshl_b32 s32, s24, 10
  s_add_u32 s32, s32, 49152
  v_lshlrev_b32 v9, 6, v4
  v_lshl_add_u32 v9, v5, 3, v9
  v_add_u32 v9, s32, v9
  v_lshrrev_b32 v10, 3, v4
  v_lshl_add_u32 v9, v10, 5, v9
  v_xor_b32 v10, 32, v9
  v_lshrrev_b32 v11, 2, v4
  v_lshl_add_u32 v11, v5, 3, v11
  v_lshlrev_b32 v11, 6, v11
  v_and_b32 v12, 3, v4
  v_lshl_add_u32 v11, v12, 3, v11
  v_and_b32 v12, 1, v5
  v_lshl_add_u32 v11, v12, 5, v11
  v_add_u32 v11, 49152, v11
  v_xor_b32 v12, 32, v11
  s_lshl_b32 s32, s24, 10
  v_lshlrev_b32 v13, 6, v4
  v_lshl_add_u32 v13, v5, 3, v13
  v_add_u32 v13, s32, v13
  s_waitcnt vmcnt(10)
  v_mfma_f32_16x16x32_bf16 v[112:115], v[16:19], v[48:51], 0
  v_mfma_f32_16x16x32_bf16 v[120:123], v[32:35], v[48:51], 0
  v_mfma_f32_16x16x32_bf16 v[116:119], v[24:27], v[48:51], 0
  v_mfma_f32_16x16x32_bf16 v[124:127], v[40:43], v[48:51], 0
  v_mfma_f32_16x16x32_bf16 v[112:115], v[20:23], v[52:55], v[112:115]
  v_mfma_f32_16x16x32_bf16 v[120:123], v[36:39], v[52:55], v[120:123]
  v_mfma_f32_16x16x32_bf16 v[116:119], v[28:31], v[52:55], v[116:119]
  v_mfma_f32_16x16x32_bf16 v[124:127], v[44:47], v[52:55], v[124:127]
  v_mfma_f32_16x16x32_bf16 v[112:115], v[32:35], v[56:59], v[112:115]
  v_mfma_f32_16x16x32_bf16 v[120:123], v[16:19], v[64:67], v[120:123]
  v_mfma_f32_16x16x32_bf16 v[116:119], v[40:43], v[56:59], v[116:119]
  v_mfma_f32_16x16x32_bf16 v[124:127], v[24:27], v[64:67], v[124:127]
  v_mfma_f32_16x16x32_bf16 v[112:115], v[36:39], v[60:63], v[112:115]
  v_mfma_f32_16x16x32_bf16 v[120:123], v[20:23], v[68:71], v[120:123]
  v_mfma_f32_16x16x32_bf16 v[116:119], v[44:47], v[60:63], v[116:119]
  v_mfma_f32_16x16x32_bf16 v[124:127], v[28:31], v[68:71], v[124:127]
  s_waitcnt vmcnt(6)
  s_nop 7
  v_mul_f32 v128, v112, v88
  v_mul_f32 v136, v120, v88
  v_mul_f32 v129, v113, v89
  v_mul_f32 v137, v121, v89
  v_mul_f32 v130, v114, v90
  v_mul_f32 v138, v122, v90
  v_mul_f32 v131, v115, v91
  v_mul_f32 v139, v123, v91
  v_mul_f32 v132, v116, v92
  v_mul_f32 v140, v124, v92
  v_mul_f32 v133, v117, v93
  v_mul_f32 v141, v125, v93
  v_mul_f32 v134, v118, v94
  v_mul_f32 v142, v126, v94
  v_mul_f32 v135, v119, v95
  v_mul_f32 v143, v127, v95
  v_fma_f32 v128, v120, v96, v128
  v_fma_f32 v136, -v112, v96, v136
  v_fma_f32 v129, v121, v97, v129
  v_fma_f32 v137, -v113, v97, v137
  v_fma_f32 v130, v122, v98, v130
  v_fma_f32 v138, -v114, v98, v138
  v_fma_f32 v131, v123, v99, v131
  v_fma_f32 v139, -v115, v99, v139
  v_fma_f32 v132, v124, v100, v132
  v_fma_f32 v140, -v116, v100, v140
  v_fma_f32 v133, v125, v101, v133
  v_fma_f32 v141, -v117, v101, v141
  v_fma_f32 v134, v126, v102, v134
  v_fma_f32 v142, -v118, v102, v142
  v_fma_f32 v135, v127, v103, v135
  v_fma_f32 v143, -v119, v103, v143
  v_cvt_pk_bf16_f32 v160, v128, v129
  v_cvt_pk_bf16_f32 v164, v136, v137
  v_cvt_pk_bf16_f32 v168, -v128, -v129
  v_cvt_pk_bf16_f32 v161, v130, v131
  v_cvt_pk_bf16_f32 v165, v138, v139
  v_cvt_pk_bf16_f32 v169, -v130, -v131
  v_cvt_pk_bf16_f32 v162, v132, v133
  v_cvt_pk_bf16_f32 v166, v140, v141
  v_cvt_pk_bf16_f32 v170, -v132, -v133
  v_cvt_pk_bf16_f32 v163, v134, v135
  v_cvt_pk_bf16_f32 v167, v142, v143
  v_cvt_pk_bf16_f32 v171, -v134, -v135
  s_waitcnt vmcnt(2)
  s_nop 1
  v_mfma_f32_16x16x32_bf16 v[112:115], v[72:75], v[160:163], 0
  v_mfma_f32_16x16x32_bf16 v[120:123], v[72:75], v[164:167], 0
  v_mfma_f32_16x16x32_bf16 v[116:119], v[76:79], v[160:163], 0
  v_mfma_f32_16x16x32_bf16 v[124:127], v[76:79], v[164:167], 0
  v_mfma_f32_16x16x32_bf16 v[112:115], v[80:83], v[164:167], v[112:115]
  v_mfma_f32_16x16x32_bf16 v[120:123], v[80:83], v[168:171], v[120:123]
  v_mfma_f32_16x16x32_bf16 v[116:119], v[84:87], v[164:167], v[116:119]
  v_mfma_f32_16x16x32_bf16 v[124:127], v[84:87], v[168:171], v[124:127]
  s_waitcnt vmcnt(0)
  v_lshlrev_b32 v144, 16, v104
  v_and_b32 v152, 0xffff0000, v104
  v_lshlrev_b32 v145, 16, v105
  v_and_b32 v153, 0xffff0000, v105
  v_lshlrev_b32 v146, 16, v106
  v_and_b32 v154, 0xffff0000, v106
  v_lshlrev_b32 v147, 16, v107
  v_and_b32 v155, 0xffff0000, v107
  v_lshlrev_b32 v148, 16, v108
  v_and_b32 v156, 0xffff0000, v108
  v_lshlrev_b32 v149, 16, v109
  v_and_b32 v157, 0xffff0000, v109
  v_lshlrev_b32 v150, 16, v110
  v_and_b32 v158, 0xffff0000, v110
  v_lshlrev_b32 v151, 16, v111
  v_and_b32 v159, 0xffff0000, v111
  v_mul_f32 v128, v112, v144
  v_mul_f32 v136, v120, v144
  v_mul_f32 v129, v113, v145
  v_mul_f32 v137, v121, v145
  v_mul_f32 v130, v114, v146
  v_mul_f32 v138, v122, v146
  v_mul_f32 v131, v115, v147
  v_mul_f32 v139, v123, v147
  v_mul_f32 v132, v116, v148
  v_mul_f32 v140, v124, v148
  v_mul_f32 v133, v117, v149
  v_mul_f32 v141, v125, v149
  v_mul_f32 v134, v118, v150
  v_mul_f32 v142, v126, v150
  v_mul_f32 v135, v119, v151
  v_mul_f32 v143, v127, v151
  v_fma_f32 v128, -v120, v152, v128
  v_fma_f32 v136, v112, v152, v136
  v_fma_f32 v129, -v121, v153, v129
  v_fma_f32 v137, v113, v153, v137
  v_fma_f32 v130, -v122, v154, v130
  v_fma_f32 v138, v114, v154, v138
  v_fma_f32 v131, -v123, v155, v131
  v_fma_f32 v139, v115, v155, v139
  v_fma_f32 v132, -v124, v156, v132
  v_fma_f32 v140, v116, v156, v140
  v_fma_f32 v133, -v125, v157, v133
  v_fma_f32 v141, v117, v157, v141
  v_fma_f32 v134, -v126, v158, v134
  v_fma_f32 v142, v118, v158, v142
  v_fma_f32 v135, -v127, v159, v135
  v_fma_f32 v143, v119, v159, v143
  v_cvt_pk_bf16_f32 v160, v128, v129
  v_cvt_pk_bf16_f32 v164, v136, v137
  v_cvt_pk_bf16_f32 v168, -v136, -v137
  v_cvt_pk_bf16_f32 v161, v130, v131
  v_cvt_pk_bf16_f32 v165, v138, v139
  v_cvt_pk_bf16_f32 v169, -v138, -v139
  v_cvt_pk_bf16_f32 v162, v132, v133
  v_cvt_pk_bf16_f32 v166, v140, v141
  v_cvt_pk_bf16_f32 v170, -v140, -v141
  v_cvt_pk_bf16_f32 v163, v134, v135
  v_cvt_pk_bf16_f32 v167, v142, v143
  v_cvt_pk_bf16_f32 v171, -v142, -v143
  s_nop 1
  v_mfma_f32_16x16x32_bf16 v[112:115], v[72:75], v[160:163], 0
  v_mfma_f32_16x16x32_bf16 v[120:123], v[72:75], v[164:167], 0
  v_mfma_f32_16x16x32_bf16 v[116:119], v[76:79], v[160:163], 0
  v_mfma_f32_16x16x32_bf16 v[124:127], v[76:79], v[164:167], 0
  v_mfma_f32_16x16x32_bf16 v[112:115], v[80:83], v[168:171], v[112:115]
  v_mfma_f32_16x16x32_bf16 v[120:123], v[80:83], v[160:163], v[120:123]
  v_mfma_f32_16x16x32_bf16 v[116:119], v[84:87], v[168:171], v[116:119]
  v_mfma_f32_16x16x32_bf16 v[124:127], v[84:87], v[160:163], v[124:127]
  s_nop 7
  s_nop 0
  v_mul_f32 v128, v112, v88
  v_mul_f32 v136, v120, v88
  v_mul_f32 v129, v113, v89
  v_mul_f32 v137, v121, v89
  v_mul_f32 v130, v114, v90
  v_mul_f32 v138, v122, v90
  v_mul_f32 v131, v115, v91
  v_mul_f32 v139, v123, v91
  v_mul_f32 v132, v116, v92
  v_mul_f32 v140, v124, v92
  v_mul_f32 v133, v117, v93
  v_mul_f32 v141, v125, v93
  v_mul_f32 v134, v118, v94
  v_mul_f32 v142, v126, v94
  v_mul_f32 v135, v119, v95
  v_mul_f32 v143, v127, v95
  v_fma_f32 v128, -v120, v96, v128
  v_fma_f32 v136, v112, v96, v136
  v_fma_f32 v129, -v121, v97, v129
  v_fma_f32 v137, v113, v97, v137
  v_fma_f32 v130, -v122, v98, v130
  v_fma_f32 v138, v114, v98, v138
  v_fma_f32 v131, -v123, v99, v131
  v_fma_f32 v139, v115, v99, v139
  v_fma_f32 v132, -v124, v100, v132
  v_fma_f32 v140, v116, v100, v140
  v_fma_f32 v133, -v125, v101, v133
  v_fma_f32 v141, v117, v101, v141
  v_fma_f32 v134, -v126, v102, v134
  v_fma_f32 v142, v118, v102, v142
  v_fma_f32 v135, -v127, v103, v135
  v_fma_f32 v143, v119, v103, v143
  v_cvt_pk_bf16_f32 v128, v128, v129
  v_cvt_pk_bf16_f32 v129, v130, v131
  ds_write_b64 v9, v[128:129] offset:0
  v_cvt_pk_bf16_f32 v132, v132, v133
  v_cvt_pk_bf16_f32 v133, v134, v135
  ds_write_b64 v10, v[132:133] offset:0
  v_cvt_pk_bf16_f32 v136, v136, v137
  v_cvt_pk_bf16_f32 v137, v138, v139
  ds_write_b64 v9, v[136:137] offset:4096
  v_cvt_pk_bf16_f32 v140, v140, v141
  v_cvt_pk_bf16_f32 v141, v142, v143
  ds_write_b64 v10, v[140:141] offset:4096
  v_mov_b32 v6, 57344
  v_mov_b32 v7, 1
  s_waitcnt lgkmcnt(0)
  s_mov_b64 exec, 1
  ds_add_u32 v6, v7
  s_mov_b64 exec, -1
k2_fft_spin:
  ds_read_b32 v7, v6
  s_waitcnt lgkmcnt(0)
  v_readfirstlane_b32 s32, v7
  s_cmp_ge_u32 s32, 4
  s_cbranch_scc1 k2_fft_go
  s_sleep 1
  s_branch k2_fft_spin
k2_fft_go:
  ds_read_b64_tr_b16 v[16:17], v11 offset:0
  ds_read_b64_tr_b16 v[18:19], v11 offset:256
  ds_read_b64_tr_b16 v[20:21], v11 offset:2048
  ds_read_b64_tr_b16 v[22:23], v11 offset:2304
  ds_read_b64_tr_b16 v[24:25], v12 offset:0
  ds_read_b64_tr_b16 v[26:27], v12 offset:256
  ds_read_b64_tr_b16 v[28:29], v12 offset:2048
  ds_read_b64_tr_b16 v[30:31], v12 offset:2304
  ds_read_b64_tr_b16 v[32:33], v11 offset:4096
  ds_read_b64_tr_b16 v[34:35], v11 offset:4352
  ds_read_b64_tr_b16 v[36:37], v11 offset:6144
  ds_read_b64_tr_b16 v[38:39], v11 offset:6400
  ds_read_b64_tr_b16 v[40:41], v12 offset:4096
  ds_read_b64_tr_b16 v[42:43], v12 offset:4352
  ds_read_b64_tr_b16 v[44:45], v12 offset:6144
  ds_read_b64_tr_b16 v[46:47], v12 offset:6400
  s_waitcnt lgkmcnt(0)
  v_mfma_f32_16x16x32_bf16 v[112:115], v[16:19], v[48:51], 0
  v_mfma_f32_16x16x32_bf16 v[120:123], v[32:35], v[48:51], 0
  v_mfma_f32_16x16x32_bf16 v[116:119], v[24:27], v[48:51], 0
  v_mfma_f32_16x16x32_bf16 v[124:127], v[40:43], v[48:51], 0
  v_mfma_f32_16x16x32_bf16 v[112:115], v[20:23], v[52:55], v[112:115]
  v_mfma_f32_16x16x32_bf16 v[120:123], v[36:39], v[52:55], v[120:123]
  v_mfma_f32_16x16x32_bf16 v[116:119], v[28:31], v[52:55], v[116:119]
  v_mfma_f32_16x16x32_bf16 v[124:127], v[44:47], v[52:55], v[124:127]
  v_mfma_f32_16x16x32_bf16 v[112:115], v[32:35], v[64:67], v[112:115]
  v_mfma_f32_16x16x32_bf16 v[120:123], v[16:19], v[56:59], v[120:123]
  v_mfma_f32_16x16x32_bf16 v[116:119], v[40:43], v[64:67], v[116:119]
  v_mfma_f32_16x16x32_bf16 v[124:127], v[24:27], v[56:59], v[124:127]
  v_mfma_f32_16x16x32_bf16 v[112:115], v[36:39], v[68:71], v[112:115]
  v_mfma_f32_16x16x32_bf16 v[120:123], v[20:23], v[60:63], v[120:123]
  v_mfma_f32_16x16x32_bf16 v[116:119], v[44:47], v[68:71], v[116:119]
  v_mfma_f32_16x16x32_bf16 v[124:127], v[28:31], v[60:63], v[124:127]
  s_nop 7
  s_nop 0
  v_cvt_pk_bf16_f32 v112, v112, v113
  v_cvt_pk_bf16_f32 v113, v114, v115
  global_store_dwordx2 v13, v[112:113], s[40:41] offset:0
  v_cvt_pk_bf16_f32 v116, v116, v117
  v_cvt_pk_bf16_f32 v117, v118, v119
  global_store_dwordx2 v13, v[116:117], s[40:41] offset:32
  s_cmp_eq_u32 s44, 0
  s_cbranch_scc1 k2_prefetch
  v_cvt_pk_bf16_f32 v120, v120, v121
  v_cvt_pk_bf16_f32 v121, v122, v123
  global_store_dwordx2 v13, v[120:121], s[42:43] offset:0
  v_cvt_pk_bf16_f32 v124, v124, v125
  v_cvt_pk_bf16_f32 v125, v126, v127
  global_store_dwordx2 v13, v[124:125], s[42:43] offset:32
  s_branch k2_prefetch
k2_prefetch:
  s_setprio 0
  s_waitcnt lgkmcnt(0)
  s_getpc_b64 s[52:53]
  s_add_u32 s52, s52, tab_G@rel32@lo+4
  s_addc_u32 s53, s53, tab_G@rel32@hi+12
  s_mov_b32 s54, 401408
  s_mov_b32 s55, 0x00020000
  s_lshr_b32 s26, s2, 3
  s_lshl_b32 s26, s26, 2
  s_add_u32 s26, s26, s24
  s_lshl_b32 s27, s26, 12
  buffer_load_dwordx4 v[176:179], v3, s[52:55], s27 offen offset:0
  buffer_load_dwordx4 v[180:183], v3, s[52:55], s27 offen offset:1024
  buffer_load_dwordx4 v[184:187], v3, s[52:55], s27 offen offset:2048
  buffer_load_dwordx4 v[188:191], v3, s[52:55], s27 offen offset:3072
  s_add_u32 s52, s18, 10485760
  s_addc_u32 s53, s19, 0
  buffer_load_dwordx4 v[196:199], v3, s[52:55], s27 offen offset:0
  buffer_load_dwordx4 v[200:203], v3, s[52:55], s27 offen offset:1024
  buffer_load_dwordx4 v[204:207], v3, s[52:55], s27 offen offset:2048
  buffer_load_dwordx4 v[208:211], v3, s[52:55], s27 offen offset:3072
  s_getpc_b64 s[56:57]
  s_add_u32 s56, s56, k3_kernel@rel32@lo+4
  s_addc_u32 s57, s57, k3_kernel@rel32@hi+12
  s_mov_b32 s58, k3_code_end-k3_kernel
  s_mov_b32 s59, 0x00020000
  s_lshl_b32 s27, s26, 10
  buffer_load_dwordx4 v[192:195], v3, s[56:59], s27 offen
  s_endpgm
k2_end:
  s_endpgm
  .globl k3_kernel
  .p2align 8
  .type k3_kernel,@function
k3_kernel:
  s_cmp_ge_u32 s2, 224
  s_cbranch_scc1 k3_end
  s_load_dwordx2 s[18:19], s[0:1], 72
  s_load_dwordx2 s[16:17], s[0:1], 56
  v_lshrrev_b32 v1, 6, v0
  v_and_b32 v2, 63, v0
  v_readfirstlane_b32 s24, v1
  v_lshlrev_b32 v3, 4, v2
  s_and_b32 s20, s2, 7
  s_lshr_b32 s21, s2, 3
  s_mul_i32 s22, s21, 37
  s_lshr_b32 s22, s22, 8
  s_mul_i32 s23, s22, 7
  s_sub_u32 s23, s21, s23
  s_lshl_b32 s20, s20, 2
  s_add_u32 s22, s22, s20
  s_and_b32 s25, s24, 3
  s_bfe_u32 s26, s24, 0x10002
  s_cmp_lt_u32 s24, 8
  s_cbranch_scc1 k3_compute
  s_sub_u32 s24, s24, 8
  v_lshrrev_b32 v6, 3, v2
  v_lshlrev_b32 v6, 12, v6
  v_bfe_u32 v7, v2, 4, 1
  s_and_b32 s27, s24, 1
  s_lshl_b32 s27, s27, 1
  v_or_b32 v7, s27, v7
  v_lshlrev_b32 v7, 1, v7
  v_and_b32 v8, 7, v2
  v_xor_b32 v7, v7, v8
  v_lshl_add_u32 v6, v7, 4, v6
  s_mov_b32 s30, 0x1000000
  s_mov_b32 s31, 0x00020000
  s_lshl_b32 s32, s24, 15
  s_lshl_b32 s33, s22, 7
  s_add_u32 s32, s32, s33
  s_add_u32 s32, s32, 13631488
  s_lshl_b32 s33, s22, 2
  s_add_u32 s33, s33, s25
  s_mul_i32 s33, s33, 14336
  s_lshl_b32 s34, s26, 10
  s_add_u32 s33, s33, s34
  s_add_u32 s33, s33, 11534336
  s_lshl_b32 s35, s24, 10
  s_mul_i32 s36, s25, 14336
  s_add_u32 s36, s36, s34
  s_add_u32 s36, s36, 57344
  s_waitcnt lgkmcnt(0)
  s_mov_b32 s28, s18
  s_mov_b32 s29, s19
  s_add_u32 m0, s35, 0
  s_add_u32 s41, s32, 0
  buffer_load_dwordx4 v6, s[28:31], s41 offen lds
  s_add_u32 m0, s36, 0
  s_add_u32 s41, s33, 0
  buffer_load_dwordx4 v3, s[28:31], s41 offen lds
  s_add_u32 m0, s35, 8192
  s_add_u32 s41, s32, 262144
  buffer_load_dwordx4 v6, s[28:31], s41 offen lds
  s_add_u32 m0, s36, 2048
  s_add_u32 s41, s33, 2048
  buffer_load_dwordx4 v3, s[28:31], s41 offen lds
  s_add_u32 m0, s35, 16384
  s_add_u32 s41, s32, 524288
  buffer_load_dwordx4 v6, s[28:31], s41 offen lds
  s_add_u32 m0, s36, 4096
  s_add_u32 s41, s33, 4096
  buffer_load_dwordx4 v3, s[28:31], s41 offen lds
  s_waitcnt vmcnt(4)
  s_barrier
  s_add_u32 m0, s35, 24576
  s_add_u32 s41, s32, 786432
  buffer_load_dwordx4 v6, s[28:31], s41 offen lds
  s_add_u32 m0, s36, 6144
  s_add_u32 s41, s33, 6144
  buffer_load_dwordx4 v3, s[28:31], s41 offen lds
  s_waitcnt vmcnt(4)
  s_barrier
  s_add_u32 m0, s35, 32768
  s_add_u32 s41, s32, 1048576
  buffer_load_dwordx4 v6, s[28:31], s41 offen lds
  s_add_u32 m0, s36, 8192
  s_add_u32 s41, s33, 8192
  buffer_load_dwordx4 v3, s[28:31], s41 offen lds
  s_waitcnt vmcnt(4)
  s_barrier
  s_add_u32 m0, s35, 40960
  s_add_u32 s41, s32, 1310720
  buffer_load_dwordx4 v6, s[28:31], s41 offen lds
  s_add_u32 m0, s36, 10240
  s_add_u32 s41, s33, 10240
  buffer_load_dwordx4 v3, s[28:31], s41 offen lds
  s_waitcnt vmcnt(4)
  s_barrier
  s_add_u32 m0, s35, 49152
  s_add_u32 s41, s32, 1572864
  buffer_load_dwordx4 v6, s[28:31], s41 offen lds
  s_add_u32 m0, s36, 12288
  s_add_u32 s41, s33, 12288
  buffer_load_dwordx4 v3, s[28:31], s41 offen lds
  s_waitcnt vmcnt(4)
  s_barrier
  s_waitcnt vmcnt(2)
  s_barrier
  s_waitcnt vmcnt(0)
  s_barrier
  s_endpgm
k3_compute:
  v_and_b32 v4, 15, v2
  v_lshrrev_b32 v5, 4, v2
  s_getpc_b64 s[38:39]
  s_add_u32 s38, s38, tab_G@rel32@lo+4
  s_addc_u32 s39, s39, tab_G@rel32@hi+12
  s_lshl_b32 s40, s23, 2
  s_add_u32 s40, s40, s25
  s_mul_i32 s44, s40, 14336
  s_lshl_b32 s41, s22, 8
  s_add_u32 s41, s41, 11010048
  v_lshlrev_b32 v7, 2, v4
  s_waitcnt lgkmcnt(0)
  s_add_u32 s42, s18, 10485760
  s_addc_u32 s43, s19, 0
  s_cmp_eq_u32 s26, 0
  s_cselect_b32 s38, s38, s42
  s_cselect_b32 s39, s39, s43
  s_add_u32 s38, s38, s44
  s_addc_u32 s39, s39, 0
  global_load_dwordx4 v[16:19], v3, s[38:39] offset:0
  global_load_dwordx4 v[20:23], v3, s[38:39] offset:1024
  global_load_dwordx4 v[24:27], v3, s[38:39] offset:2048
  global_load_dwordx4 v[28:31], v3, s[38:39] offset:3072
  s_add_u32 s38, s38, 4096
  s_addc_u32 s39, s39, 0
  global_load_dwordx4 v[32:35], v3, s[38:39] offset:0
  global_load_dwordx4 v[36:39], v3, s[38:39] offset:1024
  global_load_dwordx4 v[40:43], v3, s[38:39] offset:2048
  global_load_dwordx4 v[44:47], v3, s[38:39] offset:3072
  s_add_u32 s38, s38, 4096
  s_addc_u32 s39, s39, 0
  global_load_dwordx4 v[48:51], v3, s[38:39] offset:0
  global_load_dwordx4 v[52:55], v3, s[38:39] offset:1024
  global_load_dwordx4 v[56:59], v3, s[38:39] offset:2048
  global_load_dwordx4 v[60:63], v3, s[38:39] offset:3072
  s_add_u32 s38, s38, 4096
  s_addc_u32 s39, s39, 0
  global_load_dwordx4 v[64:67], v3, s[38:39] offset:0
  global_load_dwordx4 v[68:71], v3, s[38:39] offset:1024
  s_add_u32 s42, s18, s41
  s_addc_u32 s43, s19, 0
  global_load_dword v12, v7, s[42:43] offset:0
  global_load_dword v13, v7, s[42:43] offset:64
  global_load_dword v14, v7, s[42:43] offset:128
  global_load_dword v15, v7, s[42:43] offset:192
  s_lshl_b32 s41, s25, 12
  s_add_u32 s41, s41, 114688
  v_add_u32 v6, s41, v3
  s_cmp_eq_u32 s26, 1
  s_cbranch_scc1 k3_opart
  v_lshrrev_b32 v7, 2, v4
  v_lshl_add_u32 v7, v5, 3, v7
  v_lshlrev_b32 v7, 7, v7
  v_and_b32 v8, 3, v4
  v_lshl_add_u32 v7, v8, 3, v7
  v_lshrrev_b32 v8, 3, v4
  v_and_b32 v9, 1, v5
  v_lshl_or_b32 v8, v9, 1, v8
  v_lshl_add_u32 v8, v8, 5, v7
  v_xor_b32 v9, 32, v8
  v_xor_b32 v10, 64, v8
  v_xor_b32 v11, 96, v8
  v_mul_u32_u24 v7, 896, v4
  v_lshl_add_u32 v7, v5, 3, v7
  s_mul_i32 s41, s22, 57344
  s_lshl_b32 s40, s40, 5
  s_add_u32 s41, s41, s40
  s_add_u32 s46, s16, s41
  s_addc_u32 s47, s17, 0
  s_barrier
  ds_read_b64_tr_b16 v[88:89], v8 offset:0
  ds_read_b64_tr_b16 v[90:91], v8 offset:512
  ds_read_b64_tr_b16 v[92:93], v9 offset:0
  ds_read_b64_tr_b16 v[94:95], v9 offset:512
  ds_read_b64_tr_b16 v[96:97], v10 offset:0
  ds_read_b64_tr_b16 v[98:99], v10 offset:512
  ds_read_b64_tr_b16 v[100:101], v11 offset:0
  ds_read_b64_tr_b16 v[102:103], v11 offset:512
  ds_read_b64_tr_b16 v[104:105], v8 offset:4096
  ds_read_b64_tr_b16 v[106:107], v8 offset:4608
  ds_read_b64_tr_b16 v[108:109], v9 offset:4096
  ds_read_b64_tr_b16 v[110:111], v9 offset:4608
  ds_read_b64_tr_b16 v[112:113], v10 offset:4096
  ds_read_b64_tr_b16 v[114:115], v10 offset:4608
  ds_read_b64_tr_b16 v[116:117], v11 offset:4096
  ds_read_b64_tr_b16 v[118:119], v11 offset:4608
  s_waitcnt vmcnt(17)
  s_waitcnt lgkmcnt(14)
  v_mfma_f32_16x16x32_bf16 v[72:75], v[16:19], v[88:91], 0
  s_waitcnt lgkmcnt(12)
  v_mfma_f32_16x16x32_bf16 v[76:79], v[16:19], v[92:95], 0
  s_waitcnt lgkmcnt(10)
  v_mfma_f32_16x16x32_bf16 v[80:83], v[16:19], v[96:99], 0
  s_waitcnt lgkmcnt(8)
  v_mfma_f32_16x16x32_bf16 v[84:87], v[16:19], v[100:103], 0
  s_barrier
  ds_read_b64_tr_b16 v[88:89], v8 offset:8192
  ds_read_b64_tr_b16 v[90:91], v8 offset:8704
  ds_read_b64_tr_b16 v[92:93], v9 offset:8192
  ds_read_b64_tr_b16 v[94:95], v9 offset:8704
  ds_read_b64_tr_b16 v[96:97], v10 offset:8192
  ds_read_b64_tr_b16 v[98:99], v10 offset:8704
  ds_read_b64_tr_b16 v[100:101], v11 offset:8192
  ds_read_b64_tr_b16 v[102:103], v11 offset:8704
  s_waitcnt vmcnt(16)
  s_waitcnt lgkmcnt(14)
  v_mfma_f32_16x16x32_bf16 v[72:75], v[20:23], v[104:107], v[72:75]
  s_waitcnt lgkmcnt(12)
  v_mfma_f32_16x16x32_bf16 v[76:79], v[20:23], v[108:111], v[76:79]
  s_waitcnt lgkmcnt(10)
  v_mfma_f32_16x16x32_bf16 v[80:83], v[20:23], v[112:115], v[80:83]
  s_waitcnt lgkmcnt(8)
  v_mfma_f32_16x16x32_bf16 v[84:87], v[20:23], v[116:119], v[84:87]
  ds_read_b64_tr_b16 v[104:105], v8 offset:12288
  ds_read_b64_tr_b16 v[106:107], v8 offset:12800
  ds_read_b64_tr_b16 v[108:109], v9 offset:12288
  ds_read_b64_tr_b16 v[110:111], v9 offset:12800
  ds_read_b64_tr_b16 v[112:113], v10 offset:12288
  ds_read_b64_tr_b16 v[114:115], v10 offset:12800
  ds_read_b64_tr_b16 v[116:117], v11 offset:12288
  ds_read_b64_tr_b16 v[118:119], v11 offset:12800
  s_waitcnt vmcnt(15)
  s_waitcnt lgkmcnt(14)
  v_mfma_f32_16x16x32_bf16 v[72:75], v[24:27], v[88:91], v[72:75]
  s_waitcnt lgkmcnt(12)
  v_mfma_f32_16x16x32_bf16 v[76:79], v[24:27], v[92:95], v[76:79]
  s_waitcnt lgkmcnt(10)
  v_mfma_f32_16x16x32_bf16 v[80:83], v[24:27], v[96:99], v[80:83]
  s_waitcnt lgkmcnt(8)
  v_mfma_f32_16x16x32_bf16 v[84:87], v[24:27], v[100:103], v[84:87]
  s_barrier
  ds_read_b64_tr_b16 v[88:89], v8 offset:16384
  ds_read_b64_tr_b16 v[90:91], v8 offset:16896
  ds_read_b64_tr_b16 v[92:93], v9 offset:16384
  ds_read_b64_tr_b16 v[94:95], v9 offset:16896
  ds_read_b64_tr_b16 v[96:97], v10 offset:16384
  ds_read_b64_tr_b16 v[98:99], v10 offset:16896
  ds_read_b64_tr_b16 v[100:101], v11 offset:16384
  ds_read_b64_tr_b16 v[102:103], v11 offset:16896
  s_waitcnt vmcnt(14)
  s_waitcnt lgkmcnt(14)
  v_mfma_f32_16x16x32_bf16 v[72:75], v[28:31], v[104:107], v[72:75]
  s_waitcnt lgkmcnt(12)
  v_mfma_f32_16x16x32_bf16 v[76:79], v[28:31], v[108:111], v[76:79]
  s_waitcnt lgkmcnt(10)
  v_mfma_f32_16x16x32_bf16 v[80:83], v[28:31], v[112:115], v[80:83]
  s_waitcnt lgkmcnt(8)
  v_mfma_f32_16x16x32_bf16 v[84:87], v[28:31], v[116:119], v[84:87]
  ds_read_b64_tr_b16 v[104:105], v8 offset:20480
  ds_read_b64_tr_b16 v[106:107], v8 offset:20992
  ds_read_b64_tr_b16 v[108:109], v9 offset:20480
  ds_read_b64_tr_b16 v[110:111], v9 offset:20992
  ds_read_b64_tr_b16 v[112:113], v10 offset:20480
  ds_read_b64_tr_b16 v[114:115], v10 offset:20992
  ds_read_b64_tr_b16 v[116:117], v11 offset:20480
  ds_read_b64_tr_b16 v[118:119], v11 offset:20992
  s_waitcnt vmcnt(13)
  s_waitcnt lgkmcnt(14)
  v_mfma_f32_16x16x32_bf16 v[72:75], v[32:35], v[88:91], v[72:75]
  s_waitcnt lgkmcnt(12)
  v_mfma_f32_16x16x32_bf16 v[76:79], v[32:35], v[92:95], v[76:79]
  s_waitcnt lgkmcnt(10)
  v_mfma_f32_16x16x32_bf16 v[80:83], v[32:35], v[96:99], v[80:83]
  s_waitcnt lgkmcnt(8)
  v_mfma_f32_16x16x32_bf16 v[84:87], v[32:35], v[100:103], v[84:87]
  s_barrier
  ds_read_b64_tr_b16 v[88:89], v8 offset:24576
  ds_read_b64_tr_b16 v[90:91], v8 offset:25088
  ds_read_b64_tr_b16 v[92:93], v9 offset:24576
  ds_read_b64_tr_b16 v[94:95], v9 offset:25088
  ds_read_b64_tr_b16 v[96:97], v10 offset:24576
  ds_read_b64_tr_b16 v[98:99], v10 offset:25088
  ds_read_b64_tr_b16 v[100:101], v11 offset:24576
  ds_read_b64_tr_b16 v[102:103], v11 offset:25088
  s_waitcnt vmcnt(12)
  s_waitcnt lgkmcnt(14)
  v_mfma_f32_16x16x32_bf16 v[72:75], v[36:39], v[104:107], v[72:75]
  s_waitcnt lgkmcnt(12)
  v_mfma_f32_16x16x32_bf16 v[76:79], v[36:39], v[108:111], v[76:79]
  s_waitcnt lgkmcnt(10)
  v_mfma_f32_16x16x32_bf16 v[80:83], v[36:39], v[112:115], v[80:83]
  s_waitcnt lgkmcnt(8)
  v_mfma_f32_16x16x32_bf16 v[84:87], v[36:39], v[116:119], v[84:87]
  ds_read_b64_tr_b16 v[104:105], v8 offset:28672
  ds_read_b64_tr_b16 v[106:107], v8 offset:29184
  ds_read_b64_tr_b16 v[108:109], v9 offset:28672
  ds_read_b64_tr_b16 v[110:111], v9 offset:29184
  ds_read_b64_tr_b16 v[112:113], v10 offset:28672
  ds_read_b64_tr_b16 v[114:115], v10 offset:29184
  ds_read_b64_tr_b16 v[116:117], v11 offset:28672
  ds_read_b64_tr_b16 v[118:119], v11 offset:29184
  s_waitcnt vmcnt(11)
  s_waitcnt lgkmcnt(14)
  v_mfma_f32_16x16x32_bf16 v[72:75], v[40:43], v[88:91], v[72:75]
  s_waitcnt lgkmcnt(12)
  v_mfma_f32_16x16x32_bf16 v[76:79], v[40:43], v[92:95], v[76:79]
  s_waitcnt lgkmcnt(10)
  v_mfma_f32_16x16x32_bf16 v[80:83], v[40:43], v[96:99], v[80:83]
  s_waitcnt lgkmcnt(8)
  v_mfma_f32_16x16x32_bf16 v[84:87], v[40:43], v[100:103], v[84:87]
  s_barrier
  ds_read_b64_tr_b16 v[88:89], v8 offset:32768
  ds_read_b64_tr_b16 v[90:91], v8 offset:33280
  ds_read_b64_tr_b16 v[92:93], v9 offset:32768
  ds_read_b64_tr_b16 v[94:95], v9 offset:33280
  ds_read_b64_tr_b16 v[96:97], v10 offset:32768
  ds_read_b64_tr_b16 v[98:99], v10 offset:33280
  ds_read_b64_tr_b16 v[100:101], v11 offset:32768
  ds_read_b64_tr_b16 v[102:103], v11 offset:33280
  s_waitcnt vmcnt(10)
  s_waitcnt lgkmcnt(14)
  v_mfma_f32_16x16x32_bf16 v[72:75], v[44:47], v[104:107], v[72:75]
  s_waitcnt lgkmcnt(12)
  v_mfma_f32_16x16x32_bf16 v[76:79], v[44:47], v[108:111], v[76:79]
  s_waitcnt lgkmcnt(10)
  v_mfma_f32_16x16x32_bf16 v[80:83], v[44:47], v[112:115], v[80:83]
  s_waitcnt lgkmcnt(8)
  v_mfma_f32_16x16x32_bf16 v[84:87], v[44:47], v[116:119], v[84:87]
  ds_read_b64_tr_b16 v[104:105], v8 offset:36864
  ds_read_b64_tr_b16 v[106:107], v8 offset:37376
  ds_read_b64_tr_b16 v[108:109], v9 offset:36864
  ds_read_b64_tr_b16 v[110:111], v9 offset:37376
  ds_read_b64_tr_b16 v[112:113], v10 offset:36864
  ds_read_b64_tr_b16 v[114:115], v10 offset:37376
  ds_read_b64_tr_b16 v[116:117], v11 offset:36864
  ds_read_b64_tr_b16 v[118:119], v11 offset:37376
  s_waitcnt vmcnt(9)
  s_waitcnt lgkmcnt(14)
  v_mfma_f32_16x16x32_bf16 v[72:75], v[48:51], v[88:91], v[72:75]
  s_waitcnt lgkmcnt(12)
  v_mfma_f32_16x16x32_bf16 v[76:79], v[48:51], v[92:95], v[76:79]
  s_waitcnt lgkmcnt(10)
  v_mfma_f32_16x16x32_bf16 v[80:83], v[48:51], v[96:99], v[80:83]
  s_waitcnt lgkmcnt(8)
  v_mfma_f32_16x16x32_bf16 v[84:87], v[48:51], v[100:103], v[84:87]
  s_barrier
  ds_read_b64_tr_b16 v[88:89], v8 offset:40960
  ds_read_b64_tr_b16 v[90:91], v8 offset:41472
  ds_read_b64_tr_b16 v[92:93], v9 offset:40960
  ds_read_b64_tr_b16 v[94:95], v9 offset:41472
  ds_read_b64_tr_b16 v[96:97], v10 offset:40960
  ds_read_b64_tr_b16 v[98:99], v10 offset:41472
  ds_read_b64_tr_b16 v[100:101], v11 offset:40960
  ds_read_b64_tr_b16 v[102:103], v11 offset:41472
  s_waitcnt vmcnt(8)
  s_waitcnt lgkmcnt(14)
  v_mfma_f32_16x16x32_bf16 v[72:75], v[52:55], v[104:107], v[72:75]
  s_waitcnt lgkmcnt(12)
  v_mfma_f32_16x16x32_bf16 v[76:79], v[52:55], v[108:111], v[76:79]
  s_waitcnt lgkmcnt(10)
  v_mfma_f32_16x16x32_bf16 v[80:83], v[52:55], v[112:115], v[80:83]
  s_waitcnt lgkmcnt(8)
  v_mfma_f32_16x16x32_bf16 v[84:87], v[52:55], v[116:119], v[84:87]
  ds_read_b64_tr_b16 v[104:105], v8 offset:45056
  ds_read_b64_tr_b16 v[106:107], v8 offset:45568
  ds_read_b64_tr_b16 v[108:109], v9 offset:45056
  ds_read_b64_tr_b16 v[110:111], v9 offset:45568
  ds_read_b64_tr_b16 v[112:113], v10 offset:45056
  ds_read_b64_tr_b16 v[114:115], v10 offset:45568
  ds_read_b64_tr_b16 v[116:117], v11 offset:45056
  ds_read_b64_tr_b16 v[118:119], v11 offset:45568
  s_waitcnt vmcnt(7)
  s_waitcnt lgkmcnt(14)
  v_mfma_f32_16x16x32_bf16 v[72:75], v[56:59], v[88:91], v[72:75]
  s_waitcnt lgkmcnt(12)
  v_mfma_f32_16x16x32_bf16 v[76:79], v[56:59], v[92:95], v[76:79]
  s_waitcnt lgkmcnt(10)
  v_mfma_f32_16x16x32_bf16 v[80:83], v[56:59], v[96:99], v[80:83]
  s_waitcnt lgkmcnt(8)
  v_mfma_f32_16x16x32_bf16 v[84:87], v[56:59], v[100:103], v[84:87]
  s_barrier
  ds_read_b64_tr_b16 v[88:89], v8 offset:49152
  ds_read_b64_tr_b16 v[90:91], v8 offset:49664
  ds_read_b64_tr_b16 v[92:93], v9 offset:49152
  ds_read_b64_tr_b16 v[94:95], v9 offset:49664
  ds_read_b64_tr_b16 v[96:97], v10 offset:49152
  ds_read_b64_tr_b16 v[98:99], v10 offset:49664
  ds_read_b64_tr_b16 v[100:101], v11 offset:49152
  ds_read_b64_tr_b16 v[102:103], v11 offset:49664
  s_waitcnt vmcnt(6)
  s_waitcnt lgkmcnt(14)
  v_mfma_f32_16x16x32_bf16 v[72:75], v[60:63], v[104:107], v[72:75]
  s_waitcnt lgkmcnt(12)
  v_mfma_f32_16x16x32_bf16 v[76:79], v[60:63], v[108:111], v[76:79]
  s_waitcnt lgkmcnt(10)
  v_mfma_f32_16x16x32_bf16 v[80:83], v[60:63], v[112:115], v[80:83]
  s_waitcnt lgkmcnt(8)
  v_mfma_f32_16x16x32_bf16 v[84:87], v[60:63], v[116:119], v[84:87]
  ds_read_b64_tr_b16 v[104:105], v8 offset:53248
  ds_read_b64_tr_b16 v[106:107], v8 offset:53760
  ds_read_b64_tr_b16 v[108:109], v9 offset:53248
  ds_read_b64_tr_b16 v[110:111], v9 offset:53760
  ds_read_b64_tr_b16 v[112:113], v10 offset:53248
  ds_read_b64_tr_b16 v[114:115], v10 offset:53760
  ds_read_b64_tr_b16 v[116:117], v11 offset:53248
  ds_read_b64_tr_b16 v[118:119], v11 offset:53760
  s_waitcnt vmcnt(5)
  s_waitcnt lgkmcnt(14)
  v_mfma_f32_16x16x32_bf16 v[72:75], v[64:67], v[88:91], v[72:75]
  s_waitcnt lgkmcnt(12)
  v_mfma_f32_16x16x32_bf16 v[76:79], v[64:67], v[92:95], v[76:79]
  s_waitcnt lgkmcnt(10)
  v_mfma_f32_16x16x32_bf16 v[80:83], v[64:67], v[96:99], v[80:83]
  s_waitcnt lgkmcnt(8)
  v_mfma_f32_16x16x32_bf16 v[84:87], v[64:67], v[100:103], v[84:87]
  s_waitcnt vmcnt(4)
  s_waitcnt lgkmcnt(6)
  v_mfma_f32_16x16x32_bf16 v[72:75], v[68:71], v[104:107], v[72:75]
  s_waitcnt lgkmcnt(4)
  v_mfma_f32_16x16x32_bf16 v[76:79], v[68:71], v[108:111], v[76:79]
  s_waitcnt lgkmcnt(2)
  v_mfma_f32_16x16x32_bf16 v[80:83], v[68:71], v[112:115], v[80:83]
  s_waitcnt lgkmcnt(0)
  v_mfma_f32_16x16x32_bf16 v[84:87], v[68:71], v[116:119], v[84:87]
  s_barrier
  ds_read_b128 v[88:91], v6 offset:0
  ds_read_b128 v[92:95], v6 offset:1024
  ds_read_b128 v[96:99], v6 offset:2048
  ds_read_b128 v[100:103], v6 offset:3072
  s_waitcnt vmcnt(0)
  s_waitcnt lgkmcnt(3)
  v_sub_f32 v72, v72, v88
  v_fma_f32 v72, v12, v72, v88
  v_sub_f32 v73, v73, v89
  v_fma_f32 v73, v12, v73, v89
  v_sub_f32 v74, v74, v90
  v_fma_f32 v74, v12, v74, v90
  v_sub_f32 v75, v75, v91
  v_fma_f32 v75, v12, v75, v91
  v_cvt_pk_bf16_f32 v72, v72, v73
  v_cvt_pk_bf16_f32 v73, v74, v75
  global_store_dwordx2 v7, v[72:73], s[46:47]
  s_waitcnt lgkmcnt(2)
  v_sub_f32 v76, v76, v92
  v_fma_f32 v76, v13, v76, v92
  v_sub_f32 v77, v77, v93
  v_fma_f32 v77, v13, v77, v93
  v_sub_f32 v78, v78, v94
  v_fma_f32 v78, v13, v78, v94
  v_sub_f32 v79, v79, v95
  v_fma_f32 v79, v13, v79, v95
  v_cvt_pk_bf16_f32 v76, v76, v77
  v_cvt_pk_bf16_f32 v77, v78, v79
  v_add_u32 v7, 14336, v7
  global_store_dwordx2 v7, v[76:77], s[46:47]
  s_waitcnt lgkmcnt(1)
  v_sub_f32 v80, v80, v96
  v_fma_f32 v80, v14, v80, v96
  v_sub_f32 v81, v81, v97
  v_fma_f32 v81, v14, v81, v97
  v_sub_f32 v82, v82, v98
  v_fma_f32 v82, v14, v82, v98
  v_sub_f32 v83, v83, v99
  v_fma_f32 v83, v14, v83, v99
  v_cvt_pk_bf16_f32 v80, v80, v81
  v_cvt_pk_bf16_f32 v81, v82, v83
  v_add_u32 v7, 14336, v7
  global_store_dwordx2 v7, v[80:81], s[46:47]
  s_waitcnt lgkmcnt(0)
  v_sub_f32 v84, v84, v100
  v_fma_f32 v84, v15, v84, v100
  v_sub_f32 v85, v85, v101
  v_fma_f32 v85, v15, v85, v101
  v_sub_f32 v86, v86, v102
  v_fma_f32 v86, v15, v86, v102
  v_sub_f32 v87, v87, v103
  v_fma_f32 v87, v15, v87, v103
  v_cvt_pk_bf16_f32 v84, v84, v85
  v_cvt_pk_bf16_f32 v85, v86, v87
  v_add_u32 v7, 14336, v7
  global_store_dwordx2 v7, v[84:85], s[46:47]
  s_endpgm
k3_opart:
  v_add_u32 v8, 57344, v3
  s_barrier
  ds_read_b128 v[88:91], v8 offset:0
  ds_read_b128 v[92:95], v8 offset:14336
  ds_read_b128 v[96:99], v8 offset:28672
  ds_read_b128 v[100:103], v8 offset:43008
  ds_read_b128 v[104:107], v8 offset:1024
  ds_read_b128 v[108:111], v8 offset:15360
  ds_read_b128 v[112:115], v8 offset:29696
  ds_read_b128 v[116:119], v8 offset:44032
  s_waitcnt vmcnt(17)
  s_waitcnt lgkmcnt(7)
  v_mfma_f32_16x16x32_bf16 v[72:75], v[16:19], v[88:91], 0
  s_waitcnt lgkmcnt(6)
  v_mfma_f32_16x16x32_bf16 v[76:79], v[16:19], v[92:95], 0
  s_waitcnt lgkmcnt(5)
  v_mfma_f32_16x16x32_bf16 v[80:83], v[16:19], v[96:99], 0
  s_waitcnt lgkmcnt(4)
  v_mfma_f32_16x16x32_bf16 v[84:87], v[16:19], v[100:103], 0
  s_barrier
  ds_read_b128 v[88:91], v8 offset:2048
  ds_read_b128 v[92:95], v8 offset:16384
  ds_read_b128 v[96:99], v8 offset:30720
  ds_read_b128 v[100:103], v8 offset:45056
  s_waitcnt vmcnt(16)
  s_waitcnt lgkmcnt(7)
  v_mfma_f32_16x16x32_bf16 v[72:75], v[20:23], v[104:107], v[72:75]
  s_waitcnt lgkmcnt(6)
  v_mfma_f32_16x16x32_bf16 v[76:79], v[20:23], v[108:111], v[76:79]
  s_waitcnt lgkmcnt(5)
  v_mfma_f32_16x16x32_bf16 v[80:83], v[20:23], v[112:115], v[80:83]
  s_waitcnt lgkmcnt(4)
  v_mfma_f32_16x16x32_bf16 v[84:87], v[20:23], v[116:119], v[84:87]
  ds_read_b128 v[104:107], v8 offset:3072
  ds_read_b128 v[108:111], v8 offset:17408
  ds_read_b128 v[112:115], v8 offset:31744
  ds_read_b128 v[116:119], v8 offset:46080
  s_waitcnt vmcnt(15)
  s_waitcnt lgkmcnt(7)
  v_mfma_f32_16x16x32_bf16 v[72:75], v[24:27], v[88:91], v[72:75]
  s_waitcnt lgkmcnt(6)
  v_mfma_f32_16x16x32_bf16 v[76:79], v[24:27], v[92:95], v[76:79]
  s_waitcnt lgkmcnt(5)
  v_mfma_f32_16x16x32_bf16 v[80:83], v[24:27], v[96:99], v[80:83]
  s_waitcnt lgkmcnt(4)
  v_mfma_f32_16x16x32_bf16 v[84:87], v[24:27], v[100:103], v[84:87]
  s_barrier
  ds_read_b128 v[88:91], v8 offset:4096
  ds_read_b128 v[92:95], v8 offset:18432
  ds_read_b128 v[96:99], v8 offset:32768
  ds_read_b128 v[100:103], v8 offset:47104
  s_waitcnt vmcnt(14)
  s_waitcnt lgkmcnt(7)
  v_mfma_f32_16x16x32_bf16 v[72:75], v[28:31], v[104:107], v[72:75]
  s_waitcnt lgkmcnt(6)
  v_mfma_f32_16x16x32_bf16 v[76:79], v[28:31], v[108:111], v[76:79]
  s_waitcnt lgkmcnt(5)
  v_mfma_f32_16x16x32_bf16 v[80:83], v[28:31], v[112:115], v[80:83]
  s_waitcnt lgkmcnt(4)
  v_mfma_f32_16x16x32_bf16 v[84:87], v[28:31], v[116:119], v[84:87]
  ds_read_b128 v[104:107], v8 offset:5120
  ds_read_b128 v[108:111], v8 offset:19456
  ds_read_b128 v[112:115], v8 offset:33792
  ds_read_b128 v[116:119], v8 offset:48128
  s_waitcnt vmcnt(13)
  s_waitcnt lgkmcnt(7)
  v_mfma_f32_16x16x32_bf16 v[72:75], v[32:35], v[88:91], v[72:75]
  s_waitcnt lgkmcnt(6)
  v_mfma_f32_16x16x32_bf16 v[76:79], v[32:35], v[92:95], v[76:79]
  s_waitcnt lgkmcnt(5)
  v_mfma_f32_16x16x32_bf16 v[80:83], v[32:35], v[96:99], v[80:83]
  s_waitcnt lgkmcnt(4)
  v_mfma_f32_16x16x32_bf16 v[84:87], v[32:35], v[100:103], v[84:87]
  s_barrier
  ds_read_b128 v[88:91], v8 offset:6144
  ds_read_b128 v[92:95], v8 offset:20480
  ds_read_b128 v[96:99], v8 offset:34816
  ds_read_b128 v[100:103], v8 offset:49152
  s_waitcnt vmcnt(12)
  s_waitcnt lgkmcnt(7)
  v_mfma_f32_16x16x32_bf16 v[72:75], v[36:39], v[104:107], v[72:75]
  s_waitcnt lgkmcnt(6)
  v_mfma_f32_16x16x32_bf16 v[76:79], v[36:39], v[108:111], v[76:79]
  s_waitcnt lgkmcnt(5)
  v_mfma_f32_16x16x32_bf16 v[80:83], v[36:39], v[112:115], v[80:83]
  s_waitcnt lgkmcnt(4)
  v_mfma_f32_16x16x32_bf16 v[84:87], v[36:39], v[116:119], v[84:87]
  ds_read_b128 v[104:107], v8 offset:7168
  ds_read_b128 v[108:111], v8 offset:21504
  ds_read_b128 v[112:115], v8 offset:35840
  ds_read_b128 v[116:119], v8 offset:50176
  s_waitcnt vmcnt(11)
  s_waitcnt lgkmcnt(7)
  v_mfma_f32_16x16x32_bf16 v[72:75], v[40:43], v[88:91], v[72:75]
  s_waitcnt lgkmcnt(6)
  v_mfma_f32_16x16x32_bf16 v[76:79], v[40:43], v[92:95], v[76:79]
  s_waitcnt lgkmcnt(5)
  v_mfma_f32_16x16x32_bf16 v[80:83], v[40:43], v[96:99], v[80:83]
  s_waitcnt lgkmcnt(4)
  v_mfma_f32_16x16x32_bf16 v[84:87], v[40:43], v[100:103], v[84:87]
  s_barrier
  ds_read_b128 v[88:91], v8 offset:8192
  ds_read_b128 v[92:95], v8 offset:22528
  ds_read_b128 v[96:99], v8 offset:36864
  ds_read_b128 v[100:103], v8 offset:51200
  s_waitcnt vmcnt(10)
  s_waitcnt lgkmcnt(7)
  v_mfma_f32_16x16x32_bf16 v[72:75], v[44:47], v[104:107], v[72:75]
  s_waitcnt lgkmcnt(6)
  v_mfma_f32_16x16x32_bf16 v[76:79], v[44:47], v[108:111], v[76:79]
  s_waitcnt lgkmcnt(5)
  v_mfma_f32_16x16x32_bf16 v[80:83], v[44:47], v[112:115], v[80:83]
  s_waitcnt lgkmcnt(4)
  v_mfma_f32_16x16x32_bf16 v[84:87], v[44:47], v[116:119], v[84:87]
  ds_read_b128 v[104:107], v8 offset:9216
  ds_read_b128 v[108:111], v8 offset:23552
  ds_read_b128 v[112:115], v8 offset:37888
  ds_read_b128 v[116:119], v8 offset:52224
  s_waitcnt vmcnt(9)
  s_waitcnt lgkmcnt(7)
  v_mfma_f32_16x16x32_bf16 v[72:75], v[48:51], v[88:91], v[72:75]
  s_waitcnt lgkmcnt(6)
  v_mfma_f32_16x16x32_bf16 v[76:79], v[48:51], v[92:95], v[76:79]
  s_waitcnt lgkmcnt(5)
  v_mfma_f32_16x16x32_bf16 v[80:83], v[48:51], v[96:99], v[80:83]
  s_waitcnt lgkmcnt(4)
  v_mfma_f32_16x16x32_bf16 v[84:87], v[48:51], v[100:103], v[84:87]
  s_barrier
  ds_read_b128 v[88:91], v8 offset:10240
  ds_read_b128 v[92:95], v8 offset:24576
  ds_read_b128 v[96:99], v8 offset:38912
  ds_read_b128 v[100:103], v8 offset:53248
  s_waitcnt vmcnt(8)
  s_waitcnt lgkmcnt(7)
  v_mfma_f32_16x16x32_bf16 v[72:75], v[52:55], v[104:107], v[72:75]
  s_waitcnt lgkmcnt(6)
  v_mfma_f32_16x16x32_bf16 v[76:79], v[52:55], v[108:111], v[76:79]
  s_waitcnt lgkmcnt(5)
  v_mfma_f32_16x16x32_bf16 v[80:83], v[52:55], v[112:115], v[80:83]
  s_waitcnt lgkmcnt(4)
  v_mfma_f32_16x16x32_bf16 v[84:87], v[52:55], v[116:119], v[84:87]
  ds_read_b128 v[104:107], v8 offset:11264
  ds_read_b128 v[108:111], v8 offset:25600
  ds_read_b128 v[112:115], v8 offset:39936
  ds_read_b128 v[116:119], v8 offset:54272
  s_waitcnt vmcnt(7)
  s_waitcnt lgkmcnt(7)
  v_mfma_f32_16x16x32_bf16 v[72:75], v[56:59], v[88:91], v[72:75]
  s_waitcnt lgkmcnt(6)
  v_mfma_f32_16x16x32_bf16 v[76:79], v[56:59], v[92:95], v[76:79]
  s_waitcnt lgkmcnt(5)
  v_mfma_f32_16x16x32_bf16 v[80:83], v[56:59], v[96:99], v[80:83]
  s_waitcnt lgkmcnt(4)
  v_mfma_f32_16x16x32_bf16 v[84:87], v[56:59], v[100:103], v[84:87]
  s_barrier
  ds_read_b128 v[88:91], v8 offset:12288
  ds_read_b128 v[92:95], v8 offset:26624
  ds_read_b128 v[96:99], v8 offset:40960
  ds_read_b128 v[100:103], v8 offset:55296
  s_waitcnt vmcnt(6)
  s_waitcnt lgkmcnt(7)
  v_mfma_f32_16x16x32_bf16 v[72:75], v[60:63], v[104:107], v[72:75]
  s_waitcnt lgkmcnt(6)
  v_mfma_f32_16x16x32_bf16 v[76:79], v[60:63], v[108:111], v[76:79]
  s_waitcnt lgkmcnt(5)
  v_mfma_f32_16x16x32_bf16 v[80:83], v[60:63], v[112:115], v[80:83]
  s_waitcnt lgkmcnt(4)
  v_mfma_f32_16x16x32_bf16 v[84:87], v[60:63], v[116:119], v[84:87]
  ds_read_b128 v[104:107], v8 offset:13312
  ds_read_b128 v[108:111], v8 offset:27648
  ds_read_b128 v[112:115], v8 offset:41984
  ds_read_b128 v[116:119], v8 offset:56320
  s_waitcnt vmcnt(5)
  s_waitcnt lgkmcnt(7)
  v_mfma_f32_16x16x32_bf16 v[72:75], v[64:67], v[88:91], v[72:75]
  s_waitcnt lgkmcnt(6)
  v_mfma_f32_16x16x32_bf16 v[76:79], v[64:67], v[92:95], v[76:79]
  s_waitcnt lgkmcnt(5)
  v_mfma_f32_16x16x32_bf16 v[80:83], v[64:67], v[96:99], v[80:83]
  s_waitcnt lgkmcnt(4)
  v_mfma_f32_16x16x32_bf16 v[84:87], v[64:67], v[100:103], v[84:87]
  s_waitcnt vmcnt(4)
  s_waitcnt lgkmcnt(3)
  v_mfma_f32_16x16x32_bf16 v[72:75], v[68:71], v[104:107], v[72:75]
  s_waitcnt lgkmcnt(2)
  v_mfma_f32_16x16x32_bf16 v[76:79], v[68:71], v[108:111], v[76:79]
  s_waitcnt lgkmcnt(1)
  v_mfma_f32_16x16x32_bf16 v[80:83], v[68:71], v[112:115], v[80:83]
  s_waitcnt lgkmcnt(0)
  v_mfma_f32_16x16x32_bf16 v[84:87], v[68:71], v[116:119], v[84:87]
  s_nop 7
  ds_write_b128 v6, v[72:75] offset:0
  ds_write_b128 v6, v[76:79] offset:1024
  ds_write_b128 v6, v[80:83] offset:2048
  ds_write_b128 v6, v[84:87] offset:3072
  s_waitcnt lgkmcnt(0)
  s_barrier
k3_end:
  s_endpgm
k3_code_end:
.section .rodata,"a"
.set TC_0, 0x3f80
.set TC_1, 0x3f80
.set TC_2, 0x3f80
.set TC_3, 0x3f80
.set TC_4, 0x3f80
.set TC_5, 0x3f7f
.set TC_6, 0x3f7f
.set TC_7, 0x3f7f
.set TC_8, 0x3f7e
.set TC_9, 0x3f7e
.set TC_10, 0x3f7d
.set TC_11, 0x3f7d
.set TC_12, 0x3f7c
.set TC_13, 0x3f7c
.set TC_14, 0x3f7b
.set TC_15, 0x3f7a
.set TC_16, 0x3f7a
.set TC_17, 0x3f79
.set TC_18, 0x3f78
.set TC_19, 0x3f77
.set TC_20, 0x3f76
.set TC_21, 0x3f75
.set TC_22, 0x3f74
.set TC_23, 0x3f73
.set TC_24, 0x3f72
.set TC_25, 0x3f70
.set TC_26, 0x3f6f
.set TC_27, 0x3f6e
.set TC_28, 0x3f6d
.set TC_29, 0x3f6b
.set TC_30, 0x3f6a
.set TC_31, 0x3f68
.set TC_32, 0x3f67
.set TC_33, 0x3f65
.set TC_34, 0x3f63
.set TC_35, 0x3f62
.set TC_36, 0x3f60
.set TC_37, 0x3f5e
.set TC_38, 0x3f5c
.set TC_39, 0x3f5b
.set TC_40, 0x3f59
.set TC_41, 0x3f57
.set TC_42, 0x3f55
.set TC_43, 0x3f53
.set TC_44, 0x3f51
.set TC_45, 0x3f4f
.set TC_46, 0x3f4d
.set TC_47, 0x3f4a
.set TC_48, 0x3f48
.set TC_49, 0x3f46
.set TC_50, 0x3f44
.set TC_51, 0x3f41
.set TC_52, 0x3f3f
.set TC_53, 0x3f3c
.set TC_54, 0x3f3a
.set TC_55, 0x3f38
.set TC_56, 0x3f35
.set TC_57, 0x3f32
.set TC_58, 0x3f30
.set TC_59, 0x3f2d
.set TC_60, 0x3f2b
.set TC_61, 0x3f28
.set TC_62, 0x3f25
.set TC_63, 0x3f22
.set TC_64, 0x3f20
.set TC_65, 0x3f1d
.set TC_66, 0x3f1a
.set TC_67, 0x3f17
.set TC_68, 0x3f14
.set TC_69, 0x3f11
.set TC_70, 0x3f0e
.set TC_71, 0x3f0b
.set TC_72, 0x3f08
.set TC_73, 0x3f05
.set TC_74, 0x3f02
.set TC_75, 0x3efe
.set TC_76, 0x3ef8
.set TC_77, 0x3ef1
.set TC_78, 0x3eeb
.set TC_79, 0x3ee5
.set TC_80, 0x3ede
.set TC_81, 0x3ed8
.set TC_82, 0x3ed1
.set TC_83, 0x3ecb
.set TC_84, 0x3ec4
.set TC_85, 0x3ebd
.set TC_86, 0x3eb7
.set TC_87, 0x3eb0
.set TC_88, 0x3ea9
.set TC_89, 0x3ea2
.set TC_90, 0x3e9b
.set TC_91, 0x3e95
.set TC_92, 0x3e8e
.set TC_93, 0x3e87
.set TC_94, 0x3e80
.set TC_95, 0x3e72
.set TC_96, 0x3e64
.set TC_97, 0x3e56
.set TC_98, 0x3e48
.set TC_99, 0x3e3a
.set TC_100, 0x3e2c
.set TC_101, 0x3e1d
.set TC_102, 0x3e0f
.set TC_103, 0x3e01
.set TC_104, 0x3de5
.set TC_105, 0x3dc9
.set TC_106, 0x3dac
.set TC_107, 0x3d8f
.set TC_108, 0x3d66
.set TC_109, 0x3d2c
.set TC_110, 0x3ce6
.set TC_111, 0x3c66
.set TC_112, 0x248d
.set TC_113, 0xbc66
.set TC_114, 0xbce6
.set TC_115, 0xbd2c
.set TC_116, 0xbd66
.set TC_117, 0xbd8f
.set TC_118, 0xbdac
.set TC_119, 0xbdc9
.set TC_120, 0xbde5
.set TC_121, 0xbe01
.set TC_122, 0xbe0f
.set TC_123, 0xbe1d
.set TC_124, 0xbe2c
.set TC_125, 0xbe3a
.set TC_126, 0xbe48
.set TC_127, 0xbe56
.set TC_128, 0xbe64
.set TC_129, 0xbe72
.set TC_130, 0xbe80
.set TC_131, 0xbe87
.set TC_132, 0xbe8e
.set TC_133, 0xbe95
.set TC_134, 0xbe9b
.set TC_135, 0xbea2
.set TC_136, 0xbea9
.set TC_137, 0xbeb0
.set TC_138, 0xbeb7
.set TC_139, 0xbebd
.set TC_140, 0xbec4
.set TC_141, 0xbecb
.set TC_142, 0xbed1
.set TC_143, 0xbed8
.set TC_144, 0xbede
.set TC_145, 0xbee5
.set TC_146, 0xbeeb
.set TC_147, 0xbef1
.set TC_148, 0xbef8
.set TC_149, 0xbefe
.set TC_150, 0xbf02
.set TC_151, 0xbf05
.set TC_152, 0xbf08
.set TC_153, 0xbf0b
.set TC_154, 0xbf0e
.set TC_155, 0xbf11
.set TC_156, 0xbf14
.set TC_157, 0xbf17
.set TC_158, 0xbf1a
.set TC_159, 0xbf1d
.set TC_160, 0xbf20
.set TC_161, 0xbf22
.set TC_162, 0xbf25
.set TC_163, 0xbf28
.set TC_164, 0xbf2b
.set TC_165, 0xbf2d
.set TC_166, 0xbf30
.set TC_167, 0xbf32
.set TC_168, 0xbf35
.set TC_169, 0xbf38
.set TC_170, 0xbf3a
.set TC_171, 0xbf3c
.set TC_172, 0xbf3f
.set TC_173, 0xbf41
.set TC_174, 0xbf44
.set TC_175, 0xbf46
.set TC_176, 0xbf48
.set TC_177, 0xbf4a
.set TC_178, 0xbf4d
.set TC_179, 0xbf4f
.set TC_180, 0xbf51
.set TC_181, 0xbf53
.set TC_182, 0xbf55
.set TC_183, 0xbf57
.set TC_184, 0xbf59
.set TC_185, 0xbf5b
.set TC_186, 0xbf5c
.set TC_187, 0xbf5e
.set TC_188, 0xbf60
.set TC_189, 0xbf62
.set TC_190, 0xbf63
.set TC_191, 0xbf65
.set TC_192, 0xbf67
.set TC_193, 0xbf68
.set TC_194, 0xbf6a
.set TC_195, 0xbf6b
.set TC_196, 0xbf6d
.set TC_197, 0xbf6e
.set TC_198, 0xbf6f
.set TC_199, 0xbf70
.set TC_200, 0xbf72
.set TC_201, 0xbf73
.set TC_202, 0xbf74
.set TC_203, 0xbf75
.set TC_204, 0xbf76
.set TC_205, 0xbf77
.set TC_206, 0xbf78
.set TC_207, 0xbf79
.set TC_208, 0xbf7a
.set TC_209, 0xbf7a
.set TC_210, 0xbf7b
.set TC_211, 0xbf7c
.set TC_212, 0xbf7c
.set TC_213, 0xbf7d
.set TC_214, 0xbf7d
.set TC_215, 0xbf7e
.set TC_216, 0xbf7e
.set TC_217, 0xbf7f
.set TC_218, 0xbf7f
.set TC_219, 0xbf7f
.set TC_220, 0xbf80
.set TC_221, 0xbf80
.set TC_222, 0xbf80
.set TC_223, 0xbf80
.set TC_224, 0xbf80
.set TC_225, 0xbf80
.set TC_226, 0xbf80
.set TC_227, 0xbf80
.set TC_228, 0xbf80
.set TC_229, 0xbf7f
.set TC_230, 0xbf7f
.set TC_231, 0xbf7f
.set TC_232, 0xbf7e
.set TC_233, 0xbf7e
.set TC_234, 0xbf7d
.set TC_235, 0xbf7d
.set TC_236, 0xbf7c
.set TC_237, 0xbf7c
.set TC_238, 0xbf7b
.set TC_239, 0xbf7a
.set TC_240, 0xbf7a
.set TC_241, 0xbf79
.set TC_242, 0xbf78
.set TC_243, 0xbf77
.set TC_244, 0xbf76
.set TC_245, 0xbf75
.set TC_246, 0xbf74
.set TC_247, 0xbf73
.set TC_248, 0xbf72
.set TC_249, 0xbf70
.set TC_250, 0xbf6f
.set TC_251, 0xbf6e
.set TC_252, 0xbf6d
.set TC_253, 0xbf6b
.set TC_254, 0xbf6a
.set TC_255, 0xbf68
.set TC_256, 0xbf67
.set TC_257, 0xbf65
.set TC_258, 0xbf63
.set TC_259, 0xbf62
.set TC_260, 0xbf60
.set TC_261, 0xbf5e
.set TC_262, 0xbf5c
.set TC_263, 0xbf5b
.set TC_264, 0xbf59
.set TC_265, 0xbf57
.set TC_266, 0xbf55
.set TC_267, 0xbf53
.set TC_268, 0xbf51
.set TC_269, 0xbf4f
.set TC_270, 0xbf4d
.set TC_271, 0xbf4a
.set TC_272, 0xbf48
.set TC_273, 0xbf46
.set TC_274, 0xbf44
.set TC_275, 0xbf41
.set TC_276, 0xbf3f
.set TC_277, 0xbf3c
.set TC_278, 0xbf3a
.set TC_279, 0xbf38
.set TC_280, 0xbf35
.set TC_281, 0xbf32
.set TC_282, 0xbf30
.set TC_283, 0xbf2d
.set TC_284, 0xbf2b
.set TC_285, 0xbf28
.set TC_286, 0xbf25
.set TC_287, 0xbf22
.set TC_288, 0xbf20
.set TC_289, 0xbf1d
.set TC_290, 0xbf1a
.set TC_291, 0xbf17
.set TC_292, 0xbf14
.set TC_293, 0xbf11
.set TC_294, 0xbf0e
.set TC_295, 0xbf0b
.set TC_296, 0xbf08
.set TC_297, 0xbf05
.set TC_298, 0xbf02
.set TC_299, 0xbefe
.set TC_300, 0xbef8
.set TC_301, 0xbef1
.set TC_302, 0xbeeb
.set TC_303, 0xbee5
.set TC_304, 0xbede
.set TC_305, 0xbed8
.set TC_306, 0xbed1
.set TC_307, 0xbecb
.set TC_308, 0xbec4
.set TC_309, 0xbebd
.set TC_310, 0xbeb7
.set TC_311, 0xbeb0
.set TC_312, 0xbea9
.set TC_313, 0xbea2
.set TC_314, 0xbe9b
.set TC_315, 0xbe95
.set TC_316, 0xbe8e
.set TC_317, 0xbe87
.set TC_318, 0xbe80
.set TC_319, 0xbe72
.set TC_320, 0xbe64
.set TC_321, 0xbe56
.set TC_322, 0xbe48
.set TC_323, 0xbe3a
.set TC_324, 0xbe2c
.set TC_325, 0xbe1d
.set TC_326, 0xbe0f
.set TC_327, 0xbe01
.set TC_328, 0xbde5
.set TC_329, 0xbdc9
.set TC_330, 0xbdac
.set TC_331, 0xbd8f
.set TC_332, 0xbd66
.set TC_333, 0xbd2c
.set TC_334, 0xbce6
.set TC_335, 0xbc66
.set TC_336, 0xa554
.set TC_337, 0x3c66
.set TC_338, 0x3ce6
.set TC_339, 0x3d2c
.set TC_340, 0x3d66
.set TC_341, 0x3d8f
.set TC_342, 0x3dac
.set TC_343, 0x3dc9
.set TC_344, 0x3de5
.set TC_345, 0x3e01
.set TC_346, 0x3e0f
.set TC_347, 0x3e1d
.set TC_348, 0x3e2c
.set TC_349, 0x3e3a
.set TC_350, 0x3e48
.set TC_351, 0x3e56
.set TC_352, 0x3e64
.set TC_353, 0x3e72
.set TC_354, 0x3e80
.set TC_355, 0x3e87
.set TC_356, 0x3e8e
.set TC_357, 0x3e95
.set TC_358, 0x3e9b
.set TC_359, 0x3ea2
.set TC_360, 0x3ea9
.set TC_361, 0x3eb0
.set TC_362, 0x3eb7
.set TC_363, 0x3ebd
.set TC_364, 0x3ec4
.set TC_365, 0x3ecb
.set TC_366, 0x3ed1
.set TC_367, 0x3ed8
.set TC_368, 0x3ede
.set TC_369, 0x3ee5
.set TC_370, 0x3eeb
.set TC_371, 0x3ef1
.set TC_372, 0x3ef8
.set TC_373, 0x3efe
.set TC_374, 0x3f02
.set TC_375, 0x3f05
.set TC_376, 0x3f08
.set TC_377, 0x3f0b
.set TC_378, 0x3f0e
.set TC_379, 0x3f11
.set TC_380, 0x3f14
.set TC_381, 0x3f17
.set TC_382, 0x3f1a
.set TC_383, 0x3f1d
.set TC_384, 0x3f20
.set TC_385, 0x3f22
.set TC_386, 0x3f25
.set TC_387, 0x3f28
.set TC_388, 0x3f2b
.set TC_389, 0x3f2d
.set TC_390, 0x3f30
.set TC_391, 0x3f32
.set TC_392, 0x3f35
.set TC_393, 0x3f38
.set TC_394, 0x3f3a
.set TC_395, 0x3f3c
.set TC_396, 0x3f3f
.set TC_397, 0x3f41
.set TC_398, 0x3f44
.set TC_399, 0x3f46
.set TC_400, 0x3f48
.set TC_401, 0x3f4a
.set TC_402, 0x3f4d
.set TC_403, 0x3f4f
.set TC_404, 0x3f51
.set TC_405, 0x3f53
.set TC_406, 0x3f55
.set TC_407, 0x3f57
.set TC_408, 0x3f59
.set TC_409, 0x3f5b
.set TC_410, 0x3f5c
.set TC_411, 0x3f5e
.set TC_412, 0x3f60
.set TC_413, 0x3f62
.set TC_414, 0x3f63
.set TC_415, 0x3f65
.set TC_416, 0x3f67
.set TC_417, 0x3f68
.set TC_418, 0x3f6a
.set TC_419, 0x3f6b
.set TC_420, 0x3f6d
.set TC_421, 0x3f6e
.set TC_422, 0x3f6f
.set TC_423, 0x3f70
.set TC_424, 0x3f72
.set TC_425, 0x3f73
.set TC_426, 0x3f74
.set TC_427, 0x3f75
.set TC_428, 0x3f76
.set TC_429, 0x3f77
.set TC_430, 0x3f78
.set TC_431, 0x3f79
.set TC_432, 0x3f7a
.set TC_433, 0x3f7a
.set TC_434, 0x3f7b
.set TC_435, 0x3f7c
.set TC_436, 0x3f7c
.set TC_437, 0x3f7d
.set TC_438, 0x3f7d
.set TC_439, 0x3f7e
.set TC_440, 0x3f7e
.set TC_441, 0x3f7f
.set TC_442, 0x3f7f
.set TC_443, 0x3f7f
.set TC_444, 0x3f80
.set TC_445, 0x3f80
.set TC_446, 0x3f80
.set TC_447, 0x3f80
.set TG_0, 0x3612
.set TG_1, 0x3612
.set TG_2, 0x3612
.set TG_3, 0x3612
.set TG_4, 0x3612
.set TG_5, 0x3612
.set TG_6, 0x3612
.set TG_7, 0x3612
.set TG_8, 0x3611
.set TG_9, 0x3611
.set TG_10, 0x3611
.set TG_11, 0x3611
.set TG_12, 0x3610
.set TG_13, 0x3610
.set TG_14, 0x360f
.set TG_15, 0x360f
.set TG_16, 0x360f
.set TG_17, 0x360e
.set TG_18, 0x360e
.set TG_19, 0x360d
.set TG_20, 0x360d
.set TG_21, 0x360c
.set TG_22, 0x360b
.set TG_23, 0x360b
.set TG_24, 0x360a
.set TG_25, 0x3609
.set TG_26, 0x3609
.set TG_27, 0x3608
.set TG_28, 0x3607
.set TG_29, 0x3606
.set TG_30, 0x3606
.set TG_31, 0x3605
.set TG_32, 0x3604
.set TG_33, 0x3603
.set TG_34, 0x3602
.set TG_35, 0x3601
.set TG_36, 0x3600
.set TG_37, 0x35fe
.set TG_38, 0x35fc
.set TG_39, 0x35fa
.set TG_40, 0x35f8
.set TG_41, 0x35f6
.set TG_42, 0x35f3
.set TG_43, 0x35f1
.set TG_44, 0x35ef
.set TG_45, 0x35ec
.set TG_46, 0x35ea
.set TG_47, 0x35e7
.set TG_48, 0x35e5
.set TG_49, 0x35e2
.set TG_50, 0x35e0
.set TG_51, 0x35dd
.set TG_52, 0x35da
.set TG_53, 0x35d7
.set TG_54, 0x35d5
.set TG_55, 0x35d2
.set TG_56, 0x35cf
.set TG_57, 0x35cc
.set TG_58, 0x35c9
.set TG_59, 0x35c6
.set TG_60, 0x35c3
.set TG_61, 0x35c0
.set TG_62, 0x35bd
.set TG_63, 0x35ba
.set TG_64, 0x35b6
.set TG_65, 0x35b3
.set TG_66, 0x35b0
.set TG_67, 0x35ad
.set TG_68, 0x35a9
.set TG_69, 0x35a6
.set TG_70, 0x35a3
.set TG_71, 0x359f
.set TG_72, 0x359c
.set TG_73, 0x3598
.set TG_74, 0x3595
.set TG_75, 0x3591
.set TG_76, 0x358e
.set TG_77, 0x358a
.set TG_78, 0x3586
.set TG_79, 0x3583
.set TG_80, 0x357e
.set TG_81, 0x3576
.set TG_82, 0x356f
.set TG_83, 0x3567
.set TG_84, 0x3560
.set TG_85, 0x3558
.set TG_86, 0x3551
.set TG_87, 0x3549
.set TG_88, 0x3541
.set TG_89, 0x3539
.set TG_90, 0x3532
.set TG_91, 0x352a
.set TG_92, 0x3522
.set TG_93, 0x351a
.set TG_94, 0x3512
.set TG_95, 0x350a
.set TG_96, 0x3502
.set TG_97, 0x34f4
.set TG_98, 0x34e4
.set TG_99, 0x34d4
.set TG_100, 0x34c4
.set TG_101, 0x34b4
.set TG_102, 0x34a4
.set TG_103, 0x3493
.set TG_104, 0x3483
.set TG_105, 0x3465
.set TG_106, 0x3445
.set TG_107, 0x3424
.set TG_108, 0x3403
.set TG_109, 0x33c5
.set TG_110, 0x3383
.set TG_111, 0x3303
.set TG_112, 0x1b21
.set TG_113, 0xb303
.set TG_114, 0xb383
.set TG_115, 0xb3c5
.set TG_116, 0xb403
.set TG_117, 0xb424
.set TG_118, 0xb445
.set TG_119, 0xb465
.set TG_120, 0xb483
.set TG_121, 0xb493
.set TG_122, 0xb4a4
.set TG_123, 0xb4b4
.set TG_124, 0xb4c4
.set TG_125, 0xb4d4
.set TG_126, 0xb4e4
.set TG_127, 0xb4f4
.set TG_128, 0xb502
.set TG_129, 0xb50a
.set TG_130, 0xb512
.set TG_131, 0xb51a
.set TG_132, 0xb522
.set TG_133, 0xb52a
.set TG_134, 0xb532
.set TG_135, 0xb539
.set TG_136, 0xb541
.set TG_137, 0xb549
.set TG_138, 0xb551
.set TG_139, 0xb558
.set TG_140, 0xb560
.set TG_141, 0xb567
.set TG_142, 0xb56f
.set TG_143, 0xb576
.set TG_144, 0xb57e
.set TG_145, 0xb583
.set TG_146, 0xb586
.set TG_147, 0xb58a
.set TG_148, 0xb58e
.set TG_149, 0xb591
.set TG_150, 0xb595
.set TG_151, 0xb598
.set TG_152, 0xb59c
.set TG_153, 0xb59f
.set TG_154, 0xb5a3
.set TG_155, 0xb5a6
.set TG_156, 0xb5a9
.set TG_157, 0xb5ad
.set TG_158, 0xb5b0
.set TG_159, 0xb5b3
.set TG_160, 0xb5b6
.set TG_161, 0xb5ba
.set TG_162, 0xb5bd
.set TG_163, 0xb5c0
.set TG_164, 0xb5c3
.set TG_165, 0xb5c6
.set TG_166, 0xb5c9
.set TG_167, 0xb5cc
.set TG_168, 0xb5cf
.set TG_169, 0xb5d2
.set TG_170, 0xb5d5
.set TG_171, 0xb5d7
.set TG_172, 0xb5da
.set TG_173, 0xb5dd
.set TG_174, 0xb5e0
.set TG_175, 0xb5e2
.set TG_176, 0xb5e5
.set TG_177, 0xb5e7
.set TG_178, 0xb5ea
.set TG_179, 0xb5ec
.set TG_180, 0xb5ef
.set TG_181, 0xb5f1
.set TG_182, 0xb5f3
.set TG_183, 0xb5f6
.set TG_184, 0xb5f8
.set TG_185, 0xb5fa
.set TG_186, 0xb5fc
.set TG_187, 0xb5fe
.set TG_188, 0xb600
.set TG_189, 0xb601
.set TG_190, 0xb602
.set TG_191, 0xb603
.set TG_192, 0xb604
.set TG_193, 0xb605
.set TG_194, 0xb606
.set TG_195, 0xb606
.set TG_196, 0xb607
.set TG_197, 0xb608
.set TG_198, 0xb609
.set TG_199, 0xb609
.set TG_200, 0xb60a
.set TG_201, 0xb60b
.set TG_202, 0xb60b
.set TG_203, 0xb60c
.set TG_204, 0xb60d
.set TG_205, 0xb60d
.set TG_206, 0xb60e
.set TG_207, 0xb60e
.set TG_208, 0xb60f
.set TG_209, 0xb60f
.set TG_210, 0xb60f
.set TG_211, 0xb610
.set TG_212, 0xb610
.set TG_213, 0xb611
.set TG_214, 0xb611
.set TG_215, 0xb611
.set TG_216, 0xb611
.set TG_217, 0xb612
.set TG_218, 0xb612
.set TG_219, 0xb612
.set TG_220, 0xb612
.set TG_221, 0xb612
.set TG_222, 0xb612
.set TG_223, 0xb612
.set TG_224, 0xb612
.set TG_225, 0xb612
.set TG_226, 0xb612
.set TG_227, 0xb612
.set TG_228, 0xb612
.set TG_229, 0xb612
.set TG_230, 0xb612
.set TG_231, 0xb612
.set TG_232, 0xb611
.set TG_233, 0xb611
.set TG_234, 0xb611
.set TG_235, 0xb611
.set TG_236, 0xb610
.set TG_237, 0xb610
.set TG_238, 0xb60f
.set TG_239, 0xb60f
.set TG_240, 0xb60f
.set TG_241, 0xb60e
.set TG_242, 0xb60e
.set TG_243, 0xb60d
.set TG_244, 0xb60d
.set TG_245, 0xb60c
.set TG_246, 0xb60b
.set TG_247, 0xb60b
.set TG_248, 0xb60a
.set TG_249, 0xb609
.set TG_250, 0xb609
.set TG_251, 0xb608
.set TG_252, 0xb607
.set TG_253, 0xb606
.set TG_254, 0xb606
.set TG_255, 0xb605
.set TG_256, 0xb604
.set TG_257, 0xb603
.set TG_258, 0xb602
.set TG_259, 0xb601
.set TG_260, 0xb600
.set TG_261, 0xb5fe
.set TG_262, 0xb5fc
.set TG_263, 0xb5fa
.set TG_264, 0xb5f8
.set TG_265, 0xb5f6
.set TG_266, 0xb5f3
.set TG_267, 0xb5f1
.set TG_268, 0xb5ef
.set TG_269, 0xb5ec
.set TG_270, 0xb5ea
.set TG_271, 0xb5e7
.set TG_272, 0xb5e5
.set TG_273, 0xb5e2
.set TG_274, 0xb5e0
.set TG_275, 0xb5dd
.set TG_276, 0xb5da
.set TG_277, 0xb5d7
.set TG_278, 0xb5d5
.set TG_279, 0xb5d2
.set TG_280, 0xb5cf
.set TG_281, 0xb5cc
.set TG_282, 0xb5c9
.set TG_283, 0xb5c6
.set TG_284, 0xb5c3
.set TG_285, 0xb5c0
.set TG_286, 0xb5bd
.set TG_287, 0xb5ba
.set TG_288, 0xb5b6
.set TG_289, 0xb5b3
.set TG_290, 0xb5b0
.set TG_291, 0xb5ad
.set TG_292, 0xb5a9
.set TG_293, 0xb5a6
.set TG_294, 0xb5a3
.set TG_295, 0xb59f
.set TG_296, 0xb59c
.set TG_297, 0xb598
.set TG_298, 0xb595
.set TG_299, 0xb591
.set TG_300, 0xb58e
.set TG_301, 0xb58a
.set TG_302, 0xb586
.set TG_303, 0xb583
.set TG_304, 0xb57e
.set TG_305, 0xb576
.set TG_306, 0xb56f
.set TG_307, 0xb567
.set TG_308, 0xb560
.set TG_309, 0xb558
.set TG_310, 0xb551
.set TG_311, 0xb549
.set TG_312, 0xb541
.set TG_313, 0xb539
.set TG_314, 0xb532
.set TG_315, 0xb52a
.set TG_316, 0xb522
.set TG_317, 0xb51a
.set TG_318, 0xb512
.set TG_319, 0xb50a
.set TG_320, 0xb502
.set TG_321, 0xb4f4
.set TG_322, 0xb4e4
.set TG_323, 0xb4d4
.set TG_324, 0xb4c4
.set TG_325, 0xb4b4
.set TG_326, 0xb4a4
.set TG_327, 0xb493
.set TG_328, 0xb483
.set TG_329, 0xb465
.set TG_330, 0xb445
.set TG_331, 0xb424
.set TG_332, 0xb403
.set TG_333, 0xb3c5
.set TG_334, 0xb383
.set TG_335, 0xb303
.set TG_336, 0x9bf2
.set TG_337, 0x3303
.set TG_338, 0x3383
.set TG_339, 0x33c5
.set TG_340, 0x3403
.set TG_341, 0x3424
.set TG_342, 0x3445
.set TG_343, 0x3465
.set TG_344, 0x3483
.set TG_345, 0x3493
.set TG_346, 0x34a4
.set TG_347, 0x34b4
.set TG_348, 0x34c4
.set TG_349, 0x34d4
.set TG_350, 0x34e4
.set TG_351, 0x34f4
.set TG_352, 0x3502
.set TG_353, 0x350a
.set TG_354, 0x3512
.set TG_355, 0x351a
.set TG_356, 0x3522
.set TG_357, 0x352a
.set TG_358, 0x3532
.set TG_359, 0x3539
.set TG_360, 0x3541
.set TG_361, 0x3549
.set TG_362, 0x3551
.set TG_363, 0x3558
.set TG_364, 0x3560
.set TG_365, 0x3567
.set TG_366, 0x356f
.set TG_367, 0x3576
.set TG_368, 0x357e
.set TG_369, 0x3583
.set TG_370, 0x3586
.set TG_371, 0x358a
.set TG_372, 0x358e
.set TG_373, 0x3591
.set TG_374, 0x3595
.set TG_375, 0x3598
.set TG_376, 0x359c
.set TG_377, 0x359f
.set TG_378, 0x35a3
.set TG_379, 0x35a6
.set TG_380, 0x35a9
.set TG_381, 0x35ad
.set TG_382, 0x35b0
.set TG_383, 0x35b3
.set TG_384, 0x35b6
.set TG_385, 0x35ba
.set TG_386, 0x35bd
.set TG_387, 0x35c0
.set TG_388, 0x35c3
.set TG_389, 0x35c6
.set TG_390, 0x35c9
.set TG_391, 0x35cc
.set TG_392, 0x35cf
.set TG_393, 0x35d2
.set TG_394, 0x35d5
.set TG_395, 0x35d7
.set TG_396, 0x35da
.set TG_397, 0x35dd
.set TG_398, 0x35e0
.set TG_399, 0x35e2
.set TG_400, 0x35e5
.set TG_401, 0x35e7
.set TG_402, 0x35ea
.set TG_403, 0x35ec
.set TG_404, 0x35ef
.set TG_405, 0x35f1
.set TG_406, 0x35f3
.set TG_407, 0x35f6
.set TG_408, 0x35f8
.set TG_409, 0x35fa
.set TG_410, 0x35fc
.set TG_411, 0x35fe
.set TG_412, 0x3600
.set TG_413, 0x3601
.set TG_414, 0x3602
.set TG_415, 0x3603
.set TG_416, 0x3604
.set TG_417, 0x3605
.set TG_418, 0x3606
.set TG_419, 0x3606
.set TG_420, 0x3607
.set TG_421, 0x3608
.set TG_422, 0x3609
.set TG_423, 0x3609
.set TG_424, 0x360a
.set TG_425, 0x360b
.set TG_426, 0x360b
.set TG_427, 0x360c
.set TG_428, 0x360d
.set TG_429, 0x360d
.set TG_430, 0x360e
.set TG_431, 0x360e
.set TG_432, 0x360f
.set TG_433, 0x360f
.set TG_434, 0x360f
.set TG_435, 0x3610
.set TG_436, 0x3610
.set TG_437, 0x3611
.set TG_438, 0x3611
.set TG_439, 0x3611
.set TG_440, 0x3611
.set TG_441, 0x3612
.set TG_442, 0x3612
.set TG_443, 0x3612
.set TG_444, 0x3612
.set TG_445, 0x3612
.set TG_446, 0x3612
.set TG_447, 0x3612
.altmacro
.macro emitc a
 .short TC_\a
.endm
.macro emitg a
 .short TG_\a
.endm
.macro emitgh a
 .short TG_\a - 0x80
.endm
.p2align 8
tab_F:
.set dd, 0
.rept 448
 .set aa, 0
 .rept 225
  emitc %aa
  .set aa, (aa + dd) % 448
 .endr
 .set aa, (dd + 112) % 448
 .rept 223
  emitc %aa
  .set aa, (aa + dd) % 448
 .endr
 .set dd, dd+1
.endr
.p2align 8
tab_G:
.set ct, 0
.rept 28
 .set ks, 0
 .rept 14
  .set ln, 0
  .rept 64
   .set dc, 16*ct + (ln & 15)
   .set cc, 32*ks + 8*(ln >> 4)
   .rept 8
    .if cc == 0
     emitgh 0
    .elseif cc == 224
     emitgh %((224*dc) % 448)
    .elseif cc < 224
     emitg %((cc*dc) % 448)
    .else
     emitg %(((cc-224)*dc + 112) % 448)
    .endif
    .set cc, cc+1
   .endr
   .set ln, ln+1
  .endr
  .set ks, ks+1
 .endr
 .set ct, ct+1
.endr
.noaltmacro
.p2align 8
tab_B64:
.long 0x3f803f80,0x3f803f80,0x3f803f80,0x3f803f80,0x3f7f3f80,0x3f753f7b,0x3f623f6d,0x3f463f55
.long 0x3f7b3f80,0x3f553f6d,0x3f0e3f35,0x3e483ec4,0x3f753f80,0x3f223f55,0x3dc93ec4,0xbef1be48
.long 0x3f6d3f80,0x3ec43f35,0xbec40000,0xbf6dbf35,0x3f623f80,0x3dc93f0e,0xbf46bec4,0xbf75bf7b
.long 0x3f553f80,0xbe483ec4,0xbf7bbf35,0xbf0ebf6d,0x3f463f80,0xbef13e48,0xbf75bf6d,0x3dc9bf0e
.long 0x3f353f80,0xbf350000,0xbf35bf80,0x3f350000,0x3f223f80,0xbf62be48,0xbe95bf6d,0x3f7f3f0e
.long 0x3f0e3f80,0xbf7bbec4,0x3e48bf35,0x3f553f6d,0x3ef13f80,0xbf7fbf0e,0x3f22bec4,0x3e953f7b
.long 0x3ec43f80,0xbf6dbf35,0x3f6d0000,0xbec43f35,0x3e953f80,0xbf46bf55,0x3f7f3ec4,0xbf623e48
.long 0x3e483f80,0xbf0ebf6d,0x3f553f35,0xbf7bbec4,0x3dc93f80,0xbe95bf7b,0x3ef13f6d,0xbf22bf55
.long 0x3f803f80,0x3f803f80,0x3f803f80,0x3f803f80,0x3f223f35,0x3ef13f0e,0x3e953ec4,0x3dc93e48
.long 0xbe480000,0xbf0ebec4,0xbf55bf35,0xbf7bbf6d,0xbf62bf35,0xbf7fbf7b,0xbf46bf6d,0xbe95bf0e
.long 0xbf6dbf80,0xbec4bf35,0x3ec40000,0x3f6d3f35,0xbe95bf35,0x3f223e48,0x3f7f3f6d,0x3ef13f55
.long 0x3f0e0000,0x3f7b3f6d,0x3e483f35,0xbf55bec4,0x3f7f3f35,0x3e953f55,0xbf62bec4,0xbf22bf7b
.long 0x3f353f80,0xbf350000,0xbf35bf80,0x3f350000,0xbdc93f35,0xbf75bf55,0x3ef1bec4,0x3f463f7b
.long 0xbf550000,0xbe48bf6d,0x3f7b3f35,0xbf0e3ec4,0xbf75bf35,0x3f46be48,0x3dc93f6d,0xbf62bf55
.long 0xbec4bf80,0x3f6d3f35,0xbf6d0000,0x3ec4bf35,0x3ef1bf35,0x3dc93f7b,0xbf22bf6d,0x3f753f0e
.long 0x3f7b0000,0xbf553ec4,0x3f0ebf35,0xbe483f6d,0x3f463f35,0xbf62bf0e,0x3f753ec4,0xbf7fbe48
.long 0x3f803f80,0x3f803f80,0x3f803f80,0x3f803f80,0xbdc90000,0xbe95be48,0xbef1bec4,0xbf22bf0e
.long 0xbf7bbf80,0xbf55bf6d,0xbf0ebf35,0xbe48bec4,0x3e950000,0x3f463f0e,0x3f7f3f6d,0x3f623f7b
.long 0x3f6d3f80,0x3ec43f35,0xbec40000,0xbf6dbf35,0xbef10000,0xbf7fbf55,0xbf22bf6d,0x3e95be48
.long 0xbf55bf80,0x3e48bec4,0x3f7b3f35,0x3f0e3f6d,0x3f220000,0x3f623f7b,0xbe953ec4,0xbf7fbf55
.long 0x3f353f80,0xbf350000,0xbf35bf80,0x3f350000,0xbf460000,0xbef1bf7b,0x3f753ec4,0x3dc93f55
.long 0xbf0ebf80,0x3f7b3ec4,0xbe483f35,0xbf55bf6d,0x3f620000,0xbdc93f55,0xbf46bf6d,0x3f753e48
.long 0x3ec43f80,0xbf6dbf35,0x3f6d0000,0xbec43f35,0xbf750000,0x3f22bf0e,0xbdc93f6d,0xbef1bf7b
.long 0xbe48bf80,0x3f0e3f6d,0xbf55bf35,0x3f7b3ec4,0x3f7f0000,0xbf753e48,0x3f62bec4,0xbf463f0e
.long 0x3f803f80,0x3f803f80,0x3f803f80,0x3f803f80,0xbf46bf35,0xbf62bf55,0xbf75bf6d,0xbf7fbf7b
.long 0x3e480000,0x3f0e3ec4,0x3f553f35,0x3f7b3f6d,0x3ef13f35,0xbdc93e48,0xbf22bec4,0xbf75bf55
.long 0xbf6dbf80,0xbec4bf35,0x3ec40000,0x3f6d3f35,0x3f753f35,0x3f463f7b,0xbdc93ec4,0xbf62bf0e
.long 0xbf0e0000,0xbf7bbf6d,0xbe48bf35,0x3f553ec4,0xbdc9bf35,0x3f753f0e,0x3ef13f6d,0xbf46be48
.long 0x3f353f80,0xbf350000,0xbf35bf80,0x3f350000,0xbf7fbf35,0x3e95bf0e,0x3f623f6d,0xbf223e48
.long 0x3f550000,0x3e483f6d,0xbf7bbf35,0x3f0ebec4,0xbe953f35,0xbf22bf7b,0x3f7f3ec4,0xbef13f0e
.long 0xbec4bf80,0x3f6d3f35,0xbf6d0000,0x3ec4bf35,0x3f623f35,0xbf7fbe48,0x3f46bec4,0xbe953f55
.long 0xbf7b0000,0x3f55bec4,0xbf0e3f35,0x3e48bf6d,0x3f22bf35,0xbef13f55,0x3e95bf6d,0xbdc93f7b
.long 0x3f803f80,0x3f803f80,0x3f803f80,0x3f803f80,0xbf7fbf80,0xbf75bf7b,0xbf62bf6d,0xbf46bf55
.long 0x3f7b3f80,0x3f553f6d,0x3f0e3f35,0x3e483ec4,0xbf75bf80,0xbf22bf55,0xbdc9bec4,0x3ef13e48
.long 0x3f6d3f80,0x3ec43f35,0xbec40000,0xbf6dbf35,0xbf62bf80,0xbdc9bf0e,0x3f463ec4,0x3f753f7b
.long 0x3f553f80,0xbe483ec4,0xbf7bbf35,0xbf0ebf6d,0xbf46bf80,0x3ef1be48,0x3f753f6d,0xbdc93f0e
.long 0x3f353f80,0xbf350000,0xbf35bf80,0x3f350000,0xbf22bf80,0x3f623e48,0x3e953f6d,0xbf7fbf0e
.long 0x3f0e3f80,0xbf7bbec4,0x3e48bf35,0x3f553f6d,0xbef1bf80,0x3f7f3f0e,0xbf223ec4,0xbe95bf7b
.long 0x3ec43f80,0xbf6dbf35,0x3f6d0000,0xbec43f35,0xbe95bf80,0x3f463f55,0xbf7fbec4,0x3f62be48
.long 0x3e483f80,0xbf0ebf6d,0x3f553f35,0xbf7bbec4,0xbdc9bf80,0x3e953f7b,0xbef1bf6d,0x3f223f55
.long 0x3f803f80,0x3f803f80,0x3f803f80,0x3f803f80,0xbf22bf35,0xbef1bf0e,0xbe95bec4,0xbdc9be48
.long 0xbe480000,0xbf0ebec4,0xbf55bf35,0xbf7bbf6d,0x3f623f35,0x3f7f3f7b,0x3f463f6d,0x3e953f0e
.long 0xbf6dbf80,0xbec4bf35,0x3ec40000,0x3f6d3f35,0x3e953f35,0xbf22be48,0xbf7fbf6d,0xbef1bf55
.long 0x3f0e0000,0x3f7b3f6d,0x3e483f35,0xbf55bec4,0xbf7fbf35,0xbe95bf55,0x3f623ec4,0x3f223f7b
.long 0x3f353f80,0xbf350000,0xbf35bf80,0x3f350000,0x3dc9bf35,0x3f753f55,0xbef13ec4,0xbf46bf7b
.long 0xbf550000,0xbe48bf6d,0x3f7b3f35,0xbf0e3ec4,0x3f753f35,0xbf463e48,0xbdc9bf6d,0x3f623f55
.long 0xbec4bf80,0x3f6d3f35,0xbf6d0000,0x3ec4bf35,0xbef13f35,0xbdc9bf7b,0x3f223f6d,0xbf75bf0e
.long 0x3f7b0000,0xbf553ec4,0x3f0ebf35,0xbe483f6d,0xbf46bf35,0x3f623f0e,0xbf75bec4,0x3f7f3e48
.long 0x3f803f80,0x3f803f80,0x3f803f80,0x3f803f80,0x3dc90000,0x3e953e48,0x3ef13ec4,0x3f223f0e
.long 0xbf7bbf80,0xbf55bf6d,0xbf0ebf35,0xbe48bec4,0xbe950000,0xbf46bf0e,0xbf7fbf6d,0xbf62bf7b
.long 0x3f6d3f80,0x3ec43f35,0xbec40000,0xbf6dbf35,0x3ef10000,0x3f7f3f55,0x3f223f6d,0xbe953e48
.long 0xbf55bf80,0x3e48bec4,0x3f7b3f35,0x3f0e3f6d,0xbf220000,0xbf62bf7b,0x3e95bec4,0x3f7f3f55
.long 0x3f353f80,0xbf350000,0xbf35bf80,0x3f350000,0x3f460000,0x3ef13f7b,0xbf75bec4,0xbdc9bf55
.long 0xbf0ebf80,0x3f7b3ec4,0xbe483f35,0xbf55bf6d,0xbf620000,0x3dc9bf55,0x3f463f6d,0xbf75be48
.long 0x3ec43f80,0xbf6dbf35,0x3f6d0000,0xbec43f35,0x3f750000,0xbf223f0e,0x3dc9bf6d,0x3ef13f7b
.long 0xbe48bf80,0x3f0e3f6d,0xbf55bf35,0x3f7b3ec4,0xbf7f0000,0x3f75be48,0xbf623ec4,0x3f46bf0e
.long 0x3f803f80,0x3f803f80,0x3f803f80,0x3f803f80,0x3f463f35,0x3f623f55,0x3f753f6d,0x3f7f3f7b
.long 0x3e480000,0x3f0e3ec4,0x3f553f35,0x3f7b3f6d,0xbef1bf35,0x3dc9be48,0x3f223ec4,0x3f753f55
.long 0xbf6dbf80,0xbec4bf35,0x3ec40000,0x3f6d3f35,0xbf75bf35,0xbf46bf7b,0x3dc9bec4,0x3f623f0e
.long 0xbf0e0000,0xbf7bbf6d,0xbe48bf35,0x3f553ec4,0x3dc93f35,0xbf75bf0e,0xbef1bf6d,0x3f463e48
.long 0x3f353f80,0xbf350000,0xbf35bf80,0x3f350000,0x3f7f3f35,0xbe953f0e,0xbf62bf6d,0x3f22be48
.long 0x3f550000,0x3e483f6d,0xbf7bbf35,0x3f0ebec4,0x3e95bf35,0x3f223f7b,0xbf7fbec4,0x3ef1bf0e
.long 0xbec4bf80,0x3f6d3f35,0xbf6d0000,0x3ec4bf35,0xbf62bf35,0x3f7f3e48,0xbf463ec4,0x3e95bf55
.long 0xbf7b0000,0x3f55bec4,0xbf0e3f35,0x3e48bf6d,0xbf223f35,0x3ef1bf55,0xbe953f6d,0x3dc9bf7b
.long 0x0,0x0,0x0,0x0,0x3dc90000,0x3e953e48,0x3ef13ec4,0x3f223f0e
.long 0x3e480000,0x3f0e3ec4,0x3f553f35,0x3f7b3f6d,0x3e950000,0x3f463f0e,0x3f7f3f6d,0x3f623f7b
.long 0x3ec40000,0x3f6d3f35,0x3f6d3f80,0x3ec43f35,0x3ef10000,0x3f7f3f55,0x3f223f6d,0xbe953e48
.long 0x3f0e0000,0x3f7b3f6d,0x3e483f35,0xbf55bec4,0x3f220000,0x3f623f7b,0xbe953ec4,0xbf7fbf55
.long 0x3f350000,0x3f353f80,0xbf350000,0xbf35bf80,0x3f460000,0x3ef13f7b,0xbf75bec4,0xbdc9bf55
.long 0x3f550000,0x3e483f6d,0xbf7bbf35,0x3f0ebec4,0x3f620000,0xbdc93f55,0xbf46bf6d,0x3f753e48
.long 0x3f6d0000,0xbec43f35,0xbec4bf80,0x3f6d3f35,0x3f750000,0xbf223f0e,0x3dc9bf6d,0x3ef13f7b
.long 0x3f7b0000,0xbf553ec4,0x3f0ebf35,0xbe483f6d,0x3f7f0000,0xbf753e48,0x3f62bec4,0xbf463f0e
.long 0x0,0x0,0x0,0x0,0x3f463f35,0x3f623f55,0x3f753f6d,0x3f7f3f7b
.long 0x3f7b3f80,0x3f553f6d,0x3f0e3f35,0x3e483ec4,0x3ef13f35,0xbdc93e48,0xbf22bec4,0xbf75bf55
.long 0xbec40000,0xbf6dbf35,0xbf6dbf80,0xbec4bf35,0xbf75bf35,0xbf46bf7b,0x3dc9bec4,0x3f623f0e
.long 0xbf55bf80,0x3e48bec4,0x3f7b3f35,0x3f0e3f6d,0xbdc9bf35,0x3f753f0e,0x3ef13f6d,0xbf46be48
.long 0x3f350000,0x3f353f80,0xbf350000,0xbf35bf80,0x3f7f3f35,0xbe953f0e,0xbf62bf6d,0x3f22be48
.long 0x3f0e3f80,0xbf7bbec4,0x3e48bf35,0x3f553f6d,0xbe953f35,0xbf22bf7b,0x3f7f3ec4,0xbef13f0e
.long 0xbf6d0000,0x3ec4bf35,0x3ec43f80,0xbf6dbf35,0xbf62bf35,0x3f7f3e48,0xbf463ec4,0x3e95bf55
.long 0xbe48bf80,0x3f0e3f6d,0xbf55bf35,0x3f7b3ec4,0x3f22bf35,0xbef13f55,0x3e95bf6d,0xbdc93f7b
.long 0x0,0x0,0x0,0x0,0x3f7f3f80,0x3f753f7b,0x3f623f6d,0x3f463f55
.long 0xbe480000,0xbf0ebec4,0xbf55bf35,0xbf7bbf6d,0xbf75bf80,0xbf22bf55,0xbdc9bec4,0x3ef13e48
.long 0x3ec40000,0x3f6d3f35,0x3f6d3f80,0x3ec43f35,0x3f623f80,0x3dc93f0e,0xbf46bec4,0xbf75bf7b
.long 0xbf0e0000,0xbf7bbf6d,0xbe48bf35,0x3f553ec4,0xbf46bf80,0x3ef1be48,0x3f753f6d,0xbdc93f0e
.long 0x3f350000,0x3f353f80,0xbf350000,0xbf35bf80,0x3f223f80,0xbf62be48,0xbe95bf6d,0x3f7f3f0e
.long 0xbf550000,0xbe48bf6d,0x3f7b3f35,0xbf0e3ec4,0xbef1bf80,0x3f7f3f0e,0xbf223ec4,0xbe95bf7b
.long 0x3f6d0000,0xbec43f35,0xbec4bf80,0x3f6d3f35,0x3e953f80,0xbf46bf55,0x3f7f3ec4,0xbf623e48
.long 0xbf7b0000,0x3f55bec4,0xbf0e3f35,0x3e48bf6d,0xbdc9bf80,0x3e953f7b,0xbef1bf6d,0x3f223f55
.long 0x0,0x0,0x0,0x0,0x3f223f35,0x3ef13f0e,0x3e953ec4,0x3dc93e48
.long 0xbf7bbf80,0xbf55bf6d,0xbf0ebf35,0xbe48bec4,0x3f623f35,0x3f7f3f7b,0x3f463f6d,0x3e953f0e
.long 0xbec40000,0xbf6dbf35,0xbf6dbf80,0xbec4bf35,0xbe95bf35,0x3f223e48,0x3f7f3f6d,0x3ef13f55
.long 0x3f553f80,0xbe483ec4,0xbf7bbf35,0xbf0ebf6d,0xbf7fbf35,0xbe95bf55,0x3f623ec4,0x3f223f7b
.long 0x3f350000,0x3f353f80,0xbf350000,0xbf35bf80,0xbdc93f35,0xbf75bf55,0x3ef1bec4,0x3f463f7b
.long 0xbf0ebf80,0x3f7b3ec4,0xbe483f35,0xbf55bf6d,0x3f753f35,0xbf463e48,0xbdc9bf6d,0x3f623f55
.long 0xbf6d0000,0x3ec4bf35,0x3ec43f80,0xbf6dbf35,0x3ef1bf35,0x3dc93f7b,0xbf22bf6d,0x3f753f0e
.long 0x3e483f80,0xbf0ebf6d,0x3f553f35,0xbf7bbec4,0xbf46bf35,0x3f623f0e,0xbf75bec4,0x3f7f3e48
.long 0x0,0x0,0x0,0x0,0xbdc90000,0xbe95be48,0xbef1bec4,0xbf22bf0e
.long 0x3e480000,0x3f0e3ec4,0x3f553f35,0x3f7b3f6d,0xbe950000,0xbf46bf0e,0xbf7fbf6d,0xbf62bf7b
.long 0x3ec40000,0x3f6d3f35,0x3f6d3f80,0x3ec43f35,0xbef10000,0xbf7fbf55,0xbf22bf6d,0x3e95be48
.long 0x3f0e0000,0x3f7b3f6d,0x3e483f35,0xbf55bec4,0xbf220000,0xbf62bf7b,0x3e95bec4,0x3f7f3f55
.long 0x3f350000,0x3f353f80,0xbf350000,0xbf35bf80,0xbf460000,0xbef1bf7b,0x3f753ec4,0x3dc93f55
.long 0x3f550000,0x3e483f6d,0xbf7bbf35,0x3f0ebec4,0xbf620000,0x3dc9bf55,0x3f463f6d,0xbf75be48
.long 0x3f6d0000,0xbec43f35,0xbec4bf80,0x3f6d3f35,0xbf750000,0x3f22bf0e,0xbdc93f6d,0xbef1bf7b
.long 0x3f7b0000,0xbf553ec4,0x3f0ebf35,0xbe483f6d,0xbf7f0000,0x3f75be48,0xbf623ec4,0x3f46bf0e
.long 0x0,0x0,0x0,0x0,0xbf46bf35,0xbf62bf55,0xbf75bf6d,0xbf7fbf7b
.long 0x3f7b3f80,0x3f553f6d,0x3f0e3f35,0x3e483ec4,0xbef1bf35,0x3dc9be48,0x3f223ec4,0x3f753f55
.long 0xbec40000,0xbf6dbf35,0xbf6dbf80,0xbec4bf35,0x3f753f35,0x3f463f7b,0xbdc93ec4,0xbf62bf0e
.long 0xbf55bf80,0x3e48bec4,0x3f7b3f35,0x3f0e3f6d,0x3dc93f35,0xbf75bf0e,0xbef1bf6d,0x3f463e48
.long 0x3f350000,0x3f353f80,0xbf350000,0xbf35bf80,0xbf7fbf35,0x3e95bf0e,0x3f623f6d,0xbf223e48
.long 0x3f0e3f80,0xbf7bbec4,0x3e48bf35,0x3f553f6d,0x3e95bf35,0x3f223f7b,0xbf7fbec4,0x3ef1bf0e
.long 0xbf6d0000,0x3ec4bf35,0x3ec43f80,0xbf6dbf35,0x3f623f35,0xbf7fbe48,0x3f46bec4,0xbe953f55
.long 0xbe48bf80,0x3f0e3f6d,0xbf55bf35,0x3f7b3ec4,0xbf223f35,0x3ef1bf55,0xbe953f6d,0x3dc9bf7b
.long 0x0,0x0,0x0,0x0,0xbf7fbf80,0xbf75bf7b,0xbf62bf6d,0xbf46bf55
.long 0xbe480000,0xbf0ebec4,0xbf55bf35,0xbf7bbf6d,0x3f753f80,0x3f223f55,0x3dc93ec4,0xbef1be48
.long 0x3ec40000,0x3f6d3f35,0x3f6d3f80,0x3ec43f35,0xbf62bf80,0xbdc9bf0e,0x3f463ec4,0x3f753f7b
.long 0xbf0e0000,0xbf7bbf6d,0xbe48bf35,0x3f553ec4,0x3f463f80,0xbef13e48,0xbf75bf6d,0x3dc9bf0e
.long 0x3f350000,0x3f353f80,0xbf350000,0xbf35bf80,0xbf22bf80,0x3f623e48,0x3e953f6d,0xbf7fbf0e
.long 0xbf550000,0xbe48bf6d,0x3f7b3f35,0xbf0e3ec4,0x3ef13f80,0xbf7fbf0e,0x3f22bec4,0x3e953f7b
.long 0x3f6d0000,0xbec43f35,0xbec4bf80,0x3f6d3f35,0xbe95bf80,0x3f463f55,0xbf7fbec4,0x3f62be48
.long 0xbf7b0000,0x3f55bec4,0xbf0e3f35,0x3e48bf6d,0x3dc93f80,0xbe95bf7b,0x3ef13f6d,0xbf22bf55
.long 0x0,0x0,0x0,0x0,0xbf22bf35,0xbef1bf0e,0xbe95bec4,0xbdc9be48
.long 0xbf7bbf80,0xbf55bf6d,0xbf0ebf35,0xbe48bec4,0xbf62bf35,0xbf7fbf7b,0xbf46bf6d,0xbe95bf0e
.long 0xbec40000,0xbf6dbf35,0xbf6dbf80,0xbec4bf35,0x3e953f35,0xbf22be48,0xbf7fbf6d,0xbef1bf55
.long 0x3f553f80,0xbe483ec4,0xbf7bbf35,0xbf0ebf6d,0x3f7f3f35,0x3e953f55,0xbf62bec4,0xbf22bf7b
.long 0x3f350000,0x3f353f80,0xbf350000,0xbf35bf80,0x3dc9bf35,0x3f753f55,0xbef13ec4,0xbf46bf7b
.long 0xbf0ebf80,0x3f7b3ec4,0xbe483f35,0xbf55bf6d,0xbf75bf35,0x3f46be48,0x3dc93f6d,0xbf62bf55
.long 0xbf6d0000,0x3ec4bf35,0x3ec43f80,0xbf6dbf35,0xbef13f35,0xbdc9bf7b,0x3f223f6d,0xbf75bf0e
.long 0x3e483f80,0xbf0ebf6d,0x3f553f35,0xbf7bbec4,0x3f463f35,0xbf62bf0e,0x3f753ec4,0xbf7fbe48
.long 0x0,0x0,0x0,0x0,0xbdc90000,0xbe95be48,0xbef1bec4,0xbf22bf0e
.long 0xbe480000,0xbf0ebec4,0xbf55bf35,0xbf7bbf6d,0xbe950000,0xbf46bf0e,0xbf7fbf6d,0xbf62bf7b
.long 0xbec40000,0xbf6dbf35,0xbf6dbf80,0xbec4bf35,0xbef10000,0xbf7fbf55,0xbf22bf6d,0x3e95be48
.long 0xbf0e0000,0xbf7bbf6d,0xbe48bf35,0x3f553ec4,0xbf220000,0xbf62bf7b,0x3e95bec4,0x3f7f3f55
.long 0xbf350000,0xbf35bf80,0x3f350000,0x3f353f80,0xbf460000,0xbef1bf7b,0x3f753ec4,0x3dc93f55
.long 0xbf550000,0xbe48bf6d,0x3f7b3f35,0xbf0e3ec4,0xbf620000,0x3dc9bf55,0x3f463f6d,0xbf75be48
.long 0xbf6d0000,0x3ec4bf35,0x3ec43f80,0xbf6dbf35,0xbf750000,0x3f22bf0e,0xbdc93f6d,0xbef1bf7b
.long 0xbf7b0000,0x3f55bec4,0xbf0e3f35,0x3e48bf6d,0xbf7f0000,0x3f75be48,0xbf623ec4,0x3f46bf0e
.long 0x0,0x0,0x0,0x0,0xbf46bf35,0xbf62bf55,0xbf75bf6d,0xbf7fbf7b
.long 0xbf7bbf80,0xbf55bf6d,0xbf0ebf35,0xbe48bec4,0xbef1bf35,0x3dc9be48,0x3f223ec4,0x3f753f55
.long 0x3ec40000,0x3f6d3f35,0x3f6d3f80,0x3ec43f35,0x3f753f35,0x3f463f7b,0xbdc93ec4,0xbf62bf0e
.long 0x3f553f80,0xbe483ec4,0xbf7bbf35,0xbf0ebf6d,0x3dc93f35,0xbf75bf0e,0xbef1bf6d,0x3f463e48
.long 0xbf350000,0xbf35bf80,0x3f350000,0x3f353f80,0xbf7fbf35,0x3e95bf0e,0x3f623f6d,0xbf223e48
.long 0xbf0ebf80,0x3f7b3ec4,0xbe483f35,0xbf55bf6d,0x3e95bf35,0x3f223f7b,0xbf7fbec4,0x3ef1bf0e
.long 0x3f6d0000,0xbec43f35,0xbec4bf80,0x3f6d3f35,0x3f623f35,0xbf7fbe48,0x3f46bec4,0xbe953f55
.long 0x3e483f80,0xbf0ebf6d,0x3f553f35,0xbf7bbec4,0xbf223f35,0x3ef1bf55,0xbe953f6d,0x3dc9bf7b
.long 0x0,0x0,0x0,0x0,0xbf7fbf80,0xbf75bf7b,0xbf62bf6d,0xbf46bf55
.long 0x3e480000,0x3f0e3ec4,0x3f553f35,0x3f7b3f6d,0x3f753f80,0x3f223f55,0x3dc93ec4,0xbef1be48
.long 0xbec40000,0xbf6dbf35,0xbf6dbf80,0xbec4bf35,0xbf62bf80,0xbdc9bf0e,0x3f463ec4,0x3f753f7b
.long 0x3f0e0000,0x3f7b3f6d,0x3e483f35,0xbf55bec4,0x3f463f80,0xbef13e48,0xbf75bf6d,0x3dc9bf0e
.long 0xbf350000,0xbf35bf80,0x3f350000,0x3f353f80,0xbf22bf80,0x3f623e48,0x3e953f6d,0xbf7fbf0e
.long 0x3f550000,0x3e483f6d,0xbf7bbf35,0x3f0ebec4,0x3ef13f80,0xbf7fbf0e,0x3f22bec4,0x3e953f7b
.long 0xbf6d0000,0x3ec4bf35,0x3ec43f80,0xbf6dbf35,0xbe95bf80,0x3f463f55,0xbf7fbec4,0x3f62be48
.long 0x3f7b0000,0xbf553ec4,0x3f0ebf35,0xbe483f6d,0x3dc93f80,0xbe95bf7b,0x3ef13f6d,0xbf22bf55
.long 0x0,0x0,0x0,0x0,0xbf22bf35,0xbef1bf0e,0xbe95bec4,0xbdc9be48
.long 0x3f7b3f80,0x3f553f6d,0x3f0e3f35,0x3e483ec4,0xbf62bf35,0xbf7fbf7b,0xbf46bf6d,0xbe95bf0e
.long 0x3ec40000,0x3f6d3f35,0x3f6d3f80,0x3ec43f35,0x3e953f35,0xbf22be48,0xbf7fbf6d,0xbef1bf55
.long 0xbf55bf80,0x3e48bec4,0x3f7b3f35,0x3f0e3f6d,0x3f7f3f35,0x3e953f55,0xbf62bec4,0xbf22bf7b
.long 0xbf350000,0xbf35bf80,0x3f350000,0x3f353f80,0x3dc9bf35,0x3f753f55,0xbef13ec4,0xbf46bf7b
.long 0x3f0e3f80,0xbf7bbec4,0x3e48bf35,0x3f553f6d,0xbf75bf35,0x3f46be48,0x3dc93f6d,0xbf62bf55
.long 0x3f6d0000,0xbec43f35,0xbec4bf80,0x3f6d3f35,0xbef13f35,0xbdc9bf7b,0x3f223f6d,0xbf75bf0e
.long 0xbe48bf80,0x3f0e3f6d,0xbf55bf35,0x3f7b3ec4,0x3f463f35,0xbf62bf0e,0x3f753ec4,0xbf7fbe48
.long 0x0,0x0,0x0,0x0,0x3dc90000,0x3e953e48,0x3ef13ec4,0x3f223f0e
.long 0xbe480000,0xbf0ebec4,0xbf55bf35,0xbf7bbf6d,0x3e950000,0x3f463f0e,0x3f7f3f6d,0x3f623f7b
.long 0xbec40000,0xbf6dbf35,0xbf6dbf80,0xbec4bf35,0x3ef10000,0x3f7f3f55,0x3f223f6d,0xbe953e48
.long 0xbf0e0000,0xbf7bbf6d,0xbe48bf35,0x3f553ec4,0x3f220000,0x3f623f7b,0xbe953ec4,0xbf7fbf55
.long 0xbf350000,0xbf35bf80,0x3f350000,0x3f353f80,0x3f460000,0x3ef13f7b,0xbf75bec4,0xbdc9bf55
.long 0xbf550000,0xbe48bf6d,0x3f7b3f35,0xbf0e3ec4,0x3f620000,0xbdc93f55,0xbf46bf6d,0x3f753e48
.long 0xbf6d0000,0x3ec4bf35,0x3ec43f80,0xbf6dbf35,0x3f750000,0xbf223f0e,0x3dc9bf6d,0x3ef13f7b
.long 0xbf7b0000,0x3f55bec4,0xbf0e3f35,0x3e48bf6d,0x3f7f0000,0xbf753e48,0x3f62bec4,0xbf463f0e
.long 0x0,0x0,0x0,0x0,0x3f463f35,0x3f623f55,0x3f753f6d,0x3f7f3f7b
.long 0xbf7bbf80,0xbf55bf6d,0xbf0ebf35,0xbe48bec4,0x3ef13f35,0xbdc93e48,0xbf22bec4,0xbf75bf55
.long 0x3ec40000,0x3f6d3f35,0x3f6d3f80,0x3ec43f35,0xbf75bf35,0xbf46bf7b,0x3dc9bec4,0x3f623f0e
.long 0x3f553f80,0xbe483ec4,0xbf7bbf35,0xbf0ebf6d,0xbdc9bf35,0x3f753f0e,0x3ef13f6d,0xbf46be48
.long 0xbf350000,0xbf35bf80,0x3f350000,0x3f353f80,0x3f7f3f35,0xbe953f0e,0xbf62bf6d,0x3f22be48
.long 0xbf0ebf80,0x3f7b3ec4,0xbe483f35,0xbf55bf6d,0xbe953f35,0xbf22bf7b,0x3f7f3ec4,0xbef13f0e
.long 0x3f6d0000,0xbec43f35,0xbec4bf80,0x3f6d3f35,0xbf62bf35,0x3f7f3e48,0xbf463ec4,0x3e95bf55
.long 0x3e483f80,0xbf0ebf6d,0x3f553f35,0xbf7bbec4,0x3f22bf35,0xbef13f55,0x3e95bf6d,0xbdc93f7b
.long 0x0,0x0,0x0,0x0,0x3f7f3f80,0x3f753f7b,0x3f623f6d,0x3f463f55
.long 0x3e480000,0x3f0e3ec4,0x3f553f35,0x3f7b3f6d,0xbf75bf80,0xbf22bf55,0xbdc9bec4,0x3ef13e48
.long 0xbec40000,0xbf6dbf35,0xbf6dbf80,0xbec4bf35,0x3f623f80,0x3dc93f0e,0xbf46bec4,0xbf75bf7b
.long 0x3f0e0000,0x3f7b3f6d,0x3e483f35,0xbf55bec4,0xbf46bf80,0x3ef1be48,0x3f753f6d,0xbdc93f0e
.long 0xbf350000,0xbf35bf80,0x3f350000,0x3f353f80,0x3f223f80,0xbf62be48,0xbe95bf6d,0x3f7f3f0e
.long 0x3f550000,0x3e483f6d,0xbf7bbf35,0x3f0ebec4,0xbef1bf80,0x3f7f3f0e,0xbf223ec4,0xbe95bf7b
.long 0xbf6d0000,0x3ec4bf35,0x3ec43f80,0xbf6dbf35,0x3e953f80,0xbf46bf55,0x3f7f3ec4,0xbf623e48
.long 0x3f7b0000,0xbf553ec4,0x3f0ebf35,0xbe483f6d,0xbdc9bf80,0x3e953f7b,0xbef1bf6d,0x3f223f55
.long 0x0,0x0,0x0,0x0,0x3f223f35,0x3ef13f0e,0x3e953ec4,0x3dc93e48
.long 0x3f7b3f80,0x3f553f6d,0x3f0e3f35,0x3e483ec4,0x3f623f35,0x3f7f3f7b,0x3f463f6d,0x3e953f0e
.long 0x3ec40000,0x3f6d3f35,0x3f6d3f80,0x3ec43f35,0xbe95bf35,0x3f223e48,0x3f7f3f6d,0x3ef13f55
.long 0xbf55bf80,0x3e48bec4,0x3f7b3f35,0x3f0e3f6d,0xbf7fbf35,0xbe95bf55,0x3f623ec4,0x3f223f7b
.long 0xbf350000,0xbf35bf80,0x3f350000,0x3f353f80,0xbdc93f35,0xbf75bf55,0x3ef1bec4,0x3f463f7b
.long 0x3f0e3f80,0xbf7bbec4,0x3e48bf35,0x3f553f6d,0x3f753f35,0xbf463e48,0xbdc9bf6d,0x3f623f55
.long 0x3f6d0000,0xbec43f35,0xbec4bf80,0x3f6d3f35,0x3ef1bf35,0x3dc93f7b,0xbf22bf6d,0x3f753f0e
.long 0xbe48bf80,0x3f0e3f6d,0xbf55bf35,0x3f7b3ec4,0xbf46bf35,0x3f623f0e,0xbf75bec4,0x3f7f3e48
.long 0x3f80,0xbf80,0x3f80,0xbf80,0xbdc93f80,0x3e95bf7b,0xbef13f6d,0x3f22bf55
.long 0xbe483f80,0x3f0ebf6d,0xbf553f35,0x3f7bbec4,0xbe953f80,0x3f46bf55,0xbf7f3ec4,0x3f623e48
.long 0xbec43f80,0x3f6dbf35,0xbf6d0000,0x3ec43f35,0xbef13f80,0x3f7fbf0e,0xbf22bec4,0xbe953f7b
.long 0xbf0e3f80,0x3f7bbec4,0xbe48bf35,0xbf553f6d,0xbf223f80,0x3f62be48,0x3e95bf6d,0xbf7f3f0e
.long 0xbf353f80,0x3f350000,0x3f35bf80,0xbf350000,0xbf463f80,0x3ef13e48,0x3f75bf6d,0xbdc9bf0e
.long 0xbf553f80,0x3e483ec4,0x3f7bbf35,0x3f0ebf6d,0xbf623f80,0xbdc93f0e,0x3f46bec4,0x3f75bf7b
.long 0xbf6d3f80,0xbec43f35,0x3ec40000,0x3f6dbf35,0xbf753f80,0xbf223f55,0xbdc93ec4,0x3ef1be48
.long 0xbf7b3f80,0xbf553f6d,0xbf0e3f35,0xbe483ec4,0xbf7f3f80,0xbf753f7b,0xbf623f6d,0xbf463f55
.long 0x3f80,0xbf80,0x3f80,0xbf80,0xbf463f35,0x3f62bf0e,0xbf753ec4,0x3f7fbe48
.long 0xbf7b0000,0x3f553ec4,0xbf0ebf35,0x3e483f6d,0xbef1bf35,0xbdc93f7b,0x3f22bf6d,0xbf753f0e
.long 0x3ec4bf80,0xbf6d3f35,0x3f6d0000,0xbec4bf35,0x3f75bf35,0xbf46be48,0xbdc93f6d,0x3f62bf55
.long 0x3f550000,0x3e48bf6d,0xbf7b3f35,0x3f0e3ec4,0x3dc93f35,0x3f75bf55,0xbef1bec4,0xbf463f7b
.long 0xbf353f80,0x3f350000,0x3f35bf80,0xbf350000,0xbf7f3f35,0xbe953f55,0x3f62bec4,0x3f22bf7b
.long 0xbf0e0000,0xbf7b3f6d,0xbe483f35,0x3f55bec4,0x3e95bf35,0xbf223e48,0xbf7f3f6d,0xbef13f55
.long 0x3f6dbf80,0x3ec4bf35,0xbec40000,0xbf6d3f35,0x3f62bf35,0x3f7fbf7b,0x3f46bf6d,0x3e95bf0e
.long 0x3e480000,0x3f0ebec4,0x3f55bf35,0x3f7bbf6d,0xbf223f35,0xbef13f0e,0xbe953ec4,0xbdc93e48
.long 0x3f80,0xbf80,0x3f80,0xbf80,0xbf7f0000,0x3f753e48,0xbf62bec4,0x3f463f0e
.long 0x3e48bf80,0xbf0e3f6d,0x3f55bf35,0xbf7b3ec4,0x3f750000,0xbf22bf0e,0x3dc93f6d,0x3ef1bf7b
.long 0xbec43f80,0x3f6dbf35,0xbf6d0000,0x3ec43f35,0xbf620000,0x3dc93f55,0x3f46bf6d,0xbf753e48
.long 0x3f0ebf80,0xbf7b3ec4,0x3e483f35,0x3f55bf6d,0x3f460000,0x3ef1bf7b,0xbf753ec4,0xbdc93f55
.long 0xbf353f80,0x3f350000,0x3f35bf80,0xbf350000,0xbf220000,0xbf623f7b,0x3e953ec4,0x3f7fbf55
.long 0x3f55bf80,0xbe48bec4,0xbf7b3f35,0xbf0e3f6d,0x3ef10000,0x3f7fbf55,0x3f22bf6d,0xbe95be48
.long 0xbf6d3f80,0xbec43f35,0x3ec40000,0x3f6dbf35,0xbe950000,0xbf463f0e,0xbf7f3f6d,0xbf623f7b
.long 0x3f7bbf80,0x3f55bf6d,0x3f0ebf35,0x3e48bec4,0x3dc90000,0x3e95be48,0x3ef1bec4,0x3f22bf0e
.long 0x3f80,0xbf80,0x3f80,0xbf80,0xbf22bf35,0x3ef13f55,0xbe95bf6d,0x3dc93f7b
.long 0x3f7b0000,0xbf55bec4,0x3f0e3f35,0xbe48bf6d,0xbf623f35,0x3f7fbe48,0xbf46bec4,0x3e953f55
.long 0x3ec4bf80,0xbf6d3f35,0x3f6d0000,0xbec4bf35,0x3e953f35,0x3f22bf7b,0xbf7f3ec4,0x3ef13f0e
.long 0xbf550000,0xbe483f6d,0x3f7bbf35,0xbf0ebec4,0x3f7fbf35,0xbe95bf0e,0xbf623f6d,0x3f223e48
.long 0xbf353f80,0x3f350000,0x3f35bf80,0xbf350000,0x3dc9bf35,0xbf753f0e,0xbef13f6d,0x3f46be48
.long 0x3f0e0000,0x3f7bbf6d,0x3e48bf35,0xbf553ec4,0xbf753f35,0xbf463f7b,0x3dc93ec4,0x3f62bf0e
.long 0x3f6dbf80,0x3ec4bf35,0xbec40000,0xbf6d3f35,0xbef13f35,0x3dc93e48,0x3f22bec4,0x3f75bf55
.long 0xbe480000,0xbf0e3ec4,0xbf553f35,0xbf7b3f6d,0x3f46bf35,0x3f62bf55,0x3f75bf6d,0x3f7fbf7b
.long 0x3f80,0xbf80,0x3f80,0xbf80,0x3dc9bf80,0xbe953f7b,0x3ef1bf6d,0xbf223f55
.long 0xbe483f80,0x3f0ebf6d,0xbf553f35,0x3f7bbec4,0x3e95bf80,0xbf463f55,0x3f7fbec4,0xbf62be48
.long 0xbec43f80,0x3f6dbf35,0xbf6d0000,0x3ec43f35,0x3ef1bf80,0xbf7f3f0e,0x3f223ec4,0x3e95bf7b
.long 0xbf0e3f80,0x3f7bbec4,0xbe48bf35,0xbf553f6d,0x3f22bf80,0xbf623e48,0xbe953f6d,0x3f7fbf0e
.long 0xbf353f80,0x3f350000,0x3f35bf80,0xbf350000,0x3f46bf80,0xbef1be48,0xbf753f6d,0x3dc93f0e
.long 0xbf553f80,0x3e483ec4,0x3f7bbf35,0x3f0ebf6d,0x3f62bf80,0x3dc9bf0e,0xbf463ec4,0xbf753f7b
.long 0xbf6d3f80,0xbec43f35,0x3ec40000,0x3f6dbf35,0x3f75bf80,0x3f22bf55,0x3dc9bec4,0xbef13e48
.long 0xbf7b3f80,0xbf553f6d,0xbf0e3f35,0xbe483ec4,0x3f7fbf80,0x3f75bf7b,0x3f62bf6d,0x3f46bf55
.long 0x3f80,0xbf80,0x3f80,0xbf80,0x3f46bf35,0xbf623f0e,0x3f75bec4,0xbf7f3e48
.long 0xbf7b0000,0x3f553ec4,0xbf0ebf35,0x3e483f6d,0x3ef13f35,0x3dc9bf7b,0xbf223f6d,0x3f75bf0e
.long 0x3ec4bf80,0xbf6d3f35,0x3f6d0000,0xbec4bf35,0xbf753f35,0x3f463e48,0x3dc9bf6d,0xbf623f55
.long 0x3f550000,0x3e48bf6d,0xbf7b3f35,0x3f0e3ec4,0xbdc9bf35,0xbf753f55,0x3ef13ec4,0x3f46bf7b
.long 0xbf353f80,0x3f350000,0x3f35bf80,0xbf350000,0x3f7fbf35,0x3e95bf55,0xbf623ec4,0xbf223f7b
.long 0xbf0e0000,0xbf7b3f6d,0xbe483f35,0x3f55bec4,0xbe953f35,0x3f22be48,0x3f7fbf6d,0x3ef1bf55
.long 0x3f6dbf80,0x3ec4bf35,0xbec40000,0xbf6d3f35,0xbf623f35,0xbf7f3f7b,0xbf463f6d,0xbe953f0e
.long 0x3e480000,0x3f0ebec4,0x3f55bf35,0x3f7bbf6d,0x3f22bf35,0x3ef1bf0e,0x3e95bec4,0x3dc9be48
.long 0x3f80,0xbf80,0x3f80,0xbf80,0x3f7f0000,0xbf75be48,0x3f623ec4,0xbf46bf0e
.long 0x3e48bf80,0xbf0e3f6d,0x3f55bf35,0xbf7b3ec4,0xbf750000,0x3f223f0e,0xbdc9bf6d,0xbef13f7b
.long 0xbec43f80,0x3f6dbf35,0xbf6d0000,0x3ec43f35,0x3f620000,0xbdc9bf55,0xbf463f6d,0x3f75be48
.long 0x3f0ebf80,0xbf7b3ec4,0x3e483f35,0x3f55bf6d,0xbf460000,0xbef13f7b,0x3f75bec4,0x3dc9bf55
.long 0xbf353f80,0x3f350000,0x3f35bf80,0xbf350000,0x3f220000,0x3f62bf7b,0xbe95bec4,0xbf7f3f55
.long 0x3f55bf80,0xbe48bec4,0xbf7b3f35,0xbf0e3f6d,0xbef10000,0xbf7f3f55,0xbf223f6d,0x3e953e48
.long 0xbf6d3f80,0xbec43f35,0x3ec40000,0x3f6dbf35,0x3e950000,0x3f46bf0e,0x3f7fbf6d,0x3f62bf7b
.long 0x3f7bbf80,0x3f55bf6d,0x3f0ebf35,0x3e48bec4,0xbdc90000,0xbe953e48,0xbef13ec4,0xbf223f0e
.long 0x3f80,0xbf80,0x3f80,0xbf80,0x3f223f35,0xbef1bf55,0x3e953f6d,0xbdc9bf7b
.long 0x3f7b0000,0xbf55bec4,0x3f0e3f35,0xbe48bf6d,0x3f62bf35,0xbf7f3e48,0x3f463ec4,0xbe95bf55
.long 0x3ec4bf80,0xbf6d3f35,0x3f6d0000,0xbec4bf35,0xbe95bf35,0xbf223f7b,0x3f7fbec4,0xbef1bf0e
.long 0xbf550000,0xbe483f6d,0x3f7bbf35,0xbf0ebec4,0xbf7f3f35,0x3e953f0e,0x3f62bf6d,0xbf22be48
.long 0xbf353f80,0x3f350000,0x3f35bf80,0xbf350000,0xbdc93f35,0x3f75bf0e,0x3ef1bf6d,0xbf463e48
.long 0x3f0e0000,0x3f7bbf6d,0x3e48bf35,0xbf553ec4,0x3f75bf35,0x3f46bf7b,0xbdc9bec4,0xbf623f0e
.long 0x3f6dbf80,0x3ec4bf35,0xbec40000,0xbf6d3f35,0x3ef1bf35,0xbdc9be48,0xbf223ec4,0xbf753f55
.long 0xbe480000,0xbf0e3ec4,0xbf553f35,0xbf7b3f6d,0xbf463f35,0xbf623f55,0xbf753f6d,0xbf7f3f7b
.long 0x3f800000,0xbf800000,0x3f800000,0xbf800000,0x3f7f0000,0xbf75be48,0x3f623ec4,0xbf46bf0e
.long 0x3f7b0000,0xbf55bec4,0x3f0e3f35,0xbe48bf6d,0x3f750000,0xbf22bf0e,0x3dc93f6d,0x3ef1bf7b
.long 0x3f6d0000,0xbec4bf35,0xbec43f80,0x3f6dbf35,0x3f620000,0xbdc9bf55,0xbf463f6d,0x3f75be48
.long 0x3f550000,0x3e48bf6d,0xbf7b3f35,0x3f0e3ec4,0x3f460000,0x3ef1bf7b,0xbf753ec4,0xbdc93f55
.long 0x3f350000,0x3f35bf80,0xbf350000,0xbf353f80,0x3f220000,0x3f62bf7b,0xbe95bec4,0xbf7f3f55
.long 0x3f0e0000,0x3f7bbf6d,0x3e48bf35,0xbf553ec4,0x3ef10000,0x3f7fbf55,0x3f22bf6d,0xbe95be48
.long 0x3ec40000,0x3f6dbf35,0x3f6dbf80,0x3ec4bf35,0x3e950000,0x3f46bf0e,0x3f7fbf6d,0x3f62bf7b
.long 0x3e480000,0x3f0ebec4,0x3f55bf35,0x3f7bbf6d,0x3dc90000,0x3e95be48,0x3ef1bec4,0x3f22bf0e
.long 0x3f800000,0xbf800000,0x3f800000,0xbf800000,0x3f223f35,0xbef1bf55,0x3e953f6d,0xbdc9bf7b
.long 0xbe483f80,0x3f0ebf6d,0xbf553f35,0x3f7bbec4,0xbf623f35,0x3f7fbe48,0xbf46bec4,0x3e953f55
.long 0xbf6d0000,0x3ec43f35,0x3ec4bf80,0xbf6d3f35,0xbe95bf35,0xbf223f7b,0x3f7fbec4,0xbef1bf0e
.long 0x3f0ebf80,0xbf7b3ec4,0x3e483f35,0x3f55bf6d,0x3f7fbf35,0xbe95bf0e,0xbf623f6d,0x3f223e48
.long 0x3f350000,0x3f35bf80,0xbf350000,0xbf353f80,0xbdc93f35,0x3f75bf0e,0x3ef1bf6d,0xbf463e48
.long 0xbf553f80,0x3e483ec4,0x3f7bbf35,0x3f0ebf6d,0xbf753f35,0xbf463f7b,0x3dc93ec4,0x3f62bf0e
.long 0xbec40000,0xbf6d3f35,0xbf6d3f80,0xbec43f35,0x3ef1bf35,0xbdc9be48,0xbf223ec4,0xbf753f55
.long 0x3f7bbf80,0x3f55bf6d,0x3f0ebf35,0x3e48bec4,0x3f46bf35,0x3f62bf55,0x3f75bf6d,0x3f7fbf7b
.long 0x3f800000,0xbf800000,0x3f800000,0xbf800000,0xbdc93f80,0x3e95bf7b,0xbef13f6d,0x3f22bf55
.long 0xbf7b0000,0x3f553ec4,0xbf0ebf35,0x3e483f6d,0x3e95bf80,0xbf463f55,0x3f7fbec4,0xbf62be48
.long 0x3f6d0000,0xbec4bf35,0xbec43f80,0x3f6dbf35,0xbef13f80,0x3f7fbf0e,0xbf22bec4,0xbe953f7b
.long 0xbf550000,0xbe483f6d,0x3f7bbf35,0xbf0ebec4,0x3f22bf80,0xbf623e48,0xbe953f6d,0x3f7fbf0e
.long 0x3f350000,0x3f35bf80,0xbf350000,0xbf353f80,0xbf463f80,0x3ef13e48,0x3f75bf6d,0xbdc9bf0e
.long 0xbf0e0000,0xbf7b3f6d,0xbe483f35,0x3f55bec4,0x3f62bf80,0x3dc9bf0e,0xbf463ec4,0xbf753f7b
.long 0x3ec40000,0x3f6dbf35,0x3f6dbf80,0x3ec4bf35,0xbf753f80,0xbf223f55,0xbdc93ec4,0x3ef1be48
.long 0xbe480000,0xbf0e3ec4,0xbf553f35,0xbf7b3f6d,0x3f7fbf80,0x3f75bf7b,0x3f62bf6d,0x3f46bf55
.long 0x3f800000,0xbf800000,0x3f800000,0xbf800000,0xbf463f35,0x3f62bf0e,0xbf753ec4,0x3f7fbe48
.long 0x3e48bf80,0xbf0e3f6d,0x3f55bf35,0xbf7b3ec4,0x3ef13f35,0x3dc9bf7b,0xbf223f6d,0x3f75bf0e
.long 0xbf6d0000,0x3ec43f35,0x3ec4bf80,0xbf6d3f35,0x3f75bf35,0xbf46be48,0xbdc93f6d,0x3f62bf55
.long 0xbf0e3f80,0x3f7bbec4,0xbe48bf35,0xbf553f6d,0xbdc9bf35,0xbf753f55,0x3ef13ec4,0x3f46bf7b
.long 0x3f350000,0x3f35bf80,0xbf350000,0xbf353f80,0xbf7f3f35,0xbe953f55,0x3f62bec4,0x3f22bf7b
.long 0x3f55bf80,0xbe48bec4,0xbf7b3f35,0xbf0e3f6d,0xbe953f35,0x3f22be48,0x3f7fbf6d,0x3ef1bf55
.long 0xbec40000,0xbf6d3f35,0xbf6d3f80,0xbec43f35,0x3f62bf35,0x3f7fbf7b,0x3f46bf6d,0x3e95bf0e
.long 0xbf7b3f80,0xbf553f6d,0xbf0e3f35,0xbe483ec4,0x3f22bf35,0x3ef1bf0e,0x3e95bec4,0x3dc9be48
.long 0x3f800000,0xbf800000,0x3f800000,0xbf800000,0xbf7f0000,0x3f753e48,0xbf62bec4,0x3f463f0e
.long 0x3f7b0000,0xbf55bec4,0x3f0e3f35,0xbe48bf6d,0xbf750000,0x3f223f0e,0xbdc9bf6d,0xbef13f7b
.long 0x3f6d0000,0xbec4bf35,0xbec43f80,0x3f6dbf35,0xbf620000,0x3dc93f55,0x3f46bf6d,0xbf753e48
.long 0x3f550000,0x3e48bf6d,0xbf7b3f35,0x3f0e3ec4,0xbf460000,0xbef13f7b,0x3f75bec4,0x3dc9bf55
.long 0x3f350000,0x3f35bf80,0xbf350000,0xbf353f80,0xbf220000,0xbf623f7b,0x3e953ec4,0x3f7fbf55
.long 0x3f0e0000,0x3f7bbf6d,0x3e48bf35,0xbf553ec4,0xbef10000,0xbf7f3f55,0xbf223f6d,0x3e953e48
.long 0x3ec40000,0x3f6dbf35,0x3f6dbf80,0x3ec4bf35,0xbe950000,0xbf463f0e,0xbf7f3f6d,0xbf623f7b
.long 0x3e480000,0x3f0ebec4,0x3f55bf35,0x3f7bbf6d,0xbdc90000,0xbe953e48,0xbef13ec4,0xbf223f0e
.long 0x3f800000,0xbf800000,0x3f800000,0xbf800000,0xbf22bf35,0x3ef13f55,0xbe95bf6d,0x3dc93f7b
.long 0xbe483f80,0x3f0ebf6d,0xbf553f35,0x3f7bbec4,0x3f62bf35,0xbf7f3e48,0x3f463ec4,0xbe95bf55
.long 0xbf6d0000,0x3ec43f35,0x3ec4bf80,0xbf6d3f35,0x3e953f35,0x3f22bf7b,0xbf7f3ec4,0x3ef13f0e
.long 0x3f0ebf80,0xbf7b3ec4,0x3e483f35,0x3f55bf6d,0xbf7f3f35,0x3e953f0e,0x3f62bf6d,0xbf22be48
.long 0x3f350000,0x3f35bf80,0xbf350000,0xbf353f80,0x3dc9bf35,0xbf753f0e,0xbef13f6d,0x3f46be48
.long 0xbf553f80,0x3e483ec4,0x3f7bbf35,0x3f0ebf6d,0x3f75bf35,0x3f46bf7b,0xbdc9bec4,0xbf623f0e
.long 0xbec40000,0xbf6d3f35,0xbf6d3f80,0xbec43f35,0xbef13f35,0x3dc93e48,0x3f22bec4,0x3f75bf55
.long 0x3f7bbf80,0x3f55bf6d,0x3f0ebf35,0x3e48bec4,0xbf463f35,0xbf623f55,0xbf753f6d,0xbf7f3f7b
.long 0x3f800000,0xbf800000,0x3f800000,0xbf800000,0x3dc9bf80,0xbe953f7b,0x3ef1bf6d,0xbf223f55
.long 0xbf7b0000,0x3f553ec4,0xbf0ebf35,0x3e483f6d,0xbe953f80,0x3f46bf55,0xbf7f3ec4,0x3f623e48
.long 0x3f6d0000,0xbec4bf35,0xbec43f80,0x3f6dbf35,0x3ef1bf80,0xbf7f3f0e,0x3f223ec4,0x3e95bf7b
.long 0xbf550000,0xbe483f6d,0x3f7bbf35,0xbf0ebec4,0xbf223f80,0x3f62be48,0x3e95bf6d,0xbf7f3f0e
.long 0x3f350000,0x3f35bf80,0xbf350000,0xbf353f80,0x3f46bf80,0xbef1be48,0xbf753f6d,0x3dc93f0e
.long 0xbf0e0000,0xbf7b3f6d,0xbe483f35,0x3f55bec4,0xbf623f80,0xbdc93f0e,0x3f46bec4,0x3f75bf7b
.long 0x3ec40000,0x3f6dbf35,0x3f6dbf80,0x3ec4bf35,0x3f75bf80,0x3f22bf55,0x3dc9bec4,0xbef13e48
.long 0xbe480000,0xbf0e3ec4,0xbf553f35,0xbf7b3f6d,0xbf7f3f80,0xbf753f7b,0xbf623f6d,0xbf463f55
.long 0x3f800000,0xbf800000,0x3f800000,0xbf800000,0x3f46bf35,0xbf623f0e,0x3f75bec4,0xbf7f3e48
.long 0x3e48bf80,0xbf0e3f6d,0x3f55bf35,0xbf7b3ec4,0xbef1bf35,0xbdc93f7b,0x3f22bf6d,0xbf753f0e
.long 0xbf6d0000,0x3ec43f35,0x3ec4bf80,0xbf6d3f35,0xbf753f35,0x3f463e48,0x3dc9bf6d,0xbf623f55
.long 0xbf0e3f80,0x3f7bbec4,0xbe48bf35,0xbf553f6d,0x3dc93f35,0x3f75bf55,0xbef1bec4,0xbf463f7b
.long 0x3f350000,0x3f35bf80,0xbf350000,0xbf353f80,0x3f7fbf35,0x3e95bf55,0xbf623ec4,0xbf223f7b
.long 0x3f55bf80,0xbe48bec4,0xbf7b3f35,0xbf0e3f6d,0x3e95bf35,0xbf223e48,0xbf7f3f6d,0xbef13f55
.long 0xbec40000,0xbf6d3f35,0xbf6d3f80,0xbec43f35,0xbf623f35,0xbf7f3f7b,0xbf463f6d,0xbe953f0e
.long 0xbf7b3f80,0xbf553f6d,0xbf0e3f35,0xbe483ec4,0xbf223f35,0xbef13f0e,0xbe953ec4,0xbdc93e48
.long 0xbf800000,0x3f800000,0xbf800000,0x3f800000,0xbf7f0000,0x3f753e48,0xbf62bec4,0x3f463f0e
.long 0xbf7b0000,0x3f553ec4,0xbf0ebf35,0x3e483f6d,0xbf750000,0x3f223f0e,0xbdc9bf6d,0xbef13f7b
.long 0xbf6d0000,0x3ec43f35,0x3ec4bf80,0xbf6d3f35,0xbf620000,0x3dc93f55,0x3f46bf6d,0xbf753e48
.long 0xbf550000,0xbe483f6d,0x3f7bbf35,0xbf0ebec4,0xbf460000,0xbef13f7b,0x3f75bec4,0x3dc9bf55
.long 0xbf350000,0xbf353f80,0x3f350000,0x3f35bf80,0xbf220000,0xbf623f7b,0x3e953ec4,0x3f7fbf55
.long 0xbf0e0000,0xbf7b3f6d,0xbe483f35,0x3f55bec4,0xbef10000,0xbf7f3f55,0xbf223f6d,0x3e953e48
.long 0xbec40000,0xbf6d3f35,0xbf6d3f80,0xbec43f35,0xbe950000,0xbf463f0e,0xbf7f3f6d,0xbf623f7b
.long 0xbe480000,0xbf0e3ec4,0xbf553f35,0xbf7b3f6d,0xbdc90000,0xbe953e48,0xbef13ec4,0xbf223f0e
.long 0xbf800000,0x3f800000,0xbf800000,0x3f800000,0xbf22bf35,0x3ef13f55,0xbe95bf6d,0x3dc93f7b
.long 0x3e48bf80,0xbf0e3f6d,0x3f55bf35,0xbf7b3ec4,0x3f62bf35,0xbf7f3e48,0x3f463ec4,0xbe95bf55
.long 0x3f6d0000,0xbec4bf35,0xbec43f80,0x3f6dbf35,0x3e953f35,0x3f22bf7b,0xbf7f3ec4,0x3ef13f0e
.long 0xbf0e3f80,0x3f7bbec4,0xbe48bf35,0xbf553f6d,0xbf7f3f35,0x3e953f0e,0x3f62bf6d,0xbf22be48
.long 0xbf350000,0xbf353f80,0x3f350000,0x3f35bf80,0x3dc9bf35,0xbf753f0e,0xbef13f6d,0x3f46be48
.long 0x3f55bf80,0xbe48bec4,0xbf7b3f35,0xbf0e3f6d,0x3f75bf35,0x3f46bf7b,0xbdc9bec4,0xbf623f0e
.long 0x3ec40000,0x3f6dbf35,0x3f6dbf80,0x3ec4bf35,0xbef13f35,0x3dc93e48,0x3f22bec4,0x3f75bf55
.long 0xbf7b3f80,0xbf553f6d,0xbf0e3f35,0xbe483ec4,0xbf463f35,0xbf623f55,0xbf753f6d,0xbf7f3f7b
.long 0xbf800000,0x3f800000,0xbf800000,0x3f800000,0x3dc9bf80,0xbe953f7b,0x3ef1bf6d,0xbf223f55
.long 0x3f7b0000,0xbf55bec4,0x3f0e3f35,0xbe48bf6d,0xbe953f80,0x3f46bf55,0xbf7f3ec4,0x3f623e48
.long 0xbf6d0000,0x3ec43f35,0x3ec4bf80,0xbf6d3f35,0x3ef1bf80,0xbf7f3f0e,0x3f223ec4,0x3e95bf7b
.long 0x3f550000,0x3e48bf6d,0xbf7b3f35,0x3f0e3ec4,0xbf223f80,0x3f62be48,0x3e95bf6d,0xbf7f3f0e
.long 0xbf350000,0xbf353f80,0x3f350000,0x3f35bf80,0x3f46bf80,0xbef1be48,0xbf753f6d,0x3dc93f0e
.long 0x3f0e0000,0x3f7bbf6d,0x3e48bf35,0xbf553ec4,0xbf623f80,0xbdc93f0e,0x3f46bec4,0x3f75bf7b
.long 0xbec40000,0xbf6d3f35,0xbf6d3f80,0xbec43f35,0x3f75bf80,0x3f22bf55,0x3dc9bec4,0xbef13e48
.long 0x3e480000,0x3f0ebec4,0x3f55bf35,0x3f7bbf6d,0xbf7f3f80,0xbf753f7b,0xbf623f6d,0xbf463f55
.long 0xbf800000,0x3f800000,0xbf800000,0x3f800000,0x3f46bf35,0xbf623f0e,0x3f75bec4,0xbf7f3e48
.long 0xbe483f80,0x3f0ebf6d,0xbf553f35,0x3f7bbec4,0xbef1bf35,0xbdc93f7b,0x3f22bf6d,0xbf753f0e
.long 0x3f6d0000,0xbec4bf35,0xbec43f80,0x3f6dbf35,0xbf753f35,0x3f463e48,0x3dc9bf6d,0xbf623f55
.long 0x3f0ebf80,0xbf7b3ec4,0x3e483f35,0x3f55bf6d,0x3dc93f35,0x3f75bf55,0xbef1bec4,0xbf463f7b
.long 0xbf350000,0xbf353f80,0x3f350000,0x3f35bf80,0x3f7fbf35,0x3e95bf55,0xbf623ec4,0xbf223f7b
.long 0xbf553f80,0x3e483ec4,0x3f7bbf35,0x3f0ebf6d,0x3e95bf35,0xbf223e48,0xbf7f3f6d,0xbef13f55
.long 0x3ec40000,0x3f6dbf35,0x3f6dbf80,0x3ec4bf35,0xbf623f35,0xbf7f3f7b,0xbf463f6d,0xbe953f0e
.long 0x3f7bbf80,0x3f55bf6d,0x3f0ebf35,0x3e48bec4,0xbf223f35,0xbef13f0e,0xbe953ec4,0xbdc93e48
.long 0xbf800000,0x3f800000,0xbf800000,0x3f800000,0x3f7f0000,0xbf75be48,0x3f623ec4,0xbf46bf0e
.long 0xbf7b0000,0x3f553ec4,0xbf0ebf35,0x3e483f6d,0x3f750000,0xbf22bf0e,0x3dc93f6d,0x3ef1bf7b
.long 0xbf6d0000,0x3ec43f35,0x3ec4bf80,0xbf6d3f35,0x3f620000,0xbdc9bf55,0xbf463f6d,0x3f75be48
.long 0xbf550000,0xbe483f6d,0x3f7bbf35,0xbf0ebec4,0x3f460000,0x3ef1bf7b,0xbf753ec4,0xbdc93f55
.long 0xbf350000,0xbf353f80,0x3f350000,0x3f35bf80,0x3f220000,0x3f62bf7b,0xbe95bec4,0xbf7f3f55
.long 0xbf0e0000,0xbf7b3f6d,0xbe483f35,0x3f55bec4,0x3ef10000,0x3f7fbf55,0x3f22bf6d,0xbe95be48
.long 0xbec40000,0xbf6d3f35,0xbf6d3f80,0xbec43f35,0x3e950000,0x3f46bf0e,0x3f7fbf6d,0x3f62bf7b
.long 0xbe480000,0xbf0e3ec4,0xbf553f35,0xbf7b3f6d,0x3dc90000,0x3e95be48,0x3ef1bec4,0x3f22bf0e
.long 0xbf800000,0x3f800000,0xbf800000,0x3f800000,0x3f223f35,0xbef1bf55,0x3e953f6d,0xbdc9bf7b
.long 0x3e48bf80,0xbf0e3f6d,0x3f55bf35,0xbf7b3ec4,0xbf623f35,0x3f7fbe48,0xbf46bec4,0x3e953f55
.long 0x3f6d0000,0xbec4bf35,0xbec43f80,0x3f6dbf35,0xbe95bf35,0xbf223f7b,0x3f7fbec4,0xbef1bf0e
.long 0xbf0e3f80,0x3f7bbec4,0xbe48bf35,0xbf553f6d,0x3f7fbf35,0xbe95bf0e,0xbf623f6d,0x3f223e48
.long 0xbf350000,0xbf353f80,0x3f350000,0x3f35bf80,0xbdc93f35,0x3f75bf0e,0x3ef1bf6d,0xbf463e48
.long 0x3f55bf80,0xbe48bec4,0xbf7b3f35,0xbf0e3f6d,0xbf753f35,0xbf463f7b,0x3dc93ec4,0x3f62bf0e
.long 0x3ec40000,0x3f6dbf35,0x3f6dbf80,0x3ec4bf35,0x3ef1bf35,0xbdc9be48,0xbf223ec4,0xbf753f55
.long 0xbf7b3f80,0xbf553f6d,0xbf0e3f35,0xbe483ec4,0x3f46bf35,0x3f62bf55,0x3f75bf6d,0x3f7fbf7b
.long 0xbf800000,0x3f800000,0xbf800000,0x3f800000,0xbdc93f80,0x3e95bf7b,0xbef13f6d,0x3f22bf55
.long 0x3f7b0000,0xbf55bec4,0x3f0e3f35,0xbe48bf6d,0x3e95bf80,0xbf463f55,0x3f7fbec4,0xbf62be48
.long 0xbf6d0000,0x3ec43f35,0x3ec4bf80,0xbf6d3f35,0xbef13f80,0x3f7fbf0e,0xbf22bec4,0xbe953f7b
.long 0x3f550000,0x3e48bf6d,0xbf7b3f35,0x3f0e3ec4,0x3f22bf80,0xbf623e48,0xbe953f6d,0x3f7fbf0e
.long 0xbf350000,0xbf353f80,0x3f350000,0x3f35bf80,0xbf463f80,0x3ef13e48,0x3f75bf6d,0xbdc9bf0e
.long 0x3f0e0000,0x3f7bbf6d,0x3e48bf35,0xbf553ec4,0x3f62bf80,0x3dc9bf0e,0xbf463ec4,0xbf753f7b
.long 0xbec40000,0xbf6d3f35,0xbf6d3f80,0xbec43f35,0xbf753f80,0xbf223f55,0xbdc93ec4,0x3ef1be48
.long 0x3e480000,0x3f0ebec4,0x3f55bf35,0x3f7bbf6d,0x3f7fbf80,0x3f75bf7b,0x3f62bf6d,0x3f46bf55
.long 0xbf800000,0x3f800000,0xbf800000,0x3f800000,0xbf463f35,0x3f62bf0e,0xbf753ec4,0x3f7fbe48
.long 0xbe483f80,0x3f0ebf6d,0xbf553f35,0x3f7bbec4,0x3ef13f35,0x3dc9bf7b,0xbf223f6d,0x3f75bf0e
.long 0x3f6d0000,0xbec4bf35,0xbec43f80,0x3f6dbf35,0x3f75bf35,0xbf46be48,0xbdc93f6d,0x3f62bf55
.long 0x3f0ebf80,0xbf7b3ec4,0x3e483f35,0x3f55bf6d,0xbdc9bf35,0xbf753f55,0x3ef13ec4,0x3f46bf7b
.long 0xbf350000,0xbf353f80,0x3f350000,0x3f35bf80,0xbf7f3f35,0xbe953f55,0x3f62bec4,0x3f22bf7b
.long 0xbf553f80,0x3e483ec4,0x3f7bbf35,0x3f0ebf6d,0xbe953f35,0x3f22be48,0x3f7fbf6d,0x3ef1bf55
.long 0x3ec40000,0x3f6dbf35,0x3f6dbf80,0x3ec4bf35,0x3f62bf35,0x3f7fbf7b,0x3f46bf6d,0x3e95bf0e
.long 0x3f7bbf80,0x3f55bf6d,0x3f0ebf35,0x3e48bec4,0x3f22bf35,0x3ef1bf0e,0x3e95bec4,0x3dc9be48
.long 0xbf803f80,0xbf803f80,0xbf803f80,0xbf803f80,0xbf7f3f80,0xbf753f7b,0xbf623f6d,0xbf463f55
.long 0xbf7b3f80,0xbf553f6d,0xbf0e3f35,0xbe483ec4,0xbf753f80,0xbf223f55,0xbdc93ec4,0x3ef1be48
.long 0xbf6d3f80,0xbec43f35,0x3ec40000,0x3f6dbf35,0xbf623f80,0xbdc93f0e,0x3f46bec4,0x3f75bf7b
.long 0xbf553f80,0x3e483ec4,0x3f7bbf35,0x3f0ebf6d,0xbf463f80,0x3ef13e48,0x3f75bf6d,0xbdc9bf0e
.long 0xbf353f80,0x3f350000,0x3f35bf80,0xbf350000,0xbf223f80,0x3f62be48,0x3e95bf6d,0xbf7f3f0e
.long 0xbf0e3f80,0x3f7bbec4,0xbe48bf35,0xbf553f6d,0xbef13f80,0x3f7fbf0e,0xbf22bec4,0xbe953f7b
.long 0xbec43f80,0x3f6dbf35,0xbf6d0000,0x3ec43f35,0xbe953f80,0x3f46bf55,0xbf7f3ec4,0x3f623e48
.long 0xbe483f80,0x3f0ebf6d,0xbf553f35,0x3f7bbec4,0xbdc93f80,0x3e95bf7b,0xbef13f6d,0x3f22bf55
.long 0xbf803f80,0xbf803f80,0xbf803f80,0xbf803f80,0xbf223f35,0xbef13f0e,0xbe953ec4,0xbdc93e48
.long 0x3e480000,0x3f0ebec4,0x3f55bf35,0x3f7bbf6d,0x3f62bf35,0x3f7fbf7b,0x3f46bf6d,0x3e95bf0e
.long 0x3f6dbf80,0x3ec4bf35,0xbec40000,0xbf6d3f35,0x3e95bf35,0xbf223e48,0xbf7f3f6d,0xbef13f55
.long 0xbf0e0000,0xbf7b3f6d,0xbe483f35,0x3f55bec4,0xbf7f3f35,0xbe953f55,0x3f62bec4,0x3f22bf7b
.long 0xbf353f80,0x3f350000,0x3f35bf80,0xbf350000,0x3dc93f35,0x3f75bf55,0xbef1bec4,0xbf463f7b
.long 0x3f550000,0x3e48bf6d,0xbf7b3f35,0x3f0e3ec4,0x3f75bf35,0xbf46be48,0xbdc93f6d,0x3f62bf55
.long 0x3ec4bf80,0xbf6d3f35,0x3f6d0000,0xbec4bf35,0xbef1bf35,0xbdc93f7b,0x3f22bf6d,0xbf753f0e
.long 0xbf7b0000,0x3f553ec4,0xbf0ebf35,0x3e483f6d,0xbf463f35,0x3f62bf0e,0xbf753ec4,0x3f7fbe48
.long 0xbf803f80,0xbf803f80,0xbf803f80,0xbf803f80,0x3dc90000,0x3e95be48,0x3ef1bec4,0x3f22bf0e
.long 0x3f7bbf80,0x3f55bf6d,0x3f0ebf35,0x3e48bec4,0xbe950000,0xbf463f0e,0xbf7f3f6d,0xbf623f7b
.long 0xbf6d3f80,0xbec43f35,0x3ec40000,0x3f6dbf35,0x3ef10000,0x3f7fbf55,0x3f22bf6d,0xbe95be48
.long 0x3f55bf80,0xbe48bec4,0xbf7b3f35,0xbf0e3f6d,0xbf220000,0xbf623f7b,0x3e953ec4,0x3f7fbf55
.long 0xbf353f80,0x3f350000,0x3f35bf80,0xbf350000,0x3f460000,0x3ef1bf7b,0xbf753ec4,0xbdc93f55
.long 0x3f0ebf80,0xbf7b3ec4,0x3e483f35,0x3f55bf6d,0xbf620000,0x3dc93f55,0x3f46bf6d,0xbf753e48
.long 0xbec43f80,0x3f6dbf35,0xbf6d0000,0x3ec43f35,0x3f750000,0xbf22bf0e,0x3dc93f6d,0x3ef1bf7b
.long 0x3e48bf80,0xbf0e3f6d,0x3f55bf35,0xbf7b3ec4,0xbf7f0000,0x3f753e48,0xbf62bec4,0x3f463f0e
.long 0xbf803f80,0xbf803f80,0xbf803f80,0xbf803f80,0x3f46bf35,0x3f62bf55,0x3f75bf6d,0x3f7fbf7b
.long 0xbe480000,0xbf0e3ec4,0xbf553f35,0xbf7b3f6d,0xbef13f35,0x3dc93e48,0x3f22bec4,0x3f75bf55
.long 0x3f6dbf80,0x3ec4bf35,0xbec40000,0xbf6d3f35,0xbf753f35,0xbf463f7b,0x3dc93ec4,0x3f62bf0e
.long 0x3f0e0000,0x3f7bbf6d,0x3e48bf35,0xbf553ec4,0x3dc9bf35,0xbf753f0e,0xbef13f6d,0x3f46be48
.long 0xbf353f80,0x3f350000,0x3f35bf80,0xbf350000,0x3f7fbf35,0xbe95bf0e,0xbf623f6d,0x3f223e48
.long 0xbf550000,0xbe483f6d,0x3f7bbf35,0xbf0ebec4,0x3e953f35,0x3f22bf7b,0xbf7f3ec4,0x3ef13f0e
.long 0x3ec4bf80,0xbf6d3f35,0x3f6d0000,0xbec4bf35,0xbf623f35,0x3f7fbe48,0xbf46bec4,0x3e953f55
.long 0x3f7b0000,0xbf55bec4,0x3f0e3f35,0xbe48bf6d,0xbf22bf35,0x3ef13f55,0xbe95bf6d,0x3dc93f7b
.long 0xbf803f80,0xbf803f80,0xbf803f80,0xbf803f80,0x3f7fbf80,0x3f75bf7b,0x3f62bf6d,0x3f46bf55
.long 0xbf7b3f80,0xbf553f6d,0xbf0e3f35,0xbe483ec4,0x3f75bf80,0x3f22bf55,0x3dc9bec4,0xbef13e48
.long 0xbf6d3f80,0xbec43f35,0x3ec40000,0x3f6dbf35,0x3f62bf80,0x3dc9bf0e,0xbf463ec4,0xbf753f7b
.long 0xbf553f80,0x3e483ec4,0x3f7bbf35,0x3f0ebf6d,0x3f46bf80,0xbef1be48,0xbf753f6d,0x3dc93f0e
.long 0xbf353f80,0x3f350000,0x3f35bf80,0xbf350000,0x3f22bf80,0xbf623e48,0xbe953f6d,0x3f7fbf0e
.long 0xbf0e3f80,0x3f7bbec4,0xbe48bf35,0xbf553f6d,0x3ef1bf80,0xbf7f3f0e,0x3f223ec4,0x3e95bf7b
.long 0xbec43f80,0x3f6dbf35,0xbf6d0000,0x3ec43f35,0x3e95bf80,0xbf463f55,0x3f7fbec4,0xbf62be48
.long 0xbe483f80,0x3f0ebf6d,0xbf553f35,0x3f7bbec4,0x3dc9bf80,0xbe953f7b,0x3ef1bf6d,0xbf223f55
.long 0xbf803f80,0xbf803f80,0xbf803f80,0xbf803f80,0x3f22bf35,0x3ef1bf0e,0x3e95bec4,0x3dc9be48
.long 0x3e480000,0x3f0ebec4,0x3f55bf35,0x3f7bbf6d,0xbf623f35,0xbf7f3f7b,0xbf463f6d,0xbe953f0e
.long 0x3f6dbf80,0x3ec4bf35,0xbec40000,0xbf6d3f35,0xbe953f35,0x3f22be48,0x3f7fbf6d,0x3ef1bf55
.long 0xbf0e0000,0xbf7b3f6d,0xbe483f35,0x3f55bec4,0x3f7fbf35,0x3e95bf55,0xbf623ec4,0xbf223f7b
.long 0xbf353f80,0x3f350000,0x3f35bf80,0xbf350000,0xbdc9bf35,0xbf753f55,0x3ef13ec4,0x3f46bf7b
.long 0x3f550000,0x3e48bf6d,0xbf7b3f35,0x3f0e3ec4,0xbf753f35,0x3f463e48,0x3dc9bf6d,0xbf623f55
.long 0x3ec4bf80,0xbf6d3f35,0x3f6d0000,0xbec4bf35,0x3ef13f35,0x3dc9bf7b,0xbf223f6d,0x3f75bf0e
.long 0xbf7b0000,0x3f553ec4,0xbf0ebf35,0x3e483f6d,0x3f46bf35,0xbf623f0e,0x3f75bec4,0xbf7f3e48
.long 0xbf803f80,0xbf803f80,0xbf803f80,0xbf803f80,0xbdc90000,0xbe953e48,0xbef13ec4,0xbf223f0e
.long 0x3f7bbf80,0x3f55bf6d,0x3f0ebf35,0x3e48bec4,0x3e950000,0x3f46bf0e,0x3f7fbf6d,0x3f62bf7b
.long 0xbf6d3f80,0xbec43f35,0x3ec40000,0x3f6dbf35,0xbef10000,0xbf7f3f55,0xbf223f6d,0x3e953e48
.long 0x3f55bf80,0xbe48bec4,0xbf7b3f35,0xbf0e3f6d,0x3f220000,0x3f62bf7b,0xbe95bec4,0xbf7f3f55
.long 0xbf353f80,0x3f350000,0x3f35bf80,0xbf350000,0xbf460000,0xbef13f7b,0x3f75bec4,0x3dc9bf55
.long 0x3f0ebf80,0xbf7b3ec4,0x3e483f35,0x3f55bf6d,0x3f620000,0xbdc9bf55,0xbf463f6d,0x3f75be48
.long 0xbec43f80,0x3f6dbf35,0xbf6d0000,0x3ec43f35,0xbf750000,0x3f223f0e,0xbdc9bf6d,0xbef13f7b
.long 0x3e48bf80,0xbf0e3f6d,0x3f55bf35,0xbf7b3ec4,0x3f7f0000,0xbf75be48,0x3f623ec4,0xbf46bf0e
.long 0xbf803f80,0xbf803f80,0xbf803f80,0xbf803f80,0xbf463f35,0xbf623f55,0xbf753f6d,0xbf7f3f7b
.long 0xbe480000,0xbf0e3ec4,0xbf553f35,0xbf7b3f6d,0x3ef1bf35,0xbdc9be48,0xbf223ec4,0xbf753f55
.long 0x3f6dbf80,0x3ec4bf35,0xbec40000,0xbf6d3f35,0x3f75bf35,0x3f46bf7b,0xbdc9bec4,0xbf623f0e
.long 0x3f0e0000,0x3f7bbf6d,0x3e48bf35,0xbf553ec4,0xbdc93f35,0x3f75bf0e,0x3ef1bf6d,0xbf463e48
.long 0xbf353f80,0x3f350000,0x3f35bf80,0xbf350000,0xbf7f3f35,0x3e953f0e,0x3f62bf6d,0xbf22be48
.long 0xbf550000,0xbe483f6d,0x3f7bbf35,0xbf0ebec4,0xbe95bf35,0xbf223f7b,0x3f7fbec4,0xbef1bf0e
.long 0x3ec4bf80,0xbf6d3f35,0x3f6d0000,0xbec4bf35,0x3f62bf35,0xbf7f3e48,0x3f463ec4,0xbe95bf55
.long 0x3f7b0000,0xbf55bec4,0x3f0e3f35,0xbe48bf6d,0x3f223f35,0xbef1bf55,0x3e953f6d,0xbdc9bf7b
.long 0x0,0x0,0x0,0x0,0xbdc90000,0xbe953e48,0xbef13ec4,0xbf223f0e
.long 0xbe480000,0xbf0e3ec4,0xbf553f35,0xbf7b3f6d,0xbe950000,0xbf463f0e,0xbf7f3f6d,0xbf623f7b
.long 0xbec40000,0xbf6d3f35,0xbf6d3f80,0xbec43f35,0xbef10000,0xbf7f3f55,0xbf223f6d,0x3e953e48
.long 0xbf0e0000,0xbf7b3f6d,0xbe483f35,0x3f55bec4,0xbf220000,0xbf623f7b,0x3e953ec4,0x3f7fbf55
.long 0xbf350000,0xbf353f80,0x3f350000,0x3f35bf80,0xbf460000,0xbef13f7b,0x3f75bec4,0x3dc9bf55
.long 0xbf550000,0xbe483f6d,0x3f7bbf35,0xbf0ebec4,0xbf620000,0x3dc93f55,0x3f46bf6d,0xbf753e48
.long 0xbf6d0000,0x3ec43f35,0x3ec4bf80,0xbf6d3f35,0xbf750000,0x3f223f0e,0xbdc9bf6d,0xbef13f7b
.long 0xbf7b0000,0x3f553ec4,0xbf0ebf35,0x3e483f6d,0xbf7f0000,0x3f753e48,0xbf62bec4,0x3f463f0e
.long 0x0,0x0,0x0,0x0,0xbf463f35,0xbf623f55,0xbf753f6d,0xbf7f3f7b
.long 0xbf7b3f80,0xbf553f6d,0xbf0e3f35,0xbe483ec4,0xbef13f35,0x3dc93e48,0x3f22bec4,0x3f75bf55
.long 0x3ec40000,0x3f6dbf35,0x3f6dbf80,0x3ec4bf35,0x3f75bf35,0x3f46bf7b,0xbdc9bec4,0xbf623f0e
.long 0x3f55bf80,0xbe48bec4,0xbf7b3f35,0xbf0e3f6d,0x3dc9bf35,0xbf753f0e,0xbef13f6d,0x3f46be48
.long 0xbf350000,0xbf353f80,0x3f350000,0x3f35bf80,0xbf7f3f35,0x3e953f0e,0x3f62bf6d,0xbf22be48
.long 0xbf0e3f80,0x3f7bbec4,0xbe48bf35,0xbf553f6d,0x3e953f35,0x3f22bf7b,0xbf7f3ec4,0x3ef13f0e
.long 0x3f6d0000,0xbec4bf35,0xbec43f80,0x3f6dbf35,0x3f62bf35,0xbf7f3e48,0x3f463ec4,0xbe95bf55
.long 0x3e48bf80,0xbf0e3f6d,0x3f55bf35,0xbf7b3ec4,0xbf22bf35,0x3ef13f55,0xbe95bf6d,0x3dc93f7b
.long 0x0,0x0,0x0,0x0,0xbf7f3f80,0xbf753f7b,0xbf623f6d,0xbf463f55
.long 0x3e480000,0x3f0ebec4,0x3f55bf35,0x3f7bbf6d,0x3f75bf80,0x3f22bf55,0x3dc9bec4,0xbef13e48
.long 0xbec40000,0xbf6d3f35,0xbf6d3f80,0xbec43f35,0xbf623f80,0xbdc93f0e,0x3f46bec4,0x3f75bf7b
.long 0x3f0e0000,0x3f7bbf6d,0x3e48bf35,0xbf553ec4,0x3f46bf80,0xbef1be48,0xbf753f6d,0x3dc93f0e
.long 0xbf350000,0xbf353f80,0x3f350000,0x3f35bf80,0xbf223f80,0x3f62be48,0x3e95bf6d,0xbf7f3f0e
.long 0x3f550000,0x3e48bf6d,0xbf7b3f35,0x3f0e3ec4,0x3ef1bf80,0xbf7f3f0e,0x3f223ec4,0x3e95bf7b
.long 0xbf6d0000,0x3ec43f35,0x3ec4bf80,0xbf6d3f35,0xbe953f80,0x3f46bf55,0xbf7f3ec4,0x3f623e48
.long 0x3f7b0000,0xbf55bec4,0x3f0e3f35,0xbe48bf6d,0x3dc9bf80,0xbe953f7b,0x3ef1bf6d,0xbf223f55
.long 0x0,0x0,0x0,0x0,0xbf223f35,0xbef13f0e,0xbe953ec4,0xbdc93e48
.long 0x3f7bbf80,0x3f55bf6d,0x3f0ebf35,0x3e48bec4,0xbf623f35,0xbf7f3f7b,0xbf463f6d,0xbe953f0e
.long 0x3ec40000,0x3f6dbf35,0x3f6dbf80,0x3ec4bf35,0x3e95bf35,0xbf223e48,0xbf7f3f6d,0xbef13f55
.long 0xbf553f80,0x3e483ec4,0x3f7bbf35,0x3f0ebf6d,0x3f7fbf35,0x3e95bf55,0xbf623ec4,0xbf223f7b
.long 0xbf350000,0xbf353f80,0x3f350000,0x3f35bf80,0x3dc93f35,0x3f75bf55,0xbef1bec4,0xbf463f7b
.long 0x3f0ebf80,0xbf7b3ec4,0x3e483f35,0x3f55bf6d,0xbf753f35,0x3f463e48,0x3dc9bf6d,0xbf623f55
.long 0x3f6d0000,0xbec4bf35,0xbec43f80,0x3f6dbf35,0xbef1bf35,0xbdc93f7b,0x3f22bf6d,0xbf753f0e
.long 0xbe483f80,0x3f0ebf6d,0xbf553f35,0x3f7bbec4,0x3f46bf35,0xbf623f0e,0x3f75bec4,0xbf7f3e48
.long 0x0,0x0,0x0,0x0,0x3dc90000,0x3e95be48,0x3ef1bec4,0x3f22bf0e
.long 0xbe480000,0xbf0e3ec4,0xbf553f35,0xbf7b3f6d,0x3e950000,0x3f46bf0e,0x3f7fbf6d,0x3f62bf7b
.long 0xbec40000,0xbf6d3f35,0xbf6d3f80,0xbec43f35,0x3ef10000,0x3f7fbf55,0x3f22bf6d,0xbe95be48
.long 0xbf0e0000,0xbf7b3f6d,0xbe483f35,0x3f55bec4,0x3f220000,0x3f62bf7b,0xbe95bec4,0xbf7f3f55
.long 0xbf350000,0xbf353f80,0x3f350000,0x3f35bf80,0x3f460000,0x3ef1bf7b,0xbf753ec4,0xbdc93f55
.long 0xbf550000,0xbe483f6d,0x3f7bbf35,0xbf0ebec4,0x3f620000,0xbdc9bf55,0xbf463f6d,0x3f75be48
.long 0xbf6d0000,0x3ec43f35,0x3ec4bf80,0xbf6d3f35,0x3f750000,0xbf22bf0e,0x3dc93f6d,0x3ef1bf7b
.long 0xbf7b0000,0x3f553ec4,0xbf0ebf35,0x3e483f6d,0x3f7f0000,0xbf75be48,0x3f623ec4,0xbf46bf0e
.long 0x0,0x0,0x0,0x0,0x3f46bf35,0x3f62bf55,0x3f75bf6d,0x3f7fbf7b
.long 0xbf7b3f80,0xbf553f6d,0xbf0e3f35,0xbe483ec4,0x3ef1bf35,0xbdc9be48,0xbf223ec4,0xbf753f55
.long 0x3ec40000,0x3f6dbf35,0x3f6dbf80,0x3ec4bf35,0xbf753f35,0xbf463f7b,0x3dc93ec4,0x3f62bf0e
.long 0x3f55bf80,0xbe48bec4,0xbf7b3f35,0xbf0e3f6d,0xbdc93f35,0x3f75bf0e,0x3ef1bf6d,0xbf463e48
.long 0xbf350000,0xbf353f80,0x3f350000,0x3f35bf80,0x3f7fbf35,0xbe95bf0e,0xbf623f6d,0x3f223e48
.long 0xbf0e3f80,0x3f7bbec4,0xbe48bf35,0xbf553f6d,0xbe95bf35,0xbf223f7b,0x3f7fbec4,0xbef1bf0e
.long 0x3f6d0000,0xbec4bf35,0xbec43f80,0x3f6dbf35,0xbf623f35,0x3f7fbe48,0xbf46bec4,0x3e953f55
.long 0x3e48bf80,0xbf0e3f6d,0x3f55bf35,0xbf7b3ec4,0x3f223f35,0xbef1bf55,0x3e953f6d,0xbdc9bf7b
.long 0x0,0x0,0x0,0x0,0x3f7fbf80,0x3f75bf7b,0x3f62bf6d,0x3f46bf55
.long 0x3e480000,0x3f0ebec4,0x3f55bf35,0x3f7bbf6d,0xbf753f80,0xbf223f55,0xbdc93ec4,0x3ef1be48
.long 0xbec40000,0xbf6d3f35,0xbf6d3f80,0xbec43f35,0x3f62bf80,0x3dc9bf0e,0xbf463ec4,0xbf753f7b
.long 0x3f0e0000,0x3f7bbf6d,0x3e48bf35,0xbf553ec4,0xbf463f80,0x3ef13e48,0x3f75bf6d,0xbdc9bf0e
.long 0xbf350000,0xbf353f80,0x3f350000,0x3f35bf80,0x3f22bf80,0xbf623e48,0xbe953f6d,0x3f7fbf0e
.long 0x3f550000,0x3e48bf6d,0xbf7b3f35,0x3f0e3ec4,0xbef13f80,0x3f7fbf0e,0xbf22bec4,0xbe953f7b
.long 0xbf6d0000,0x3ec43f35,0x3ec4bf80,0xbf6d3f35,0x3e95bf80,0xbf463f55,0x3f7fbec4,0xbf62be48
.long 0x3f7b0000,0xbf55bec4,0x3f0e3f35,0xbe48bf6d,0xbdc93f80,0x3e95bf7b,0xbef13f6d,0x3f22bf55
.long 0x0,0x0,0x0,0x0,0x3f22bf35,0x3ef1bf0e,0x3e95bec4,0x3dc9be48
.long 0x3f7bbf80,0x3f55bf6d,0x3f0ebf35,0x3e48bec4,0x3f62bf35,0x3f7fbf7b,0x3f46bf6d,0x3e95bf0e
.long 0x3ec40000,0x3f6dbf35,0x3f6dbf80,0x3ec4bf35,0xbe953f35,0x3f22be48,0x3f7fbf6d,0x3ef1bf55
.long 0xbf553f80,0x3e483ec4,0x3f7bbf35,0x3f0ebf6d,0xbf7f3f35,0xbe953f55,0x3f62bec4,0x3f22bf7b
.long 0xbf350000,0xbf353f80,0x3f350000,0x3f35bf80,0xbdc9bf35,0xbf753f55,0x3ef13ec4,0x3f46bf7b
.long 0x3f0ebf80,0xbf7b3ec4,0x3e483f35,0x3f55bf6d,0x3f75bf35,0xbf46be48,0xbdc93f6d,0x3f62bf55
.long 0x3f6d0000,0xbec4bf35,0xbec43f80,0x3f6dbf35,0x3ef13f35,0x3dc9bf7b,0xbf223f6d,0x3f75bf0e
.long 0xbe483f80,0x3f0ebf6d,0xbf553f35,0x3f7bbec4,0xbf463f35,0x3f62bf0e,0xbf753ec4,0x3f7fbe48
.long 0x0,0x0,0x0,0x0,0x3dc90000,0x3e95be48,0x3ef1bec4,0x3f22bf0e
.long 0x3e480000,0x3f0ebec4,0x3f55bf35,0x3f7bbf6d,0x3e950000,0x3f46bf0e,0x3f7fbf6d,0x3f62bf7b
.long 0x3ec40000,0x3f6dbf35,0x3f6dbf80,0x3ec4bf35,0x3ef10000,0x3f7fbf55,0x3f22bf6d,0xbe95be48
.long 0x3f0e0000,0x3f7bbf6d,0x3e48bf35,0xbf553ec4,0x3f220000,0x3f62bf7b,0xbe95bec4,0xbf7f3f55
.long 0x3f350000,0x3f35bf80,0xbf350000,0xbf353f80,0x3f460000,0x3ef1bf7b,0xbf753ec4,0xbdc93f55
.long 0x3f550000,0x3e48bf6d,0xbf7b3f35,0x3f0e3ec4,0x3f620000,0xbdc9bf55,0xbf463f6d,0x3f75be48
.long 0x3f6d0000,0xbec4bf35,0xbec43f80,0x3f6dbf35,0x3f750000,0xbf22bf0e,0x3dc93f6d,0x3ef1bf7b
.long 0x3f7b0000,0xbf55bec4,0x3f0e3f35,0xbe48bf6d,0x3f7f0000,0xbf75be48,0x3f623ec4,0xbf46bf0e
.long 0x0,0x0,0x0,0x0,0x3f46bf35,0x3f62bf55,0x3f75bf6d,0x3f7fbf7b
.long 0x3f7bbf80,0x3f55bf6d,0x3f0ebf35,0x3e48bec4,0x3ef1bf35,0xbdc9be48,0xbf223ec4,0xbf753f55
.long 0xbec40000,0xbf6d3f35,0xbf6d3f80,0xbec43f35,0xbf753f35,0xbf463f7b,0x3dc93ec4,0x3f62bf0e
.long 0xbf553f80,0x3e483ec4,0x3f7bbf35,0x3f0ebf6d,0xbdc93f35,0x3f75bf0e,0x3ef1bf6d,0xbf463e48
.long 0x3f350000,0x3f35bf80,0xbf350000,0xbf353f80,0x3f7fbf35,0xbe95bf0e,0xbf623f6d,0x3f223e48
.long 0x3f0ebf80,0xbf7b3ec4,0x3e483f35,0x3f55bf6d,0xbe95bf35,0xbf223f7b,0x3f7fbec4,0xbef1bf0e
.long 0xbf6d0000,0x3ec43f35,0x3ec4bf80,0xbf6d3f35,0xbf623f35,0x3f7fbe48,0xbf46bec4,0x3e953f55
.long 0xbe483f80,0x3f0ebf6d,0xbf553f35,0x3f7bbec4,0x3f223f35,0xbef1bf55,0x3e953f6d,0xbdc9bf7b
.long 0x0,0x0,0x0,0x0,0x3f7fbf80,0x3f75bf7b,0x3f62bf6d,0x3f46bf55
.long 0xbe480000,0xbf0e3ec4,0xbf553f35,0xbf7b3f6d,0xbf753f80,0xbf223f55,0xbdc93ec4,0x3ef1be48
.long 0x3ec40000,0x3f6dbf35,0x3f6dbf80,0x3ec4bf35,0x3f62bf80,0x3dc9bf0e,0xbf463ec4,0xbf753f7b
.long 0xbf0e0000,0xbf7b3f6d,0xbe483f35,0x3f55bec4,0xbf463f80,0x3ef13e48,0x3f75bf6d,0xbdc9bf0e
.long 0x3f350000,0x3f35bf80,0xbf350000,0xbf353f80,0x3f22bf80,0xbf623e48,0xbe953f6d,0x3f7fbf0e
.long 0xbf550000,0xbe483f6d,0x3f7bbf35,0xbf0ebec4,0xbef13f80,0x3f7fbf0e,0xbf22bec4,0xbe953f7b
.long 0x3f6d0000,0xbec4bf35,0xbec43f80,0x3f6dbf35,0x3e95bf80,0xbf463f55,0x3f7fbec4,0xbf62be48
.long 0xbf7b0000,0x3f553ec4,0xbf0ebf35,0x3e483f6d,0xbdc93f80,0x3e95bf7b,0xbef13f6d,0x3f22bf55
.long 0x0,0x0,0x0,0x0,0x3f22bf35,0x3ef1bf0e,0x3e95bec4,0x3dc9be48
.long 0xbf7b3f80,0xbf553f6d,0xbf0e3f35,0xbe483ec4,0x3f62bf35,0x3f7fbf7b,0x3f46bf6d,0x3e95bf0e
.long 0xbec40000,0xbf6d3f35,0xbf6d3f80,0xbec43f35,0xbe953f35,0x3f22be48,0x3f7fbf6d,0x3ef1bf55
.long 0x3f55bf80,0xbe48bec4,0xbf7b3f35,0xbf0e3f6d,0xbf7f3f35,0xbe953f55,0x3f62bec4,0x3f22bf7b
.long 0x3f350000,0x3f35bf80,0xbf350000,0xbf353f80,0xbdc9bf35,0xbf753f55,0x3ef13ec4,0x3f46bf7b
.long 0xbf0e3f80,0x3f7bbec4,0xbe48bf35,0xbf553f6d,0x3f75bf35,0xbf46be48,0xbdc93f6d,0x3f62bf55
.long 0xbf6d0000,0x3ec43f35,0x3ec4bf80,0xbf6d3f35,0x3ef13f35,0x3dc9bf7b,0xbf223f6d,0x3f75bf0e
.long 0x3e48bf80,0xbf0e3f6d,0x3f55bf35,0xbf7b3ec4,0xbf463f35,0x3f62bf0e,0xbf753ec4,0x3f7fbe48
.long 0x0,0x0,0x0,0x0,0xbdc90000,0xbe953e48,0xbef13ec4,0xbf223f0e
.long 0x3e480000,0x3f0ebec4,0x3f55bf35,0x3f7bbf6d,0xbe950000,0xbf463f0e,0xbf7f3f6d,0xbf623f7b
.long 0x3ec40000,0x3f6dbf35,0x3f6dbf80,0x3ec4bf35,0xbef10000,0xbf7f3f55,0xbf223f6d,0x3e953e48
.long 0x3f0e0000,0x3f7bbf6d,0x3e48bf35,0xbf553ec4,0xbf220000,0xbf623f7b,0x3e953ec4,0x3f7fbf55
.long 0x3f350000,0x3f35bf80,0xbf350000,0xbf353f80,0xbf460000,0xbef13f7b,0x3f75bec4,0x3dc9bf55
.long 0x3f550000,0x3e48bf6d,0xbf7b3f35,0x3f0e3ec4,0xbf620000,0x3dc93f55,0x3f46bf6d,0xbf753e48
.long 0x3f6d0000,0xbec4bf35,0xbec43f80,0x3f6dbf35,0xbf750000,0x3f223f0e,0xbdc9bf6d,0xbef13f7b
.long 0x3f7b0000,0xbf55bec4,0x3f0e3f35,0xbe48bf6d,0xbf7f0000,0x3f753e48,0xbf62bec4,0x3f463f0e
.long 0x0,0x0,0x0,0x0,0xbf463f35,0xbf623f55,0xbf753f6d,0xbf7f3f7b
.long 0x3f7bbf80,0x3f55bf6d,0x3f0ebf35,0x3e48bec4,0xbef13f35,0x3dc93e48,0x3f22bec4,0x3f75bf55
.long 0xbec40000,0xbf6d3f35,0xbf6d3f80,0xbec43f35,0x3f75bf35,0x3f46bf7b,0xbdc9bec4,0xbf623f0e
.long 0xbf553f80,0x3e483ec4,0x3f7bbf35,0x3f0ebf6d,0x3dc9bf35,0xbf753f0e,0xbef13f6d,0x3f46be48
.long 0x3f350000,0x3f35bf80,0xbf350000,0xbf353f80,0xbf7f3f35,0x3e953f0e,0x3f62bf6d,0xbf22be48
.long 0x3f0ebf80,0xbf7b3ec4,0x3e483f35,0x3f55bf6d,0x3e953f35,0x3f22bf7b,0xbf7f3ec4,0x3ef13f0e
.long 0xbf6d0000,0x3ec43f35,0x3ec4bf80,0xbf6d3f35,0x3f62bf35,0xbf7f3e48,0x3f463ec4,0xbe95bf55
.long 0xbe483f80,0x3f0ebf6d,0xbf553f35,0x3f7bbec4,0xbf22bf35,0x3ef13f55,0xbe95bf6d,0x3dc93f7b
.long 0x0,0x0,0x0,0x0,0xbf7f3f80,0xbf753f7b,0xbf623f6d,0xbf463f55
.long 0xbe480000,0xbf0e3ec4,0xbf553f35,0xbf7b3f6d,0x3f75bf80,0x3f22bf55,0x3dc9bec4,0xbef13e48
.long 0x3ec40000,0x3f6dbf35,0x3f6dbf80,0x3ec4bf35,0xbf623f80,0xbdc93f0e,0x3f46bec4,0x3f75bf7b
.long 0xbf0e0000,0xbf7b3f6d,0xbe483f35,0x3f55bec4,0x3f46bf80,0xbef1be48,0xbf753f6d,0x3dc93f0e
.long 0x3f350000,0x3f35bf80,0xbf350000,0xbf353f80,0xbf223f80,0x3f62be48,0x3e95bf6d,0xbf7f3f0e
.long 0xbf550000,0xbe483f6d,0x3f7bbf35,0xbf0ebec4,0x3ef1bf80,0xbf7f3f0e,0x3f223ec4,0x3e95bf7b
.long 0x3f6d0000,0xbec4bf35,0xbec43f80,0x3f6dbf35,0xbe953f80,0x3f46bf55,0xbf7f3ec4,0x3f623e48
.long 0xbf7b0000,0x3f553ec4,0xbf0ebf35,0x3e483f6d,0x3dc9bf80,0xbe953f7b,0x3ef1bf6d,0xbf223f55
.long 0x0,0x0,0x0,0x0,0xbf223f35,0xbef13f0e,0xbe953ec4,0xbdc93e48
.long 0xbf7b3f80,0xbf553f6d,0xbf0e3f35,0xbe483ec4,0xbf623f35,0xbf7f3f7b,0xbf463f6d,0xbe953f0e
.long 0xbec40000,0xbf6d3f35,0xbf6d3f80,0xbec43f35,0x3e95bf35,0xbf223e48,0xbf7f3f6d,0xbef13f55
.long 0x3f55bf80,0xbe48bec4,0xbf7b3f35,0xbf0e3f6d,0x3f7fbf35,0x3e95bf55,0xbf623ec4,0xbf223f7b
.long 0x3f350000,0x3f35bf80,0xbf350000,0xbf353f80,0x3dc93f35,0x3f75bf55,0xbef1bec4,0xbf463f7b
.long 0xbf0e3f80,0x3f7bbec4,0xbe48bf35,0xbf553f6d,0xbf753f35,0x3f463e48,0x3dc9bf6d,0xbf623f55
.long 0xbf6d0000,0x3ec43f35,0x3ec4bf80,0xbf6d3f35,0xbef1bf35,0xbdc93f7b,0x3f22bf6d,0xbf753f0e
.long 0x3e48bf80,0xbf0e3f6d,0x3f55bf35,0xbf7b3ec4,0x3f46bf35,0xbf623f0e,0x3f75bec4,0xbf7f3e48
.long 0x3f80,0xbf80,0x3f80,0xbf80,0x3dc93f80,0xbe95bf7b,0x3ef13f6d,0xbf22bf55
.long 0x3e483f80,0xbf0ebf6d,0x3f553f35,0xbf7bbec4,0x3e953f80,0xbf46bf55,0x3f7f3ec4,0xbf623e48
.long 0x3ec43f80,0xbf6dbf35,0x3f6d0000,0xbec43f35,0x3ef13f80,0xbf7fbf0e,0x3f22bec4,0x3e953f7b
.long 0x3f0e3f80,0xbf7bbec4,0x3e48bf35,0x3f553f6d,0x3f223f80,0xbf62be48,0xbe95bf6d,0x3f7f3f0e
.long 0x3f353f80,0xbf350000,0xbf35bf80,0x3f350000,0x3f463f80,0xbef13e48,0xbf75bf6d,0x3dc9bf0e
.long 0x3f553f80,0xbe483ec4,0xbf7bbf35,0xbf0ebf6d,0x3f623f80,0x3dc93f0e,0xbf46bec4,0xbf75bf7b
.long 0x3f6d3f80,0x3ec43f35,0xbec40000,0xbf6dbf35,0x3f753f80,0x3f223f55,0x3dc93ec4,0xbef1be48
.long 0x3f7b3f80,0x3f553f6d,0x3f0e3f35,0x3e483ec4,0x3f7f3f80,0x3f753f7b,0x3f623f6d,0x3f463f55
.long 0x3f80,0xbf80,0x3f80,0xbf80,0x3f463f35,0xbf62bf0e,0x3f753ec4,0xbf7fbe48
.long 0x3f7b0000,0xbf553ec4,0x3f0ebf35,0xbe483f6d,0x3ef1bf35,0x3dc93f7b,0xbf22bf6d,0x3f753f0e
.long 0xbec4bf80,0x3f6d3f35,0xbf6d0000,0x3ec4bf35,0xbf75bf35,0x3f46be48,0x3dc93f6d,0xbf62bf55
.long 0xbf550000,0xbe48bf6d,0x3f7b3f35,0xbf0e3ec4,0xbdc93f35,0xbf75bf55,0x3ef1bec4,0x3f463f7b
.long 0x3f353f80,0xbf350000,0xbf35bf80,0x3f350000,0x3f7f3f35,0x3e953f55,0xbf62bec4,0xbf22bf7b
.long 0x3f0e0000,0x3f7b3f6d,0x3e483f35,0xbf55bec4,0xbe95bf35,0x3f223e48,0x3f7f3f6d,0x3ef13f55
.long 0xbf6dbf80,0xbec4bf35,0x3ec40000,0x3f6d3f35,0xbf62bf35,0xbf7fbf7b,0xbf46bf6d,0xbe95bf0e
.long 0xbe480000,0xbf0ebec4,0xbf55bf35,0xbf7bbf6d,0x3f223f35,0x3ef13f0e,0x3e953ec4,0x3dc93e48
.long 0x3f80,0xbf80,0x3f80,0xbf80,0x3f7f0000,0xbf753e48,0x3f62bec4,0xbf463f0e
.long 0xbe48bf80,0x3f0e3f6d,0xbf55bf35,0x3f7b3ec4,0xbf750000,0x3f22bf0e,0xbdc93f6d,0xbef1bf7b
.long 0x3ec43f80,0xbf6dbf35,0x3f6d0000,0xbec43f35,0x3f620000,0xbdc93f55,0xbf46bf6d,0x3f753e48
.long 0xbf0ebf80,0x3f7b3ec4,0xbe483f35,0xbf55bf6d,0xbf460000,0xbef1bf7b,0x3f753ec4,0x3dc93f55
.long 0x3f353f80,0xbf350000,0xbf35bf80,0x3f350000,0x3f220000,0x3f623f7b,0xbe953ec4,0xbf7fbf55
.long 0xbf55bf80,0x3e48bec4,0x3f7b3f35,0x3f0e3f6d,0xbef10000,0xbf7fbf55,0xbf22bf6d,0x3e95be48
.long 0x3f6d3f80,0x3ec43f35,0xbec40000,0xbf6dbf35,0x3e950000,0x3f463f0e,0x3f7f3f6d,0x3f623f7b
.long 0xbf7bbf80,0xbf55bf6d,0xbf0ebf35,0xbe48bec4,0xbdc90000,0xbe95be48,0xbef1bec4,0xbf22bf0e
.long 0x3f80,0xbf80,0x3f80,0xbf80,0x3f22bf35,0xbef13f55,0x3e95bf6d,0xbdc93f7b
.long 0xbf7b0000,0x3f55bec4,0xbf0e3f35,0x3e48bf6d,0x3f623f35,0xbf7fbe48,0x3f46bec4,0xbe953f55
.long 0xbec4bf80,0x3f6d3f35,0xbf6d0000,0x3ec4bf35,0xbe953f35,0xbf22bf7b,0x3f7f3ec4,0xbef13f0e
.long 0x3f550000,0x3e483f6d,0xbf7bbf35,0x3f0ebec4,0xbf7fbf35,0x3e95bf0e,0x3f623f6d,0xbf223e48
.long 0x3f353f80,0xbf350000,0xbf35bf80,0x3f350000,0xbdc9bf35,0x3f753f0e,0x3ef13f6d,0xbf46be48
.long 0xbf0e0000,0xbf7bbf6d,0xbe48bf35,0x3f553ec4,0x3f753f35,0x3f463f7b,0xbdc93ec4,0xbf62bf0e
.long 0xbf6dbf80,0xbec4bf35,0x3ec40000,0x3f6d3f35,0x3ef13f35,0xbdc93e48,0xbf22bec4,0xbf75bf55
.long 0x3e480000,0x3f0e3ec4,0x3f553f35,0x3f7b3f6d,0xbf46bf35,0xbf62bf55,0xbf75bf6d,0xbf7fbf7b
.long 0x3f80,0xbf80,0x3f80,0xbf80,0xbdc9bf80,0x3e953f7b,0xbef1bf6d,0x3f223f55
.long 0x3e483f80,0xbf0ebf6d,0x3f553f35,0xbf7bbec4,0xbe95bf80,0x3f463f55,0xbf7fbec4,0x3f62be48
.long 0x3ec43f80,0xbf6dbf35,0x3f6d0000,0xbec43f35,0xbef1bf80,0x3f7f3f0e,0xbf223ec4,0xbe95bf7b
.long 0x3f0e3f80,0xbf7bbec4,0x3e48bf35,0x3f553f6d,0xbf22bf80,0x3f623e48,0x3e953f6d,0xbf7fbf0e
.long 0x3f353f80,0xbf350000,0xbf35bf80,0x3f350000,0xbf46bf80,0x3ef1be48,0x3f753f6d,0xbdc93f0e
.long 0x3f553f80,0xbe483ec4,0xbf7bbf35,0xbf0ebf6d,0xbf62bf80,0xbdc9bf0e,0x3f463ec4,0x3f753f7b
.long 0x3f6d3f80,0x3ec43f35,0xbec40000,0xbf6dbf35,0xbf75bf80,0xbf22bf55,0xbdc9bec4,0x3ef13e48
.long 0x3f7b3f80,0x3f553f6d,0x3f0e3f35,0x3e483ec4,0xbf7fbf80,0xbf75bf7b,0xbf62bf6d,0xbf46bf55
.long 0x3f80,0xbf80,0x3f80,0xbf80,0xbf46bf35,0x3f623f0e,0xbf75bec4,0x3f7f3e48
.long 0x3f7b0000,0xbf553ec4,0x3f0ebf35,0xbe483f6d,0xbef13f35,0xbdc9bf7b,0x3f223f6d,0xbf75bf0e
.long 0xbec4bf80,0x3f6d3f35,0xbf6d0000,0x3ec4bf35,0x3f753f35,0xbf463e48,0xbdc9bf6d,0x3f623f55
.long 0xbf550000,0xbe48bf6d,0x3f7b3f35,0xbf0e3ec4,0x3dc9bf35,0x3f753f55,0xbef13ec4,0xbf46bf7b
.long 0x3f353f80,0xbf350000,0xbf35bf80,0x3f350000,0xbf7fbf35,0xbe95bf55,0x3f623ec4,0x3f223f7b
.long 0x3f0e0000,0x3f7b3f6d,0x3e483f35,0xbf55bec4,0x3e953f35,0xbf22be48,0xbf7fbf6d,0xbef1bf55
.long 0xbf6dbf80,0xbec4bf35,0x3ec40000,0x3f6d3f35,0x3f623f35,0x3f7f3f7b,0x3f463f6d,0x3e953f0e
.long 0xbe480000,0xbf0ebec4,0xbf55bf35,0xbf7bbf6d,0xbf22bf35,0xbef1bf0e,0xbe95bec4,0xbdc9be48
.long 0x3f80,0xbf80,0x3f80,0xbf80,0xbf7f0000,0x3f75be48,0xbf623ec4,0x3f46bf0e
.long 0xbe48bf80,0x3f0e3f6d,0xbf55bf35,0x3f7b3ec4,0x3f750000,0xbf223f0e,0x3dc9bf6d,0x3ef13f7b
.long 0x3ec43f80,0xbf6dbf35,0x3f6d0000,0xbec43f35,0xbf620000,0x3dc9bf55,0x3f463f6d,0xbf75be48
.long 0xbf0ebf80,0x3f7b3ec4,0xbe483f35,0xbf55bf6d,0x3f460000,0x3ef13f7b,0xbf75bec4,0xbdc9bf55
.long 0x3f353f80,0xbf350000,0xbf35bf80,0x3f350000,0xbf220000,0xbf62bf7b,0x3e95bec4,0x3f7f3f55
.long 0xbf55bf80,0x3e48bec4,0x3f7b3f35,0x3f0e3f6d,0x3ef10000,0x3f7f3f55,0x3f223f6d,0xbe953e48
.long 0x3f6d3f80,0x3ec43f35,0xbec40000,0xbf6dbf35,0xbe950000,0xbf46bf0e,0xbf7fbf6d,0xbf62bf7b
.long 0xbf7bbf80,0xbf55bf6d,0xbf0ebf35,0xbe48bec4,0x3dc90000,0x3e953e48,0x3ef13ec4,0x3f223f0e
.long 0x3f80,0xbf80,0x3f80,0xbf80,0xbf223f35,0x3ef1bf55,0xbe953f6d,0x3dc9bf7b
.long 0xbf7b0000,0x3f55bec4,0xbf0e3f35,0x3e48bf6d,0xbf62bf35,0x3f7f3e48,0xbf463ec4,0x3e95bf55
.long 0xbec4bf80,0x3f6d3f35,0xbf6d0000,0x3ec4bf35,0x3e95bf35,0x3f223f7b,0xbf7fbec4,0x3ef1bf0e
.long 0x3f550000,0x3e483f6d,0xbf7bbf35,0x3f0ebec4,0x3f7f3f35,0xbe953f0e,0xbf62bf6d,0x3f22be48
.long 0x3f353f80,0xbf350000,0xbf35bf80,0x3f350000,0x3dc93f35,0xbf75bf0e,0xbef1bf6d,0x3f463e48
.long 0xbf0e0000,0xbf7bbf6d,0xbe48bf35,0x3f553ec4,0xbf75bf35,0xbf46bf7b,0x3dc9bec4,0x3f623f0e
.long 0xbf6dbf80,0xbec4bf35,0x3ec40000,0x3f6d3f35,0xbef1bf35,0x3dc9be48,0x3f223ec4,0x3f753f55
.long 0x3e480000,0x3f0e3ec4,0x3f553f35,0x3f7b3f6d,0x3f463f35,0x3f623f55,0x3f753f6d,0x3f7f3f7b
.long 0xbf800000,0x3f800000,0xbf800000,0x3f800000,0xbf7f0000,0x3f75be48,0xbf623ec4,0x3f46bf0e
.long 0xbf7b0000,0x3f55bec4,0xbf0e3f35,0x3e48bf6d,0xbf750000,0x3f22bf0e,0xbdc93f6d,0xbef1bf7b
.long 0xbf6d0000,0x3ec4bf35,0x3ec43f80,0xbf6dbf35,0xbf620000,0x3dc9bf55,0x3f463f6d,0xbf75be48
.long 0xbf550000,0xbe48bf6d,0x3f7b3f35,0xbf0e3ec4,0xbf460000,0xbef1bf7b,0x3f753ec4,0x3dc93f55
.long 0xbf350000,0xbf35bf80,0x3f350000,0x3f353f80,0xbf220000,0xbf62bf7b,0x3e95bec4,0x3f7f3f55
.long 0xbf0e0000,0xbf7bbf6d,0xbe48bf35,0x3f553ec4,0xbef10000,0xbf7fbf55,0xbf22bf6d,0x3e95be48
.long 0xbec40000,0xbf6dbf35,0xbf6dbf80,0xbec4bf35,0xbe950000,0xbf46bf0e,0xbf7fbf6d,0xbf62bf7b
.long 0xbe480000,0xbf0ebec4,0xbf55bf35,0xbf7bbf6d,0xbdc90000,0xbe95be48,0xbef1bec4,0xbf22bf0e
.long 0xbf800000,0x3f800000,0xbf800000,0x3f800000,0xbf223f35,0x3ef1bf55,0xbe953f6d,0x3dc9bf7b
.long 0x3e483f80,0xbf0ebf6d,0x3f553f35,0xbf7bbec4,0x3f623f35,0xbf7fbe48,0x3f46bec4,0xbe953f55
.long 0x3f6d0000,0xbec43f35,0xbec4bf80,0x3f6d3f35,0x3e95bf35,0x3f223f7b,0xbf7fbec4,0x3ef1bf0e
.long 0xbf0ebf80,0x3f7b3ec4,0xbe483f35,0xbf55bf6d,0xbf7fbf35,0x3e95bf0e,0x3f623f6d,0xbf223e48
.long 0xbf350000,0xbf35bf80,0x3f350000,0x3f353f80,0x3dc93f35,0xbf75bf0e,0xbef1bf6d,0x3f463e48
.long 0x3f553f80,0xbe483ec4,0xbf7bbf35,0xbf0ebf6d,0x3f753f35,0x3f463f7b,0xbdc93ec4,0xbf62bf0e
.long 0x3ec40000,0x3f6d3f35,0x3f6d3f80,0x3ec43f35,0xbef1bf35,0x3dc9be48,0x3f223ec4,0x3f753f55
.long 0xbf7bbf80,0xbf55bf6d,0xbf0ebf35,0xbe48bec4,0xbf46bf35,0xbf62bf55,0xbf75bf6d,0xbf7fbf7b
.long 0xbf800000,0x3f800000,0xbf800000,0x3f800000,0x3dc93f80,0xbe95bf7b,0x3ef13f6d,0xbf22bf55
.long 0x3f7b0000,0xbf553ec4,0x3f0ebf35,0xbe483f6d,0xbe95bf80,0x3f463f55,0xbf7fbec4,0x3f62be48
.long 0xbf6d0000,0x3ec4bf35,0x3ec43f80,0xbf6dbf35,0x3ef13f80,0xbf7fbf0e,0x3f22bec4,0x3e953f7b
.long 0x3f550000,0x3e483f6d,0xbf7bbf35,0x3f0ebec4,0xbf22bf80,0x3f623e48,0x3e953f6d,0xbf7fbf0e
.long 0xbf350000,0xbf35bf80,0x3f350000,0x3f353f80,0x3f463f80,0xbef13e48,0xbf75bf6d,0x3dc9bf0e
.long 0x3f0e0000,0x3f7b3f6d,0x3e483f35,0xbf55bec4,0xbf62bf80,0xbdc9bf0e,0x3f463ec4,0x3f753f7b
.long 0xbec40000,0xbf6dbf35,0xbf6dbf80,0xbec4bf35,0x3f753f80,0x3f223f55,0x3dc93ec4,0xbef1be48
.long 0x3e480000,0x3f0e3ec4,0x3f553f35,0x3f7b3f6d,0xbf7fbf80,0xbf75bf7b,0xbf62bf6d,0xbf46bf55
.long 0xbf800000,0x3f800000,0xbf800000,0x3f800000,0x3f463f35,0xbf62bf0e,0x3f753ec4,0xbf7fbe48
.long 0xbe48bf80,0x3f0e3f6d,0xbf55bf35,0x3f7b3ec4,0xbef13f35,0xbdc9bf7b,0x3f223f6d,0xbf75bf0e
.long 0x3f6d0000,0xbec43f35,0xbec4bf80,0x3f6d3f35,0xbf75bf35,0x3f46be48,0x3dc93f6d,0xbf62bf55
.long 0x3f0e3f80,0xbf7bbec4,0x3e48bf35,0x3f553f6d,0x3dc9bf35,0x3f753f55,0xbef13ec4,0xbf46bf7b
.long 0xbf350000,0xbf35bf80,0x3f350000,0x3f353f80,0x3f7f3f35,0x3e953f55,0xbf62bec4,0xbf22bf7b
.long 0xbf55bf80,0x3e48bec4,0x3f7b3f35,0x3f0e3f6d,0x3e953f35,0xbf22be48,0xbf7fbf6d,0xbef1bf55
.long 0x3ec40000,0x3f6d3f35,0x3f6d3f80,0x3ec43f35,0xbf62bf35,0xbf7fbf7b,0xbf46bf6d,0xbe95bf0e
.long 0x3f7b3f80,0x3f553f6d,0x3f0e3f35,0x3e483ec4,0xbf22bf35,0xbef1bf0e,0xbe95bec4,0xbdc9be48
.long 0xbf800000,0x3f800000,0xbf800000,0x3f800000,0x3f7f0000,0xbf753e48,0x3f62bec4,0xbf463f0e
.long 0xbf7b0000,0x3f55bec4,0xbf0e3f35,0x3e48bf6d,0x3f750000,0xbf223f0e,0x3dc9bf6d,0x3ef13f7b
.long 0xbf6d0000,0x3ec4bf35,0x3ec43f80,0xbf6dbf35,0x3f620000,0xbdc93f55,0xbf46bf6d,0x3f753e48
.long 0xbf550000,0xbe48bf6d,0x3f7b3f35,0xbf0e3ec4,0x3f460000,0x3ef13f7b,0xbf75bec4,0xbdc9bf55
.long 0xbf350000,0xbf35bf80,0x3f350000,0x3f353f80,0x3f220000,0x3f623f7b,0xbe953ec4,0xbf7fbf55
.long 0xbf0e0000,0xbf7bbf6d,0xbe48bf35,0x3f553ec4,0x3ef10000,0x3f7f3f55,0x3f223f6d,0xbe953e48
.long 0xbec40000,0xbf6dbf35,0xbf6dbf80,0xbec4bf35,0x3e950000,0x3f463f0e,0x3f7f3f6d,0x3f623f7b
.long 0xbe480000,0xbf0ebec4,0xbf55bf35,0xbf7bbf6d,0x3dc90000,0x3e953e48,0x3ef13ec4,0x3f223f0e
.long 0xbf800000,0x3f800000,0xbf800000,0x3f800000,0x3f22bf35,0xbef13f55,0x3e95bf6d,0xbdc93f7b
.long 0x3e483f80,0xbf0ebf6d,0x3f553f35,0xbf7bbec4,0xbf62bf35,0x3f7f3e48,0xbf463ec4,0x3e95bf55
.long 0x3f6d0000,0xbec43f35,0xbec4bf80,0x3f6d3f35,0xbe953f35,0xbf22bf7b,0x3f7f3ec4,0xbef13f0e
.long 0xbf0ebf80,0x3f7b3ec4,0xbe483f35,0xbf55bf6d,0x3f7f3f35,0xbe953f0e,0xbf62bf6d,0x3f22be48
.long 0xbf350000,0xbf35bf80,0x3f350000,0x3f353f80,0xbdc9bf35,0x3f753f0e,0x3ef13f6d,0xbf46be48
.long 0x3f553f80,0xbe483ec4,0xbf7bbf35,0xbf0ebf6d,0xbf75bf35,0xbf46bf7b,0x3dc9bec4,0x3f623f0e
.long 0x3ec40000,0x3f6d3f35,0x3f6d3f80,0x3ec43f35,0x3ef13f35,0xbdc93e48,0xbf22bec4,0xbf75bf55
.long 0xbf7bbf80,0xbf55bf6d,0xbf0ebf35,0xbe48bec4,0x3f463f35,0x3f623f55,0x3f753f6d,0x3f7f3f7b
.long 0xbf800000,0x3f800000,0xbf800000,0x3f800000,0xbdc9bf80,0x3e953f7b,0xbef1bf6d,0x3f223f55
.long 0x3f7b0000,0xbf553ec4,0x3f0ebf35,0xbe483f6d,0x3e953f80,0xbf46bf55,0x3f7f3ec4,0xbf623e48
.long 0xbf6d0000,0x3ec4bf35,0x3ec43f80,0xbf6dbf35,0xbef1bf80,0x3f7f3f0e,0xbf223ec4,0xbe95bf7b
.long 0x3f550000,0x3e483f6d,0xbf7bbf35,0x3f0ebec4,0x3f223f80,0xbf62be48,0xbe95bf6d,0x3f7f3f0e
.long 0xbf350000,0xbf35bf80,0x3f350000,0x3f353f80,0xbf46bf80,0x3ef1be48,0x3f753f6d,0xbdc93f0e
.long 0x3f0e0000,0x3f7b3f6d,0x3e483f35,0xbf55bec4,0x3f623f80,0x3dc93f0e,0xbf46bec4,0xbf75bf7b
.long 0xbec40000,0xbf6dbf35,0xbf6dbf80,0xbec4bf35,0xbf75bf80,0xbf22bf55,0xbdc9bec4,0x3ef13e48
.long 0x3e480000,0x3f0e3ec4,0x3f553f35,0x3f7b3f6d,0x3f7f3f80,0x3f753f7b,0x3f623f6d,0x3f463f55
.long 0xbf800000,0x3f800000,0xbf800000,0x3f800000,0xbf46bf35,0x3f623f0e,0xbf75bec4,0x3f7f3e48
.long 0xbe48bf80,0x3f0e3f6d,0xbf55bf35,0x3f7b3ec4,0x3ef1bf35,0x3dc93f7b,0xbf22bf6d,0x3f753f0e
.long 0x3f6d0000,0xbec43f35,0xbec4bf80,0x3f6d3f35,0x3f753f35,0xbf463e48,0xbdc9bf6d,0x3f623f55
.long 0x3f0e3f80,0xbf7bbec4,0x3e48bf35,0x3f553f6d,0xbdc93f35,0xbf75bf55,0x3ef1bec4,0x3f463f7b
.long 0xbf350000,0xbf35bf80,0x3f350000,0x3f353f80,0xbf7fbf35,0xbe95bf55,0x3f623ec4,0x3f223f7b
.long 0xbf55bf80,0x3e48bec4,0x3f7b3f35,0x3f0e3f6d,0xbe95bf35,0x3f223e48,0x3f7f3f6d,0x3ef13f55
.long 0x3ec40000,0x3f6d3f35,0x3f6d3f80,0x3ec43f35,0x3f623f35,0x3f7f3f7b,0x3f463f6d,0x3e953f0e
.long 0x3f7b3f80,0x3f553f6d,0x3f0e3f35,0x3e483ec4,0x3f223f35,0x3ef13f0e,0x3e953ec4,0x3dc93e48
.long 0x3f800000,0xbf800000,0x3f800000,0xbf800000,0x3f7f0000,0xbf753e48,0x3f62bec4,0xbf463f0e
.long 0x3f7b0000,0xbf553ec4,0x3f0ebf35,0xbe483f6d,0x3f750000,0xbf223f0e,0x3dc9bf6d,0x3ef13f7b
.long 0x3f6d0000,0xbec43f35,0xbec4bf80,0x3f6d3f35,0x3f620000,0xbdc93f55,0xbf46bf6d,0x3f753e48
.long 0x3f550000,0x3e483f6d,0xbf7bbf35,0x3f0ebec4,0x3f460000,0x3ef13f7b,0xbf75bec4,0xbdc9bf55
.long 0x3f350000,0x3f353f80,0xbf350000,0xbf35bf80,0x3f220000,0x3f623f7b,0xbe953ec4,0xbf7fbf55
.long 0x3f0e0000,0x3f7b3f6d,0x3e483f35,0xbf55bec4,0x3ef10000,0x3f7f3f55,0x3f223f6d,0xbe953e48
.long 0x3ec40000,0x3f6d3f35,0x3f6d3f80,0x3ec43f35,0x3e950000,0x3f463f0e,0x3f7f3f6d,0x3f623f7b
.long 0x3e480000,0x3f0e3ec4,0x3f553f35,0x3f7b3f6d,0x3dc90000,0x3e953e48,0x3ef13ec4,0x3f223f0e
.long 0x3f800000,0xbf800000,0x3f800000,0xbf800000,0x3f22bf35,0xbef13f55,0x3e95bf6d,0xbdc93f7b
.long 0xbe48bf80,0x3f0e3f6d,0xbf55bf35,0x3f7b3ec4,0xbf62bf35,0x3f7f3e48,0xbf463ec4,0x3e95bf55
.long 0xbf6d0000,0x3ec4bf35,0x3ec43f80,0xbf6dbf35,0xbe953f35,0xbf22bf7b,0x3f7f3ec4,0xbef13f0e
.long 0x3f0e3f80,0xbf7bbec4,0x3e48bf35,0x3f553f6d,0x3f7f3f35,0xbe953f0e,0xbf62bf6d,0x3f22be48
.long 0x3f350000,0x3f353f80,0xbf350000,0xbf35bf80,0xbdc9bf35,0x3f753f0e,0x3ef13f6d,0xbf46be48
.long 0xbf55bf80,0x3e48bec4,0x3f7b3f35,0x3f0e3f6d,0xbf75bf35,0xbf46bf7b,0x3dc9bec4,0x3f623f0e
.long 0xbec40000,0xbf6dbf35,0xbf6dbf80,0xbec4bf35,0x3ef13f35,0xbdc93e48,0xbf22bec4,0xbf75bf55
.long 0x3f7b3f80,0x3f553f6d,0x3f0e3f35,0x3e483ec4,0x3f463f35,0x3f623f55,0x3f753f6d,0x3f7f3f7b
.long 0x3f800000,0xbf800000,0x3f800000,0xbf800000,0xbdc9bf80,0x3e953f7b,0xbef1bf6d,0x3f223f55
.long 0xbf7b0000,0x3f55bec4,0xbf0e3f35,0x3e48bf6d,0x3e953f80,0xbf46bf55,0x3f7f3ec4,0xbf623e48
.long 0x3f6d0000,0xbec43f35,0xbec4bf80,0x3f6d3f35,0xbef1bf80,0x3f7f3f0e,0xbf223ec4,0xbe95bf7b
.long 0xbf550000,0xbe48bf6d,0x3f7b3f35,0xbf0e3ec4,0x3f223f80,0xbf62be48,0xbe95bf6d,0x3f7f3f0e
.long 0x3f350000,0x3f353f80,0xbf350000,0xbf35bf80,0xbf46bf80,0x3ef1be48,0x3f753f6d,0xbdc93f0e
.long 0xbf0e0000,0xbf7bbf6d,0xbe48bf35,0x3f553ec4,0x3f623f80,0x3dc93f0e,0xbf46bec4,0xbf75bf7b
.long 0x3ec40000,0x3f6d3f35,0x3f6d3f80,0x3ec43f35,0xbf75bf80,0xbf22bf55,0xbdc9bec4,0x3ef13e48
.long 0xbe480000,0xbf0ebec4,0xbf55bf35,0xbf7bbf6d,0x3f7f3f80,0x3f753f7b,0x3f623f6d,0x3f463f55
.long 0x3f800000,0xbf800000,0x3f800000,0xbf800000,0xbf46bf35,0x3f623f0e,0xbf75bec4,0x3f7f3e48
.long 0x3e483f80,0xbf0ebf6d,0x3f553f35,0xbf7bbec4,0x3ef1bf35,0x3dc93f7b,0xbf22bf6d,0x3f753f0e
.long 0xbf6d0000,0x3ec4bf35,0x3ec43f80,0xbf6dbf35,0x3f753f35,0xbf463e48,0xbdc9bf6d,0x3f623f55
.long 0xbf0ebf80,0x3f7b3ec4,0xbe483f35,0xbf55bf6d,0xbdc93f35,0xbf75bf55,0x3ef1bec4,0x3f463f7b
.long 0x3f350000,0x3f353f80,0xbf350000,0xbf35bf80,0xbf7fbf35,0xbe95bf55,0x3f623ec4,0x3f223f7b
.long 0x3f553f80,0xbe483ec4,0xbf7bbf35,0xbf0ebf6d,0xbe95bf35,0x3f223e48,0x3f7f3f6d,0x3ef13f55
.long 0xbec40000,0xbf6dbf35,0xbf6dbf80,0xbec4bf35,0x3f623f35,0x3f7f3f7b,0x3f463f6d,0x3e953f0e
.long 0xbf7bbf80,0xbf55bf6d,0xbf0ebf35,0xbe48bec4,0x3f223f35,0x3ef13f0e,0x3e953ec4,0x3dc93e48
.long 0x3f800000,0xbf800000,0x3f800000,0xbf800000,0xbf7f0000,0x3f75be48,0xbf623ec4,0x3f46bf0e
.long 0x3f7b0000,0xbf553ec4,0x3f0ebf35,0xbe483f6d,0xbf750000,0x3f22bf0e,0xbdc93f6d,0xbef1bf7b
.long 0x3f6d0000,0xbec43f35,0xbec4bf80,0x3f6d3f35,0xbf620000,0x3dc9bf55,0x3f463f6d,0xbf75be48
.long 0x3f550000,0x3e483f6d,0xbf7bbf35,0x3f0ebec4,0xbf460000,0xbef1bf7b,0x3f753ec4,0x3dc93f55
.long 0x3f350000,0x3f353f80,0xbf350000,0xbf35bf80,0xbf220000,0xbf62bf7b,0x3e95bec4,0x3f7f3f55
.long 0x3f0e0000,0x3f7b3f6d,0x3e483f35,0xbf55bec4,0xbef10000,0xbf7fbf55,0xbf22bf6d,0x3e95be48
.long 0x3ec40000,0x3f6d3f35,0x3f6d3f80,0x3ec43f35,0xbe950000,0xbf46bf0e,0xbf7fbf6d,0xbf62bf7b
.long 0x3e480000,0x3f0e3ec4,0x3f553f35,0x3f7b3f6d,0xbdc90000,0xbe95be48,0xbef1bec4,0xbf22bf0e
.long 0x3f800000,0xbf800000,0x3f800000,0xbf800000,0xbf223f35,0x3ef1bf55,0xbe953f6d,0x3dc9bf7b
.long 0xbe48bf80,0x3f0e3f6d,0xbf55bf35,0x3f7b3ec4,0x3f623f35,0xbf7fbe48,0x3f46bec4,0xbe953f55
.long 0xbf6d0000,0x3ec4bf35,0x3ec43f80,0xbf6dbf35,0x3e95bf35,0x3f223f7b,0xbf7fbec4,0x3ef1bf0e
.long 0x3f0e3f80,0xbf7bbec4,0x3e48bf35,0x3f553f6d,0xbf7fbf35,0x3e95bf0e,0x3f623f6d,0xbf223e48
.long 0x3f350000,0x3f353f80,0xbf350000,0xbf35bf80,0x3dc93f35,0xbf75bf0e,0xbef1bf6d,0x3f463e48
.long 0xbf55bf80,0x3e48bec4,0x3f7b3f35,0x3f0e3f6d,0x3f753f35,0x3f463f7b,0xbdc93ec4,0xbf62bf0e
.long 0xbec40000,0xbf6dbf35,0xbf6dbf80,0xbec4bf35,0xbef1bf35,0x3dc9be48,0x3f223ec4,0x3f753f55
.long 0x3f7b3f80,0x3f553f6d,0x3f0e3f35,0x3e483ec4,0xbf46bf35,0xbf62bf55,0xbf75bf6d,0xbf7fbf7b
.long 0x3f800000,0xbf800000,0x3f800000,0xbf800000,0x3dc93f80,0xbe95bf7b,0x3ef13f6d,0xbf22bf55
.long 0xbf7b0000,0x3f55bec4,0xbf0e3f35,0x3e48bf6d,0xbe95bf80,0x3f463f55,0xbf7fbec4,0x3f62be48
.long 0x3f6d0000,0xbec43f35,0xbec4bf80,0x3f6d3f35,0x3ef13f80,0xbf7fbf0e,0x3f22bec4,0x3e953f7b
.long 0xbf550000,0xbe48bf6d,0x3f7b3f35,0xbf0e3ec4,0xbf22bf80,0x3f623e48,0x3e953f6d,0xbf7fbf0e
.long 0x3f350000,0x3f353f80,0xbf350000,0xbf35bf80,0x3f463f80,0xbef13e48,0xbf75bf6d,0x3dc9bf0e
.long 0xbf0e0000,0xbf7bbf6d,0xbe48bf35,0x3f553ec4,0xbf62bf80,0xbdc9bf0e,0x3f463ec4,0x3f753f7b
.long 0x3ec40000,0x3f6d3f35,0x3f6d3f80,0x3ec43f35,0x3f753f80,0x3f223f55,0x3dc93ec4,0xbef1be48
.long 0xbe480000,0xbf0ebec4,0xbf55bf35,0xbf7bbf6d,0xbf7fbf80,0xbf75bf7b,0xbf62bf6d,0xbf46bf55
.long 0x3f800000,0xbf800000,0x3f800000,0xbf800000,0x3f463f35,0xbf62bf0e,0x3f753ec4,0xbf7fbe48
.long 0x3e483f80,0xbf0ebf6d,0x3f553f35,0xbf7bbec4,0xbef13f35,0xbdc9bf7b,0x3f223f6d,0xbf75bf0e
.long 0xbf6d0000,0x3ec4bf35,0x3ec43f80,0xbf6dbf35,0xbf75bf35,0x3f46be48,0x3dc93f6d,0xbf62bf55
.long 0xbf0ebf80,0x3f7b3ec4,0xbe483f35,0xbf55bf6d,0x3dc9bf35,0x3f753f55,0xbef13ec4,0xbf46bf7b
.long 0x3f350000,0x3f353f80,0xbf350000,0xbf35bf80,0x3f7f3f35,0x3e953f55,0xbf62bec4,0xbf22bf7b
.long 0x3f553f80,0xbe483ec4,0xbf7bbf35,0xbf0ebf6d,0x3e953f35,0xbf22be48,0xbf7fbf6d,0xbef1bf55
.long 0xbec40000,0xbf6dbf35,0xbf6dbf80,0xbec4bf35,0xbf62bf35,0xbf7fbf7b,0xbf46bf6d,0xbe95bf0e
.long 0xbf7bbf80,0xbf55bf6d,0xbf0ebf35,0xbe48bec4,0xbf22bf35,0xbef1bf0e,0xbe95bec4,0xbdc9be48
.p2align 8
tab_A32:
.long 0x3f803f80,0x3f803f80,0x3f803f80,0x3f803f80,0x3f7b3f80,0x3f553f6d,0xbf7bbf80,0xbf55bf6d
.long 0x3f6d3f80,0x3ec43f35,0x3f6d3f80,0x3ec43f35,0x3f553f80,0xbe483ec4,0xbf55bf80,0x3e48bec4
.long 0x3f353f80,0xbf350000,0x3f353f80,0xbf350000,0x3f0e3f80,0xbf7bbec4,0xbf0ebf80,0x3f7b3ec4
.long 0x3ec43f80,0xbf6dbf35,0x3ec43f80,0xbf6dbf35,0x3e483f80,0xbf0ebf6d,0xbe48bf80,0x3f0e3f6d
.long 0x3f80,0xbf80,0x3f80,0xbf80,0xbe483f80,0x3f0ebf6d,0x3e48bf80,0xbf0e3f6d
.long 0xbec43f80,0x3f6dbf35,0xbec43f80,0x3f6dbf35,0xbf0e3f80,0x3f7bbec4,0x3f0ebf80,0xbf7b3ec4
.long 0xbf353f80,0x3f350000,0xbf353f80,0x3f350000,0xbf553f80,0x3e483ec4,0x3f55bf80,0xbe48bec4
.long 0xbf6d3f80,0xbec43f35,0xbf6d3f80,0xbec43f35,0xbf7b3f80,0xbf553f6d,0x3f7bbf80,0x3f55bf6d
.long 0x3f803f80,0x3f803f80,0x3f803f80,0x3f803f80,0x3f0e3f35,0x3e483ec4,0xbf0ebf35,0xbe48bec4
.long 0xbec40000,0xbf6dbf35,0xbec40000,0xbf6dbf35,0xbf7bbf35,0xbf0ebf6d,0x3f7b3f35,0x3f0e3f6d
.long 0xbf35bf80,0x3f350000,0xbf35bf80,0x3f350000,0x3e48bf35,0x3f553f6d,0xbe483f35,0xbf55bf6d
.long 0x3f6d0000,0xbec43f35,0x3f6d0000,0xbec43f35,0x3f553f35,0xbf7bbec4,0xbf55bf35,0x3f7b3ec4
.long 0x3f80,0xbf80,0x3f80,0xbf80,0xbf553f35,0x3f7bbec4,0x3f55bf35,0xbf7b3ec4
.long 0xbf6d0000,0x3ec43f35,0xbf6d0000,0x3ec43f35,0xbe48bf35,0xbf553f6d,0x3e483f35,0x3f55bf6d
.long 0x3f35bf80,0xbf350000,0x3f35bf80,0xbf350000,0x3f7bbf35,0x3f0ebf6d,0xbf7b3f35,0xbf0e3f6d
.long 0x3ec40000,0x3f6dbf35,0x3ec40000,0x3f6dbf35,0xbf0e3f35,0xbe483ec4,0x3f0ebf35,0x3e48bec4
.long 0x3f803f80,0x3f803f80,0x3f803f80,0x3f803f80,0xbe480000,0xbf0ebec4,0x3e480000,0x3f0e3ec4
.long 0xbf6dbf80,0xbec4bf35,0xbf6dbf80,0xbec4bf35,0x3f0e0000,0x3f7b3f6d,0xbf0e0000,0xbf7bbf6d
.long 0x3f353f80,0xbf350000,0x3f353f80,0xbf350000,0xbf550000,0xbe48bf6d,0x3f550000,0x3e483f6d
.long 0xbec4bf80,0x3f6d3f35,0xbec4bf80,0x3f6d3f35,0x3f7b0000,0xbf553ec4,0xbf7b0000,0x3f55bec4
.long 0x3f80,0xbf80,0x3f80,0xbf80,0xbf7b0000,0x3f553ec4,0x3f7b0000,0xbf55bec4
.long 0x3ec4bf80,0xbf6d3f35,0x3ec4bf80,0xbf6d3f35,0x3f550000,0x3e48bf6d,0xbf550000,0xbe483f6d
.long 0xbf353f80,0x3f350000,0xbf353f80,0x3f350000,0xbf0e0000,0xbf7b3f6d,0x3f0e0000,0x3f7bbf6d
.long 0x3f6dbf80,0x3ec4bf35,0x3f6dbf80,0x3ec4bf35,0x3e480000,0x3f0ebec4,0xbe480000,0xbf0e3ec4
.long 0x3f803f80,0x3f803f80,0x3f803f80,0x3f803f80,0xbf55bf35,0xbf7bbf6d,0x3f553f35,0x3f7b3f6d
.long 0x3ec40000,0x3f6d3f35,0x3ec40000,0x3f6d3f35,0x3e483f35,0xbf55bec4,0xbe48bf35,0x3f553ec4
.long 0xbf35bf80,0x3f350000,0xbf35bf80,0x3f350000,0x3f7b3f35,0xbf0e3ec4,0xbf7bbf35,0x3f0ebec4
.long 0xbf6d0000,0x3ec4bf35,0xbf6d0000,0x3ec4bf35,0x3f0ebf35,0xbe483f6d,0xbf0e3f35,0x3e48bf6d
.long 0x3f80,0xbf80,0x3f80,0xbf80,0xbf0ebf35,0x3e483f6d,0x3f0e3f35,0xbe48bf6d
.long 0x3f6d0000,0xbec4bf35,0x3f6d0000,0xbec4bf35,0xbf7b3f35,0x3f0e3ec4,0x3f7bbf35,0xbf0ebec4
.long 0x3f35bf80,0xbf350000,0x3f35bf80,0xbf350000,0xbe483f35,0x3f55bec4,0x3e48bf35,0xbf553ec4
.long 0xbec40000,0xbf6d3f35,0xbec40000,0xbf6d3f35,0x3f55bf35,0x3f7bbf6d,0xbf553f35,0xbf7b3f6d
.long 0xbf803f80,0xbf803f80,0xbf803f80,0xbf803f80,0xbf7b3f80,0xbf553f6d,0x3f7bbf80,0x3f55bf6d
.long 0xbf6d3f80,0xbec43f35,0xbf6d3f80,0xbec43f35,0xbf553f80,0x3e483ec4,0x3f55bf80,0xbe48bec4
.long 0xbf353f80,0x3f350000,0xbf353f80,0x3f350000,0xbf0e3f80,0x3f7bbec4,0x3f0ebf80,0xbf7b3ec4
.long 0xbec43f80,0x3f6dbf35,0xbec43f80,0x3f6dbf35,0xbe483f80,0x3f0ebf6d,0x3e48bf80,0xbf0e3f6d
.long 0x3f80,0xbf80,0x3f80,0xbf80,0x3e483f80,0xbf0ebf6d,0xbe48bf80,0x3f0e3f6d
.long 0x3ec43f80,0xbf6dbf35,0x3ec43f80,0xbf6dbf35,0x3f0e3f80,0xbf7bbec4,0xbf0ebf80,0x3f7b3ec4
.long 0x3f353f80,0xbf350000,0x3f353f80,0xbf350000,0x3f553f80,0xbe483ec4,0xbf55bf80,0x3e48bec4
.long 0x3f6d3f80,0x3ec43f35,0x3f6d3f80,0x3ec43f35,0x3f7b3f80,0x3f553f6d,0xbf7bbf80,0xbf55bf6d
.long 0xbf803f80,0xbf803f80,0xbf803f80,0xbf803f80,0xbf0e3f35,0xbe483ec4,0x3f0ebf35,0x3e48bec4
.long 0x3ec40000,0x3f6dbf35,0x3ec40000,0x3f6dbf35,0x3f7bbf35,0x3f0ebf6d,0xbf7b3f35,0xbf0e3f6d
.long 0x3f35bf80,0xbf350000,0x3f35bf80,0xbf350000,0xbe48bf35,0xbf553f6d,0x3e483f35,0x3f55bf6d
.long 0xbf6d0000,0x3ec43f35,0xbf6d0000,0x3ec43f35,0xbf553f35,0x3f7bbec4,0x3f55bf35,0xbf7b3ec4
.long 0x3f80,0xbf80,0x3f80,0xbf80,0x3f553f35,0xbf7bbec4,0xbf55bf35,0x3f7b3ec4
.long 0x3f6d0000,0xbec43f35,0x3f6d0000,0xbec43f35,0x3e48bf35,0x3f553f6d,0xbe483f35,0xbf55bf6d
.long 0xbf35bf80,0x3f350000,0xbf35bf80,0x3f350000,0xbf7bbf35,0xbf0ebf6d,0x3f7b3f35,0x3f0e3f6d
.long 0xbec40000,0xbf6dbf35,0xbec40000,0xbf6dbf35,0x3f0e3f35,0x3e483ec4,0xbf0ebf35,0xbe48bec4
.long 0xbf803f80,0xbf803f80,0xbf803f80,0xbf803f80,0x3e480000,0x3f0ebec4,0xbe480000,0xbf0e3ec4
.long 0x3f6dbf80,0x3ec4bf35,0x3f6dbf80,0x3ec4bf35,0xbf0e0000,0xbf7b3f6d,0x3f0e0000,0x3f7bbf6d
.long 0xbf353f80,0x3f350000,0xbf353f80,0x3f350000,0x3f550000,0x3e48bf6d,0xbf550000,0xbe483f6d
.long 0x3ec4bf80,0xbf6d3f35,0x3ec4bf80,0xbf6d3f35,0xbf7b0000,0x3f553ec4,0x3f7b0000,0xbf55bec4
.long 0x3f80,0xbf80,0x3f80,0xbf80,0x3f7b0000,0xbf553ec4,0xbf7b0000,0x3f55bec4
.long 0xbec4bf80,0x3f6d3f35,0xbec4bf80,0x3f6d3f35,0xbf550000,0xbe48bf6d,0x3f550000,0x3e483f6d
.long 0x3f353f80,0xbf350000,0x3f353f80,0xbf350000,0x3f0e0000,0x3f7b3f6d,0xbf0e0000,0xbf7bbf6d
.long 0xbf6dbf80,0xbec4bf35,0xbf6dbf80,0xbec4bf35,0xbe480000,0xbf0ebec4,0x3e480000,0x3f0e3ec4
.long 0xbf803f80,0xbf803f80,0xbf803f80,0xbf803f80,0x3f55bf35,0x3f7bbf6d,0xbf553f35,0xbf7b3f6d
.long 0xbec40000,0xbf6d3f35,0xbec40000,0xbf6d3f35,0xbe483f35,0x3f55bec4,0x3e48bf35,0xbf553ec4
.long 0x3f35bf80,0xbf350000,0x3f35bf80,0xbf350000,0xbf7b3f35,0x3f0e3ec4,0x3f7bbf35,0xbf0ebec4
.long 0x3f6d0000,0xbec4bf35,0x3f6d0000,0xbec4bf35,0xbf0ebf35,0x3e483f6d,0x3f0e3f35,0xbe48bf6d
.long 0x3f80,0xbf80,0x3f80,0xbf80,0x3f0ebf35,0xbe483f6d,0xbf0e3f35,0x3e48bf6d
.long 0xbf6d0000,0x3ec4bf35,0xbf6d0000,0x3ec4bf35,0x3f7b3f35,0xbf0e3ec4,0xbf7bbf35,0x3f0ebec4
.long 0xbf35bf80,0x3f350000,0xbf35bf80,0x3f350000,0x3e483f35,0xbf55bec4,0xbe48bf35,0x3f553ec4
.long 0x3ec40000,0x3f6d3f35,0x3ec40000,0x3f6d3f35,0xbf55bf35,0xbf7bbf6d,0x3f553f35,0x3f7b3f6d
.long 0x0,0x0,0x0,0x0,0x3e480000,0x3f0e3ec4,0xbe480000,0xbf0ebec4
.long 0x3ec40000,0x3f6d3f35,0x3ec40000,0x3f6d3f35,0x3f0e0000,0x3f7b3f6d,0xbf0e0000,0xbf7bbf6d
.long 0x3f350000,0x3f353f80,0x3f350000,0x3f353f80,0x3f550000,0x3e483f6d,0xbf550000,0xbe48bf6d
.long 0x3f6d0000,0xbec43f35,0x3f6d0000,0xbec43f35,0x3f7b0000,0xbf553ec4,0xbf7b0000,0x3f55bec4
.long 0x3f800000,0xbf800000,0x3f800000,0xbf800000,0x3f7b0000,0xbf55bec4,0xbf7b0000,0x3f553ec4
.long 0x3f6d0000,0xbec4bf35,0x3f6d0000,0xbec4bf35,0x3f550000,0x3e48bf6d,0xbf550000,0xbe483f6d
.long 0x3f350000,0x3f35bf80,0x3f350000,0x3f35bf80,0x3f0e0000,0x3f7bbf6d,0xbf0e0000,0xbf7b3f6d
.long 0x3ec40000,0x3f6dbf35,0x3ec40000,0x3f6dbf35,0x3e480000,0x3f0ebec4,0xbe480000,0xbf0e3ec4
.long 0x0,0x0,0x0,0x0,0x3f553f35,0x3f7b3f6d,0xbf55bf35,0xbf7bbf6d
.long 0x3f6d3f80,0x3ec43f35,0x3f6d3f80,0x3ec43f35,0x3e483f35,0xbf55bec4,0xbe48bf35,0x3f553ec4
.long 0xbf350000,0xbf35bf80,0xbf350000,0xbf35bf80,0xbf7bbf35,0x3f0ebec4,0x3f7b3f35,0xbf0e3ec4
.long 0xbec4bf80,0x3f6d3f35,0xbec4bf80,0x3f6d3f35,0x3f0ebf35,0xbe483f6d,0xbf0e3f35,0x3e48bf6d
.long 0x3f800000,0xbf800000,0x3f800000,0xbf800000,0x3f0e3f35,0xbe48bf6d,0xbf0ebf35,0x3e483f6d
.long 0xbec43f80,0x3f6dbf35,0xbec43f80,0x3f6dbf35,0xbf7b3f35,0x3f0e3ec4,0x3f7bbf35,0xbf0ebec4
.long 0xbf350000,0xbf353f80,0xbf350000,0xbf353f80,0x3e48bf35,0xbf553ec4,0xbe483f35,0x3f55bec4
.long 0x3f6dbf80,0x3ec4bf35,0x3f6dbf80,0x3ec4bf35,0x3f55bf35,0x3f7bbf6d,0xbf553f35,0xbf7b3f6d
.long 0x0,0x0,0x0,0x0,0x3f7b3f80,0x3f553f6d,0xbf7bbf80,0xbf55bf6d
.long 0xbec40000,0xbf6dbf35,0xbec40000,0xbf6dbf35,0xbf55bf80,0x3e48bec4,0x3f553f80,0xbe483ec4
.long 0x3f350000,0x3f353f80,0x3f350000,0x3f353f80,0x3f0e3f80,0xbf7bbec4,0xbf0ebf80,0x3f7b3ec4
.long 0xbf6d0000,0x3ec4bf35,0xbf6d0000,0x3ec4bf35,0xbe48bf80,0x3f0e3f6d,0x3e483f80,0xbf0ebf6d
.long 0x3f800000,0xbf800000,0x3f800000,0xbf800000,0xbe483f80,0x3f0ebf6d,0x3e48bf80,0xbf0e3f6d
.long 0xbf6d0000,0x3ec43f35,0xbf6d0000,0x3ec43f35,0x3f0ebf80,0xbf7b3ec4,0xbf0e3f80,0x3f7bbec4
.long 0x3f350000,0x3f35bf80,0x3f350000,0x3f35bf80,0xbf553f80,0x3e483ec4,0x3f55bf80,0xbe48bec4
.long 0xbec40000,0xbf6d3f35,0xbec40000,0xbf6d3f35,0x3f7bbf80,0x3f55bf6d,0xbf7b3f80,0xbf553f6d
.long 0x0,0x0,0x0,0x0,0x3f0e3f35,0x3e483ec4,0xbf0ebf35,0xbe48bec4
.long 0xbf6dbf80,0xbec4bf35,0xbf6dbf80,0xbec4bf35,0x3f7b3f35,0x3f0e3f6d,0xbf7bbf35,0xbf0ebf6d
.long 0xbf350000,0xbf35bf80,0xbf350000,0xbf35bf80,0x3e48bf35,0x3f553f6d,0xbe483f35,0xbf55bf6d
.long 0x3ec43f80,0xbf6dbf35,0x3ec43f80,0xbf6dbf35,0xbf55bf35,0x3f7b3ec4,0x3f553f35,0xbf7bbec4
.long 0x3f800000,0xbf800000,0x3f800000,0xbf800000,0xbf553f35,0x3f7bbec4,0x3f55bf35,0xbf7b3ec4
.long 0x3ec4bf80,0xbf6d3f35,0x3ec4bf80,0xbf6d3f35,0x3e483f35,0x3f55bf6d,0xbe48bf35,0xbf553f6d
.long 0xbf350000,0xbf353f80,0xbf350000,0xbf353f80,0x3f7bbf35,0x3f0ebf6d,0xbf7b3f35,0xbf0e3f6d
.long 0xbf6d3f80,0xbec43f35,0xbf6d3f80,0xbec43f35,0x3f0ebf35,0x3e48bec4,0xbf0e3f35,0xbe483ec4
.long 0x0,0x0,0x0,0x0,0xbe480000,0xbf0e3ec4,0x3e480000,0x3f0ebec4
.long 0xbec40000,0xbf6d3f35,0xbec40000,0xbf6d3f35,0xbf0e0000,0xbf7b3f6d,0x3f0e0000,0x3f7bbf6d
.long 0xbf350000,0xbf353f80,0xbf350000,0xbf353f80,0xbf550000,0xbe483f6d,0x3f550000,0x3e48bf6d
.long 0xbf6d0000,0x3ec43f35,0xbf6d0000,0x3ec43f35,0xbf7b0000,0x3f553ec4,0x3f7b0000,0xbf55bec4
.long 0xbf800000,0x3f800000,0xbf800000,0x3f800000,0xbf7b0000,0x3f55bec4,0x3f7b0000,0xbf553ec4
.long 0xbf6d0000,0x3ec4bf35,0xbf6d0000,0x3ec4bf35,0xbf550000,0xbe48bf6d,0x3f550000,0x3e483f6d
.long 0xbf350000,0xbf35bf80,0xbf350000,0xbf35bf80,0xbf0e0000,0xbf7bbf6d,0x3f0e0000,0x3f7b3f6d
.long 0xbec40000,0xbf6dbf35,0xbec40000,0xbf6dbf35,0xbe480000,0xbf0ebec4,0x3e480000,0x3f0e3ec4
.long 0x0,0x0,0x0,0x0,0xbf553f35,0xbf7b3f6d,0x3f55bf35,0x3f7bbf6d
.long 0xbf6d3f80,0xbec43f35,0xbf6d3f80,0xbec43f35,0xbe483f35,0x3f55bec4,0x3e48bf35,0xbf553ec4
.long 0x3f350000,0x3f35bf80,0x3f350000,0x3f35bf80,0x3f7bbf35,0xbf0ebec4,0xbf7b3f35,0x3f0e3ec4
.long 0x3ec4bf80,0xbf6d3f35,0x3ec4bf80,0xbf6d3f35,0xbf0ebf35,0x3e483f6d,0x3f0e3f35,0xbe48bf6d
.long 0xbf800000,0x3f800000,0xbf800000,0x3f800000,0xbf0e3f35,0x3e48bf6d,0x3f0ebf35,0xbe483f6d
.long 0x3ec43f80,0xbf6dbf35,0x3ec43f80,0xbf6dbf35,0x3f7b3f35,0xbf0e3ec4,0xbf7bbf35,0x3f0ebec4
.long 0x3f350000,0x3f353f80,0x3f350000,0x3f353f80,0xbe48bf35,0x3f553ec4,0x3e483f35,0xbf55bec4
.long 0xbf6dbf80,0xbec4bf35,0xbf6dbf80,0xbec4bf35,0xbf55bf35,0xbf7bbf6d,0x3f553f35,0x3f7b3f6d
.long 0x0,0x0,0x0,0x0,0xbf7b3f80,0xbf553f6d,0x3f7bbf80,0x3f55bf6d
.long 0x3ec40000,0x3f6dbf35,0x3ec40000,0x3f6dbf35,0x3f55bf80,0xbe48bec4,0xbf553f80,0x3e483ec4
.long 0xbf350000,0xbf353f80,0xbf350000,0xbf353f80,0xbf0e3f80,0x3f7bbec4,0x3f0ebf80,0xbf7b3ec4
.long 0x3f6d0000,0xbec4bf35,0x3f6d0000,0xbec4bf35,0x3e48bf80,0xbf0e3f6d,0xbe483f80,0x3f0ebf6d
.long 0xbf800000,0x3f800000,0xbf800000,0x3f800000,0x3e483f80,0xbf0ebf6d,0xbe48bf80,0x3f0e3f6d
.long 0x3f6d0000,0xbec43f35,0x3f6d0000,0xbec43f35,0xbf0ebf80,0x3f7b3ec4,0x3f0e3f80,0xbf7bbec4
.long 0xbf350000,0xbf35bf80,0xbf350000,0xbf35bf80,0x3f553f80,0xbe483ec4,0xbf55bf80,0x3e48bec4
.long 0x3ec40000,0x3f6d3f35,0x3ec40000,0x3f6d3f35,0xbf7bbf80,0xbf55bf6d,0x3f7b3f80,0x3f553f6d
.long 0x0,0x0,0x0,0x0,0xbf0e3f35,0xbe483ec4,0x3f0ebf35,0x3e48bec4
.long 0x3f6dbf80,0x3ec4bf35,0x3f6dbf80,0x3ec4bf35,0xbf7b3f35,0xbf0e3f6d,0x3f7bbf35,0x3f0ebf6d
.long 0x3f350000,0x3f35bf80,0x3f350000,0x3f35bf80,0xbe48bf35,0xbf553f6d,0x3e483f35,0x3f55bf6d
.long 0xbec43f80,0x3f6dbf35,0xbec43f80,0x3f6dbf35,0x3f55bf35,0xbf7b3ec4,0xbf553f35,0x3f7bbec4
.long 0xbf800000,0x3f800000,0xbf800000,0x3f800000,0x3f553f35,0xbf7bbec4,0xbf55bf35,0x3f7b3ec4
.long 0xbec4bf80,0x3f6d3f35,0xbec4bf80,0x3f6d3f35,0xbe483f35,0xbf55bf6d,0x3e48bf35,0x3f553f6d
.long 0x3f350000,0x3f353f80,0x3f350000,0x3f353f80,0xbf7bbf35,0xbf0ebf6d,0x3f7b3f35,0x3f0e3f6d
.long 0x3f6d3f80,0x3ec43f35,0x3f6d3f80,0x3ec43f35,0xbf0ebf35,0xbe48bec4,0x3f0e3f35,0x3e483ec4
.p2align 8
tab_TW:
.long 0x3f800000,0x3f800000,0x3f800000,0x3f800000,0x3f800000,0x3f7fffb1,0x3f7ffec4,0x3f7ffd39
.long 0x3f800000,0x3f7ffec4,0x3f7ffb11,0x3f7ff4e6,0x3f800000,0x3f7ffd39,0x3f7ff4e6,0x3f7fe705
.long 0x3f800000,0x3f7ffb11,0x3f7fec43,0x3f7fd397,0x3f800000,0x3f7ff84a,0x3f7fe129,0x3f7fba9e
.long 0x3f800000,0x3f7ff4e6,0x3f7fd397,0x3f7f9c18,0x3f800000,0x3f7ff0e3,0x3f7fc38f,0x3f7f7808
.long 0x3f800000,0x3f7fec43,0x3f7fb10f,0x3f7f4e6d,0x3f800000,0x3f7fe705,0x3f7f9c18,0x3f7f1f49
.long 0x3f800000,0x3f7fe129,0x3f7f84ab,0x3f7eea9d,0x3f800000,0x3f7fdaaf,0x3f7f6ac7,0x3f7eb069
.long 0x3f800000,0x3f7fd397,0x3f7f4e6d,0x3f7e70b0,0x3f800000,0x3f7fcbe2,0x3f7f2f9d,0x3f7e2b72
.long 0x3f800000,0x3f7fc38f,0x3f7f0e58,0x3f7de0b1,0x3f800000,0x3f7fba9e,0x3f7eea9d,0x3f7d906e
.long 0x3f800000,0x3f800000,0x3f800000,0x3f800000,0x3f7ffb11,0x3f7ff84a,0x3f7ff4e6,0x3f7ff0e3
.long 0x3f7fec43,0x3f7fe129,0x3f7fd397,0x3f7fc38f,0x3f7fd397,0x3f7fba9e,0x3f7f9c18,0x3f7f7808
.long 0x3f7fb10f,0x3f7f84ab,0x3f7f4e6d,0x3f7f0e58,0x3f7f84ab,0x3f7f3f54,0x3f7eea9d,0x3f7e868b
.long 0x3f7f4e6d,0x3f7eea9d,0x3f7e70b0,0x3f7de0b1,0x3f7f0e58,0x3f7e868b,0x3f7de0b1,0x3f7d1cdd
.long 0x3f7ec46d,0x3f7e1324,0x3f7d3aac,0x3f7c3b28,0x3f7e70b0,0x3f7d906e,0x3f7c7eb0,0x3f7b3bab
.long 0x3f7e1324,0x3f7cfe73,0x3f7baccd,0x3f7a1e84,0x3f7dabcc,0x3f7c5d3a,0x3f7ac516,0x3f78e3d6
.long 0x3f7d3aac,0x3f7baccd,0x3f79c79d,0x3f778bc5,0x3f7cbfc9,0x3f7aed37,0x3f78b47b,0x3f76167a
.long 0x3f7c3b28,0x3f7a1e84,0x3f778bc5,0x3f748422,0x3f7baccd,0x3f7940c0,0x3f764d97,0x3f72d4eb
.long 0x3f800000,0x3f800000,0x3f800000,0x3f800000,0x3f7fec43,0x3f7fe705,0x3f7fe129,0x3f7fdaaf
.long 0x3f7fb10f,0x3f7f9c18,0x3f7f84ab,0x3f7f6ac7,0x3f7f4e6d,0x3f7f1f49,0x3f7eea9d,0x3f7eb069
.long 0x3f7ec46d,0x3f7e70b0,0x3f7e1324,0x3f7dabcc,0x3f7e1324,0x3f7d906e,0x3f7cfe73,0x3f7c5d3a
.long 0x3f7d3aac,0x3f7c7eb0,0x3f7baccd,0x3f7ac516,0x3f7c3b28,0x3f7b3bab,0x3f7a1e84,0x3f78e3d6
.long 0x3f7b14be,0x3f79c79d,0x3f7853f8,0x3f76ba07,0x3f79c79d,0x3f7822d1,0x3f764d97,0x3f74484b
.long 0x3f7853f8,0x3f764d97,0x3f740bdd,0x3f718f57,0x3f76ba07,0x3f74484b,0x3f718f57,0x3f6e8ff8
.long 0x3f74fa0b,0x3f721352,0x3f6ed89e,0x3f6b4b0c,0x3f731447,0x3f6faf1b,0x3f6be858,0x3f67c187
.long 0x3f710908,0x3f6d1c1d,0x3f68bf3c,0x3f63f473,0x3f6ed89e,0x3f6a5ad9,0x3f655e0b,0x3f5fe4e9
.long 0x3f800000,0x3f800000,0x3f800000,0x3f800000,0x3f7fd397,0x3f7fcbe2,0x3f7fc38f,0x3f7fba9e
.long 0x3f7f4e6d,0x3f7f2f9d,0x3f7f0e58,0x3f7eea9d,0x3f7e70b0,0x3f7e2b72,0x3f7de0b1,0x3f7d906e
.long 0x3f7d3aac,0x3f7cbfc9,0x3f7c3b28,0x3f7baccd,0x3f7baccd,0x3f7aed37,0x3f7a1e84,0x3f7940c0
.long 0x3f79c79d,0x3f78b47b,0x3f778bc5,0x3f764d97,0x3f778bc5,0x3f76167a,0x3f748422,0x3f72d4eb
.long 0x3f74fa0b,0x3f731447,0x3f710908,0x3f6ed89e,0x3f721352,0x3f6faf1b,0x3f6d1c1d,0x3f6a5ad9
.long 0x3f6ed89e,0x3f6be858,0x3f68bf3c,0x3f655e0b,0x3f6b4b0c,0x3f67c187,0x3f63f473,0x3f5fe4e9
.long 0x3f676bd8,0x3f633c5a,0x3f5ebe05,0x3f59f26a,0x3f633c5a,0x3f5e5aa6,0x3f591e6a,0x3f5389c7
.long 0x3f5ebe05,0x3f591e6a,0x3f531849,0x3f4cae79,0x3f59f26a,0x3f5389c7,0x3f4cae79,0x3f456439
.long 0x0,0x0,0x0,0x0,0x0,0x3b490fc6,0x3bc90f88,0x3c16cb58
.long 0x0,0x3bc90f88,0x3c490e90,0x3c96c9b6,0x0,0x3c16cb58,0x3c96c9b6,0x3ce22a7a
.long 0x0,0x3c490e90,0x3cc90ab0,0x3d16c32c,0x0,0x3c7b514b,0x3cfb49ba,0x3d3c6dd5
.long 0x0,0x3c96c9b6,0x3d16c32c,0x3d621469,0x0,0x3cafea69,0x3d2fe007,0x3d83db0a
.long 0x0,0x3cc90ab0,0x3d48fb30,0x3d96a905,0x0,0x3ce22a7a,0x3d621469,0x3da973ba
.long 0x0,0x3cfb49ba,0x3d7b2b74,0x3dbc3ac3,0x0,0x3d0a342f,0x3d8a200a,0x3dcefdb7
.long 0x0,0x3d16c32c,0x3d96a905,0x3de1bc2e,0x0,0x3d2351cb,0x3da3308c,0x3df475c0
.long 0x0,0x3d2fe007,0x3dafb680,0x3e039502,0x0,0x3d3c6dd5,0x3dbc3ac3,0x3e0cec4a
.long 0x0,0x0,0x0,0x0,0x3c490e90,0x3c7b514b,0x3c96c9b6,0x3cafea69
.long 0x3cc90ab0,0x3cfb49ba,0x3d16c32c,0x3d2fe007,0x3d16c32c,0x3d3c6dd5,0x3d621469,0x3d83db0a
.long 0x3d48fb30,0x3d7b2b74,0x3d96a905,0x3dafb680,0x3d7b2b74,0x3d9cecf9,0x3dbc3ac3,0x3ddb7d37
.long 0x3d96a905,0x3dbc3ac3,0x3de1bc2e,0x3e039502,0x3dafb680,0x3ddb7d37,0x3e039502,0x3e195be0
.long 0x3dc8bd36,0x3dfab273,0x3e164083,0x3e2f10a2,0x3de1bc2e,0x3e0cec4a,0x3e28defc,0x3e44b0b9
.long 0x3dfab273,0x3e1c76de,0x3e3b6ecf,0x3e5a3997,0x3e09cf86,0x3e2bf804,0x3e4dee60,0x3e6fa8b2
.long 0x3e164083,0x3e3b6ecf,0x3e605c13,0x3e827dc0,0x3e22abb6,0x3e4ada4f,0x3e72b651,0x3e8d17c0
.long 0x3e2f10a2,0x3e5a3997,0x3e827dc0,0x3e97a117,0x3e3b6ecf,0x3e698bba,0x3e8b9507,0x3ea21887
.long 0x0,0x0,0x0,0x0,0x3cc90ab0,0x3ce22a7a,0x3cfb49ba,0x3d0a342f
.long 0x3d48fb30,0x3d621469,0x3d7b2b74,0x3d8a200a,0x3d96a905,0x3da973ba,0x3dbc3ac3,0x3dcefdb7
.long 0x3dc8bd36,0x3de1bc2e,0x3dfab273,0x3e09cf86,0x3dfab273,0x3e0cec4a,0x3e1c76de,0x3e2bf804
.long 0x3e164083,0x3e28defc,0x3e3b6ecf,0x3e4dee60,0x3e2f10a2,0x3e44b0b9,0x3e5a3997,0x3e6fa8b2
.long 0x3e47c5c2,0x3e605c13,0x3e78cfcc,0x3e888e93,0x3e605c13,0x3e7bdba4,0x3e8b9507,0x3e9920fe
.long 0x3e78cfcc,0x3e8b9507,0x3e9aa086,0x3ea986c4,0x3e888e93,0x3e9920fe,0x3ea986c4,0x3eb9bb1e
.long 0x3e94a031,0x3ea68f12,0x3eb8442a,0x3ec9b953,0x3ea09ae5,0x3eb3dca5,0x3ec6d529,0x3ed97cb9
.long 0x3eac7cd4,0x3ec1071e,0x3ed53641,0x3ee900b7,0x3eb8442a,0x3ece0bea,0x3ee363fa,0x3ef840c8
.long 0x0,0x0,0x0,0x0,0x3d16c32c,0x3d2351cb,0x3d2fe007,0x3d3c6dd5
.long 0x3d96a905,0x3da3308c,0x3dafb680,0x3dbc3ac3,0x3de1bc2e,0x3df475c0,0x3e039502,0x3e0cec4a
.long 0x3e164083,0x3e22abb6,0x3e2f10a2,0x3e3b6ecf,0x3e3b6ecf,0x3e4ada4f,0x3e5a3997,0x3e698bba
.long 0x3e605c13,0x3e72b651,0x3e827dc0,0x3e8b9507,0x3e827dc0,0x3e8d17c0,0x3e97a117,0x3ea21887
.long 0x3e94a031,0x3ea09ae5,0x3eac7cd4,0x3eb8442a,0x3ea68f12,0x3eb3dca5,0x3ec1071e,0x3ece0bea
.long 0x3eb8442a,0x3ec6d529,0x3ed53641,0x3ee363fa,0x3ec9b953,0x3ed97cb9,0x3ee900b7,0x3ef840c8
.long 0x3edae880,0x3eebcbbb,0x3efc5d27,0x3f064b82,0x3eebcbbb,0x3efdbabb,0x3f07a136,0x3f102dd5
.long 0x3efc5d27,0x3f07a136,0x3f10d3cd,0x3f19c200,0x3f064b82,0x3f102dd5,0x3f19c200,0x3f2302d3
.long 0x3f800000,0x3f800000,0x3f800000,0x3f800000,0x3f7fb10f,0x3f7fa6e3,0x3f7f9c18,0x3f7f90b1
.long 0x3f7ec46d,0x3f7e9bc9,0x3f7e70b0,0x3f7e4323,0x3f7d3aac,0x3f7cdf6c,0x3f7c7eb0,0x3f7c187a
.long 0x3f7b14be,0x3f7a7302,0x3f79c79d,0x3f791298,0x3f7853f8,0x3f77583a,0x3f764d97,0x3f75341d
.long 0x3f74fa0b,0x3f73913f,0x3f721352,0x3f708066,0x3f710908,0x3f6f20b0,0x3f6d1c1d,0x3f6afb8c
.long 0x3f6c835e,0x3f6a09a7,0x3f676bd8,0x3f64aa59,0x3f676bd8,0x3f644fac,0x3f6106f2,0x3f5d924d
.long 0x3f61c598,0x3f5df6be,0x3f59f26a,0x3f55b993,0x3f5b941a,0x3f570348,0x3f5233c6,0x3f4d26fd
.long 0x3f54db31,0x3f4f7a1f,0x3f49d112,0x3f43e200,0x3f4d9f02,0x3f476085,0x3f40d0da,0x3f39f2ac
.long 0x3f45e403,0x3f3ebc1b,0x3f373a23,0x3f2f61a5,0x3f3daef9,0x3f3592e7,0x3f2d1469,0x3f24381a
.long 0x3f800000,0x3f800000,0x3f800000,0x3f800000,0x3f7f84ab,0x3f7f7808,0x3f7f6ac7,0x3f7f5ce9
.long 0x3f7e1324,0x3f7de0b1,0x3f7dabcc,0x3f7d7474,0x3f7baccd,0x3f7b3bab,0x3f7ac516,0x3f7a4910
.long 0x3f7853f8,0x3f778bc5,0x3f76ba07,0x3f75dec6,0x3f740bdd,0x3f72d4eb,0x3f718f57,0x3f703b37
.long 0x3f6ed89e,0x3f6d1c1d,0x3f6b4b0c,0x3f696591,0x3f68bf3c,0x3f666771,0x3f63f473,0x3f61668a
.long 0x3f61c598,0x3f5ebe05,0x3f5b941a,0x3f584853,0x3f59f26a,0x3f5627fe,0x3f5233c6,0x3f4e1689
.long 0x3f514d3d,0x3f4cae79,0x3f47de65,0x3f42de29,0x3f47de65,0x3f425b89,0x3f3ca003,0x3f36ad7f
.long 0x3f3daef9,0x3f373a23,0x3f3085bb,0x3f299415,0x3f32c8c9,0x3f2b561b,0x3f239da9,0x3f1ba299
.long 0x3f273656,0x3f1ebc12,0x3f15f6d9,0x3f0cead0,0x3f1b02c6,0x3f11796b,0x3f07a136,0x3efafef7
.long 0x3f800000,0x3f800000,0x3f800000,0x3f800000,0x3f7f4e6d,0x3f7f3f54,0x3f7f2f9d,0x3f7f1f49
.long 0x3f7d3aac,0x3f7cfe73,0x3f7cbfc9,0x3f7c7eb0,0x3f79c79d,0x3f7940c0,0x3f78b47b,0x3f7822d1
.long 0x3f74fa0b,0x3f740bdd,0x3f731447,0x3f721352,0x3f6ed89e,0x3f6d67a1,0x3f6be858,0x3f6a5ad9
.long 0x3f676bd8,0x3f655e0b,0x3f633c5a,0x3f6106f2,0x3f5ebe05,0x3f5bfb34,0x3f591e6a,0x3f5627fe
.long 0x3f54db31,0x3f514d3d,0x3f4d9f02,0x3f49d112,0x3f49d112,0x3f456439,0x3f40d0da,0x3f3c17d9
.long 0x3f3daef9,0x3f385216,0x3f32c8c9,0x3f2d1469,0x3f3085bb,0x3f2a2a80,0x3f239da9,0x3f1ce11f
.long 0x3f226799,0x3f1b02c6,0x3f13682a,0x3f0b9a6b,0x3f13682a,0x3f0af1b7,0x3f0242b1,0x3ef2bd43
.long 0x3f039c3d,0x3ef41f07,0x3ee0924f,0x3ecc9b8b,0x3ee63375,0x3ed0eb2a,0x3ebb31a0,0x3ea5129f
.long 0x3f800000,0x3f800000,0x3f800000,0x3f800000,0x3f7f0e58,0x3f7efcc9,0x3f7eea9d,0x3f7ed7d4
.long 0x3f7c3b28,0x3f7bf531,0x3f7baccd,0x3f7b61fc,0x3f778bc5,0x3f76ef5b,0x3f764d97,0x3f75a67b
.long 0x3f710908,0x3f6ff573,0x3f6ed89e,0x3f6db293,0x3f68bf3c,0x3f671599,0x3f655e0b,0x3f6398ac
.long 0x3f5ebe05,0x3f5c61c7,0x3f59f26a,0x3f577026,0x3f531849,0x3f4fefa8,0x3f4cae79,0x3f495521
.long 0x3f45e403,0x3f41d870,0x3f3daef9,0x3f396842,0x3f373a23,0x3f3238aa,0x3f2d1469,0x3f27ce61
.long 0x3f273656,0x3f212ff9,0x3f1b02c6,0x3f14b039,0x3f15f6d9,0x3f0ee0db,0x3f07a136,0x3f003a06
.long 0x3f039c3d,0x3ef6e0cb,0x3ee63375,0x3ed53641,0x3ee0924f,0x3ece0bea,0x3ebb31a0,0x3ea80b1f
.long 0x3eb8442a,0x3ea395c5,0x3e8e9a22,0x3e72b651,0x3e8e9a22,0x3e6fa8b2,0x3e419b37,0x3e1324ca
.long 0x0,0x0,0x0,0x0,0x3d48fb30,0x3d55880e,0x3d621469,0x3d6ea038
.long 0x3dc8bd36,0x3dd53db9,0x3de1bc2e,0x3dee3876,0x3e164083,0x3e1f917b,0x3e28defc,0x3e3228d4
.long 0x3e47c5c2,0x3e541501,0x3e605c13,0x3e6c9a7f,0x3e78cfcc,0x3e840270,0x3e8b9507,0x3e931f35
.long 0x3e94a031,0x3e9d9e78,0x3ea68f12,0x3eaf713a,0x3eac7cd4,0x3eb6ccc3,0x3ec1071e,0x3ecb2aae
.long 0x3ec3ef15,0x3ecf7bca,0x3edae880,0x3ee63375,0x3edae880,0x3ee79a5d,0x3ef41f07,0x3f003a06
.long 0x3ef15aea,0x3eff17b2,0x3f064b82,0x3f0cead0,0x3f039c3d,0x3f0af1b7,0x3f121eb0,0x3f19210f
.long 0x3f0e39da,0x3f15f6d9,0x3f1d7fd1,0x3f24d225,0x3f187fc0,0x3f209393,0x3f286605,0x3f2ff3e6
.long 0x3f226799,0x3f2ac082,0x3f32c8c9,0x3f3a7ca4,0x3f2beb4a,0x3f34768f,0x3f3ca003,0x3f446337
.long 0x0,0x0,0x0,0x0,0x3d7b2b74,0x3d83db0a,0x3d8a200a,0x3d9064b4
.long 0x3dfab273,0x3e039502,0x3e09cf86,0x3e1008b7,0x3e3b6ecf,0x3e44b0b9,0x3e4dee60,0x3e57278f
.long 0x3e78cfcc,0x3e827dc0,0x3e888e93,0x3e8e9a22,0x3e9aa086,0x3ea21887,0x3ea986c4,0x3eb0eacb
.long 0x3eb8442a,0x3ec1071e,0x3ec9b953,0x3ed25a09,0x3ed53641,0x3edf28a9,0x3ee900b7,0x3ef2bd43
.long 0x3ef15aea,0x3efc5d27,0x3f039c3d,0x3f08f59b,0x3f064b82,0x3f0c42c9,0x3f121eb0,0x3f17de12
.long 0x3f13682a,0x3f19c200,0x3f1ff6cb,0x3f26050a,0x3f1ff6cb,0x3f269de3,0x3f2d1469,0x3f33587a
.long 0x3f2beb4a,0x3f32c8c9,0x3f396842,0x3f3fc767,0x3f373a23,0x3f3e35c5,0x3f44e3f5,0x3f4b41fa
.long 0x3f41d870,0x3f48d8b3,0x3f4f7a1f,0x3f55b993,0x3f4bbbf8,0x3f52a649,0x3f591e6a,0x3f5f20db
.long 0x0,0x0,0x0,0x0,0x3d96a905,0x3d9cecf9,0x3da3308c,0x3da973ba
.long 0x3e164083,0x3e1c76de,0x3e22abb6,0x3e28defc,0x3e605c13,0x3e698bba,0x3e72b651,0x3e7bdba4
.long 0x3e94a031,0x3e9aa086,0x3ea09ae5,0x3ea68f12,0x3eb8442a,0x3ebf926f,0x3ec6d529,0x3ece0bea
.long 0x3edae880,0x3ee363fa,0x3eebcbbb,0x3ef41f07,0x3efc5d27,0x3f02ef9f,0x3f07a136,0x3f0c42c9
.long 0x3f0e39da,0x3f13682a,0x3f187fc0,0x3f1d7fd1,0x3f1d7fd1,0x3f2302d3,0x3f286605,0x3f2da859
.long 0x3f2beb4a,0x3f31a81d,0x3f373a23,0x3f3ca003,0x3f396842,0x3f3f41fc,0x3f44e3f5,0x3f4a4c87
.long 0x3f45e403,0x3f4bbbf8,0x3f514d3d,0x3f5695e5,0x3f514d3d,0x3f570348,0x3f5c61c7,0x3f61668a
.long 0x3f5b941a,0x3f6106f2,0x3f660f88,0x3f6aab7b,0x3f64aa59,0x3f69b7e4,0x3f6e46be,0x3f725470
.long 0x0,0x0,0x0,0x0,0x3dafb680,0x3db5f8da,0x3dbc3ac3,0x3dc27c39
.long 0x3e2f10a2,0x3e354098,0x3e3b6ecf,0x3e419b37,0x3e827dc0,0x3e870ada,0x3e8b9507,0x3e901c2c
.long 0x3eac7cd4,0x3eb263ef,0x3eb8442a,0x3ebe1d4a,0x3ed53641,0x3edc53c1,0x3ee363fa,0x3eea6681
.long 0x3efc5d27,0x3f0242b1,0x3f064b82,0x3f0a48ad,0x3f10d3cd,0x3f1553b7,0x3f19c200,0x3f1e1e22
.long 0x3f226799,0x3f273656,0x3f2beb4a,0x3f3085bb,0x3f32c8c9,0x3f37c655,0x3f3ca003,0x3f4154e1
.long 0x3f41d870,0x3f46e22a,0x3f4bbbf8,0x3f5064af,0x3f4f7a1f,0x3f546b3b,0x3f591e6a,0x3f5d924d
.long 0x3f5b941a,0x3f604621,0x3f64aa59,0x3f68bf3c,0x3f660f88,0x3f6a5ad9,0x3f6e46be,0x3f71d19f
.long 0x3f6ed89e,0x3f7294f8,0x3f75dec6,0x3f78b47b,0x3f75dec6,0x3f78e3d6,0x3f7b61fc,0x3f7d57de
.long 0x3f800000,0x3f7fb10f,0x3f7ec46d,0x3f7d3aac,0x3f800000,0x3f7fa6e3,0x3f7e9bc9,0x3f7cdf6c
.long 0x3f800000,0x3f7f9c18,0x3f7e70b0,0x3f7c7eb0,0x3f800000,0x3f7f90b1,0x3f7e4323,0x3f7c187a
.long 0x3f800000,0x3f7f84ab,0x3f7e1324,0x3f7baccd,0x3f800000,0x3f7f7808,0x3f7de0b1,0x3f7b3bab
.long 0x3f800000,0x3f7f6ac7,0x3f7dabcc,0x3f7ac516,0x3f800000,0x3f7f5ce9,0x3f7d7474,0x3f7a4910
.long 0x3f800000,0x3f7f4e6d,0x3f7d3aac,0x3f79c79d,0x3f800000,0x3f7f3f54,0x3f7cfe73,0x3f7940c0
.long 0x3f800000,0x3f7f2f9d,0x3f7cbfc9,0x3f78b47b,0x3f800000,0x3f7f1f49,0x3f7c7eb0,0x3f7822d1
.long 0x3f800000,0x3f7f0e58,0x3f7c3b28,0x3f778bc5,0x3f800000,0x3f7efcc9,0x3f7bf531,0x3f76ef5b
.long 0x3f800000,0x3f7eea9d,0x3f7baccd,0x3f764d97,0x3f800000,0x3f7ed7d4,0x3f7b61fc,0x3f75a67b
.long 0x3f7b14be,0x3f7853f8,0x3f74fa0b,0x3f710908,0x3f7a7302,0x3f77583a,0x3f73913f,0x3f6f20b0
.long 0x3f79c79d,0x3f764d97,0x3f721352,0x3f6d1c1d,0x3f791298,0x3f75341d,0x3f708066,0x3f6afb8c
.long 0x3f7853f8,0x3f740bdd,0x3f6ed89e,0x3f68bf3c,0x3f778bc5,0x3f72d4eb,0x3f6d1c1d,0x3f666771
.long 0x3f76ba07,0x3f718f57,0x3f6b4b0c,0x3f63f473,0x3f75dec6,0x3f703b37,0x3f696591,0x3f61668a
.long 0x3f74fa0b,0x3f6ed89e,0x3f676bd8,0x3f5ebe05,0x3f740bdd,0x3f6d67a1,0x3f655e0b,0x3f5bfb34
.long 0x3f731447,0x3f6be858,0x3f633c5a,0x3f591e6a,0x3f721352,0x3f6a5ad9,0x3f6106f2,0x3f5627fe
.long 0x3f710908,0x3f68bf3c,0x3f5ebe05,0x3f531849,0x3f6ff573,0x3f671599,0x3f5c61c7,0x3f4fefa8
.long 0x3f6ed89e,0x3f655e0b,0x3f59f26a,0x3f4cae79,0x3f6db293,0x3f6398ac,0x3f577026,0x3f495521
.long 0x3f6c835e,0x3f676bd8,0x3f61c598,0x3f5b941a,0x3f6a09a7,0x3f644fac,0x3f5df6be,0x3f570348
.long 0x3f676bd8,0x3f6106f2,0x3f59f26a,0x3f5233c6,0x3f64aa59,0x3f5d924d,0x3f55b993,0x3f4d26fd
.long 0x3f61c598,0x3f59f26a,0x3f514d3d,0x3f47de65,0x3f5ebe05,0x3f5627fe,0x3f4cae79,0x3f425b89
.long 0x3f5b941a,0x3f5233c6,0x3f47de65,0x3f3ca003,0x3f584853,0x3f4e1689,0x3f42de29,0x3f36ad7f
.long 0x3f54db31,0x3f49d112,0x3f3daef9,0x3f3085bb,0x3f514d3d,0x3f456439,0x3f385216,0x3f2a2a80
.long 0x3f4d9f02,0x3f40d0da,0x3f32c8c9,0x3f239da9,0x3f49d112,0x3f3c17d9,0x3f2d1469,0x3f1ce11f
.long 0x3f45e403,0x3f373a23,0x3f273656,0x3f15f6d9,0x3f41d870,0x3f3238aa,0x3f212ff9,0x3f0ee0db
.long 0x3f3daef9,0x3f2d1469,0x3f1b02c6,0x3f07a136,0x3f396842,0x3f27ce61,0x3f14b039,0x3f003a06
.long 0x3f54db31,0x3f4d9f02,0x3f45e403,0x3f3daef9,0x3f4f7a1f,0x3f476085,0x3f3ebc1b,0x3f3592e7
.long 0x3f49d112,0x3f40d0da,0x3f373a23,0x3f2d1469,0x3f43e200,0x3f39f2ac,0x3f2f61a5,0x3f24381a
.long 0x3f3daef9,0x3f32c8c9,0x3f273656,0x3f1b02c6,0x3f373a23,0x3f2b561b,0x3f1ebc12,0x3f11796b
.long 0x3f3085bb,0x3f239da9,0x3f15f6d9,0x3f07a136,0x3f299415,0x3f1ba299,0x3f0cead0,0x3efafef7
.long 0x3f226799,0x3f13682a,0x3f039c3d,0x3ee63375,0x3f1b02c6,0x3f0af1b7,0x3ef41f07,0x3ed0eb2a
.long 0x3f13682a,0x3f0242b1,0x3ee0924f,0x3ebb31a0,0x3f0b9a6b,0x3ef2bd43,0x3ecc9b8b,0x3ea5129f
.long 0x3f039c3d,0x3ee0924f,0x3eb8442a,0x3e8e9a22,0x3ef6e0cb,0x3ece0bea,0x3ea395c5,0x3e6fa8b2
.long 0x3ee63375,0x3ebb31a0,0x3e8e9a22,0x3e419b37,0x3ed53641,0x3ea80b1f,0x3e72b651,0x3e1324ca
.long 0x0,0x3d48fb30,0x3dc8bd36,0x3e164083,0x0,0x3d55880e,0x3dd53db9,0x3e1f917b
.long 0x0,0x3d621469,0x3de1bc2e,0x3e28defc,0x0,0x3d6ea038,0x3dee3876,0x3e3228d4
.long 0x0,0x3d7b2b74,0x3dfab273,0x3e3b6ecf,0x0,0x3d83db0a,0x3e039502,0x3e44b0b9
.long 0x0,0x3d8a200a,0x3e09cf86,0x3e4dee60,0x0,0x3d9064b4,0x3e1008b7,0x3e57278f
.long 0x0,0x3d96a905,0x3e164083,0x3e605c13,0x0,0x3d9cecf9,0x3e1c76de,0x3e698bba
.long 0x0,0x3da3308c,0x3e22abb6,0x3e72b651,0x0,0x3da973ba,0x3e28defc,0x3e7bdba4
.long 0x0,0x3dafb680,0x3e2f10a2,0x3e827dc0,0x0,0x3db5f8da,0x3e354098,0x3e870ada
.long 0x0,0x3dbc3ac3,0x3e3b6ecf,0x3e8b9507,0x0,0x3dc27c39,0x3e419b37,0x3e901c2c
.long 0x3e47c5c2,0x3e78cfcc,0x3e94a031,0x3eac7cd4,0x3e541501,0x3e840270,0x3e9d9e78,0x3eb6ccc3
.long 0x3e605c13,0x3e8b9507,0x3ea68f12,0x3ec1071e,0x3e6c9a7f,0x3e931f35,0x3eaf713a,0x3ecb2aae
.long 0x3e78cfcc,0x3e9aa086,0x3eb8442a,0x3ed53641,0x3e827dc0,0x3ea21887,0x3ec1071e,0x3edf28a9
.long 0x3e888e93,0x3ea986c4,0x3ec9b953,0x3ee900b7,0x3e8e9a22,0x3eb0eacb,0x3ed25a09,0x3ef2bd43
.long 0x3e94a031,0x3eb8442a,0x3edae880,0x3efc5d27,0x3e9aa086,0x3ebf926f,0x3ee363fa,0x3f02ef9f
.long 0x3ea09ae5,0x3ec6d529,0x3eebcbbb,0x3f07a136,0x3ea68f12,0x3ece0bea,0x3ef41f07,0x3f0c42c9
.long 0x3eac7cd4,0x3ed53641,0x3efc5d27,0x3f10d3cd,0x3eb263ef,0x3edc53c1,0x3f0242b1,0x3f1553b7
.long 0x3eb8442a,0x3ee363fa,0x3f064b82,0x3f19c200,0x3ebe1d4a,0x3eea6681,0x3f0a48ad,0x3f1e1e22
.long 0x3ec3ef15,0x3edae880,0x3ef15aea,0x3f039c3d,0x3ecf7bca,0x3ee79a5d,0x3eff17b2,0x3f0af1b7
.long 0x3edae880,0x3ef41f07,0x3f064b82,0x3f121eb0,0x3ee63375,0x3f003a06,0x3f0cead0,0x3f19210f
.long 0x3ef15aea,0x3f064b82,0x3f13682a,0x3f1ff6cb,0x3efc5d27,0x3f0c42c9,0x3f19c200,0x3f269de3
.long 0x3f039c3d,0x3f121eb0,0x3f1ff6cb,0x3f2d1469,0x3f08f59b,0x3f17de12,0x3f26050a,0x3f33587a
.long 0x3f0e39da,0x3f1d7fd1,0x3f2beb4a,0x3f396842,0x3f13682a,0x3f2302d3,0x3f31a81d,0x3f3f41fc
.long 0x3f187fc0,0x3f286605,0x3f373a23,0x3f44e3f5,0x3f1d7fd1,0x3f2da859,0x3f3ca003,0x3f4a4c87
.long 0x3f226799,0x3f32c8c9,0x3f41d870,0x3f4f7a1f,0x3f273656,0x3f37c655,0x3f46e22a,0x3f546b3b
.long 0x3f2beb4a,0x3f3ca003,0x3f4bbbf8,0x3f591e6a,0x3f3085bb,0x3f4154e1,0x3f5064af,0x3f5d924d
.long 0x3f0e39da,0x3f187fc0,0x3f226799,0x3f2beb4a,0x3f15f6d9,0x3f209393,0x3f2ac082,0x3f34768f
.long 0x3f1d7fd1,0x3f286605,0x3f32c8c9,0x3f3ca003,0x3f24d225,0x3f2ff3e6,0x3f3a7ca4,0x3f446337
.long 0x3f2beb4a,0x3f373a23,0x3f41d870,0x3f4bbbf8,0x3f32c8c9,0x3f3e35c5,0x3f48d8b3,0x3f52a649
.long 0x3f396842,0x3f44e3f5,0x3f4f7a1f,0x3f591e6a,0x3f3fc767,0x3f4b41fa,0x3f55b993,0x3f5f20db
.long 0x3f45e403,0x3f514d3d,0x3f5b941a,0x3f64aa59,0x3f4bbbf8,0x3f570348,0x3f6106f2,0x3f69b7e4
.long 0x3f514d3d,0x3f5c61c7,0x3f660f88,0x3f6e46be,0x3f5695e5,0x3f61668a,0x3f6aab7b,0x3f725470
.long 0x3f5b941a,0x3f660f88,0x3f6ed89e,0x3f75dec6,0x3f604621,0x3f6a5ad9,0x3f7294f8,0x3f78e3d6
.long 0x3f64aa59,0x3f6e46be,0x3f75dec6,0x3f7b61fc,0x3f68bf3c,0x3f71d19f,0x3f78b47b,0x3f7d57de
.long 0x3f3504f3,0x3f2beb4a,0x3f226799,0x3f187fc0,0x3f2beb4a,0x3f21cbfb,0x3f173c07,0x3f0c42c9
.long 0x3f226799,0x3f173c07,0x3f0b9a6b,0x3eff17b2,0x3f187fc0,0x3f0c42c9,0x3eff17b2,0x3ee4cbfe
.long 0x3f0e39da,0x3f00e7e4,0x3ee63375,0x3ec9b953,0x3f039c3d,0x3eea6681,0x3ecc9b8b,0x3eadf73c
.long 0x3ef15aea,0x3ed25a09,0x3eb263ef,0x3e919ddd,0x3edae880,0x3eb9bb1e,0x3e97a117,0x3e698bba
.long 0x3ec3ef15,0x3ea09ae5,0x3e78cfcc,0x3e2f10a2,0x3eac7cd4,0x3e870ada,0x3e419b37,0x3de7fa9a
.long 0x3e94a031,0x3e5a3997,0x3e09cf86,0x3d621469,0x3e78cfcc,0x3e25c58c,0x3da3308c,0xbb490fc6
.long 0x3e47c5c2,0x3de1bc2e,0x3cc90ab0,0xbd7b2b74,0x3e164083,0x3d6ea038,0xbcfb49ba,0xbdf475c0
.long 0x3dc8bd36,0x3bc90f88,0xbdafb680,0xbe354098,0x3d48fb30,0xbd3c6dd5,0xbe1008b7,0xbe6fa8b2
.long 0x3f0e39da,0x3f039c3d,0x3ef15aea,0x3edae880,0x3f00e7e4,0x3eea6681,0x3ed25a09,0x3eb9bb1e
.long 0x3ee63375,0x3ecc9b8b,0x3eb263ef,0x3e97a117,0x3ec9b953,0x3eadf73c,0x3e919ddd,0x3e698bba
.long 0x3eac7cd4,0x3e8e9a22,0x3e605c13,0x3e22abb6,0x3e8e9a22,0x3e5d4b1a,0x3e1c76de,0x3db5f8da
.long 0x3e605c13,0x3e1c76de,0x3dafb680,0x3c96c9b6,0x3e22abb6,0x3db5f8da,0x3c96c9b6,0xbd55880e
.long 0x3dc8bd36,0x3cc90ab0,0xbd48fb30,0xbdfab273,0x3d16c32c,0xbd2351cb,0xbdee3876,0xbe44b0b9
.long 0xbcc90ab0,0xbdd53db9,0xbe3b6ecf,0xbe8586ce,0xbdafb680,0xbe2bf804,0xbe7ee6e1,0xbea80b1f
.long 0xbe164083,0xbe6c9a7f,0xbea09ae5,0xbec9b953,0xbe541501,0xbe9620d2,0xbec1071e,0xbeea6681
.long 0xbe888e93,0xbeb554ec,0xbee0924f,0xbf04f484,0xbea68f12,0xbed3c867,0xbeff17b2,0xbf140c5f
.long 0x3ec3ef15,0x3eac7cd4,0x3e94a031,0x3e78cfcc,0x3ea09ae5,0x3e870ada,0x3e5a3997,0x3e25c58c
.long 0x3e78cfcc,0x3e419b37,0x3e09cf86,0x3da3308c,0x3e2f10a2,0x3de7fa9a,0x3d621469,0xbb490fc6
.long 0x3dc8bd36,0x3d16c32c,0xbcc90ab0,0xbdafb680,0x3cc90ab0,0xbd2351cb,0xbdd53db9,0xbe2bf804
.long 0xbd48fb30,0xbdee3876,0xbe3b6ecf,0xbe7ee6e1,0xbdfab273,0xbe44b0b9,0xbe8586ce,0xbea80b1f
.long 0xbe47c5c2,0xbe888e93,0xbeac7cd4,0xbecf7bca,0xbe888e93,0xbeadf73c,0xbed25a09,0xbef58035
.long 0xbeac7cd4,0xbed25a09,0xbef6e0cb,0xbf0cead0,0xbecf7bca,0xbef58035,0xbf0cead0,0xbf1e1e22
.long 0xbef15aea,0xbf0b9a6b,0xbf1d7fd1,0xbf2e3bde,0xbf08f59b,0xbf1ba299,0xbf2d1469,0xbf3d27b8
.long 0xbf187fc0,0xbf2ac082,0xbf3b8f3b,0xbf4ac77f,0xbf273656,0xbf38dd65,0xbf48d8b3,0xbf570348
.long 0x3e47c5c2,0x3e164083,0x3dc8bd36,0x3d48fb30,0x3de1bc2e,0x3d6ea038,0x3bc90f88,0xbd3c6dd5
.long 0x3cc90ab0,0xbcfb49ba,0xbdafb680,0xbe1008b7,0xbd7b2b74,0xbdf475c0,0xbe354098,0xbe6fa8b2
.long 0xbe164083,0xbe541501,0xbe888e93,0xbea68f12,0xbe6c9a7f,0xbe9620d2,0xbeb554ec,0xbed3c867
.long 0xbea09ae5,0xbec1071e,0xbee0924f,0xbeff17b2,0xbec9b953,0xbeea6681,0xbf04f484,0xbf140c5f
.long 0xbef15aea,0xbf08f59b,0xbf187fc0,0xbf273656,0xbf0b9a6b,0xbf1ba299,0xbf2ac082,0xbf38dd65
.long 0xbf1d7fd1,0xbf2d1469,0xbf3b8f3b,0xbf48d8b3,0xbf2e3bde,0xbf3d27b8,0xbf4ac77f,0xbf570348
.long 0xbf3daef9,0xbf4bbbf8,0xbf584853,0xbf633c5a,0xbf4bbbf8,0xbf58b3a1,0xbf63f473,0xbf6d67a1
.long 0xbf584853,0xbf63f473,0xbf6db293,0xbf756d97,0xbf633c5a,0xbf6d67a1,0xbf756d97,0xbf7b3bab
.long 0x3f3504f3,0x3f3daef9,0x3f45e403,0x3f4d9f02,0x3f3daef9,0x3f466354,0x3f4e8d90,0x3f5627fe
.long 0x3f45e403,0x3f4e8d90,0x3f5695e5,0x3f5df6be,0x3f4d9f02,0x3f5627fe,0x3f5df6be,0x3f650479
.long 0x3f54db31,0x3f5d2d53,0x3f64aa59,0x3f6b4b0c,0x3f5b941a,0x3f6398ac,0x3f6aab7b,0x3f70c501
.long 0x3f61c598,0x3f696591,0x3f6ff573,0x3f756d97,0x3f676bd8,0x3f6e8ff8,0x3f748422,0x3f7940c0
.long 0x3f6c835e,0x3f731447,0x3f7853f8,0x3f7c3b28,0x3f710908,0x3f76ef5b,0x3f7b61fc,0x3f7e5a38
.long 0x3f74fa0b,0x3f7a1e84,0x3f7dabcc,0x3f7f9c18,0x3f7853f8,0x3f7c9f8a,0x3f7f2f9d,0x3f7fffb1
.long 0x3f7b14be,0x3f7e70b0,0x3f7fec43,0x3f7f84ab,0x3f7d3aac,0x3f7f90b1,0x3f7fe129,0x3f7e2b72
.long 0x3f7ec46d,0x3f7ffec4,0x3f7f0e58,0x3f7bf531,0x3f7fb10f,0x3f7fba9e,0x3f7d7474,0x3f78e3d6
.long 0x3f54db31,0x3f5b941a,0x3f61c598,0x3f676bd8,0x3f5d2d53,0x3f6398ac,0x3f696591,0x3f6e8ff8
.long 0x3f64aa59,0x3f6aab7b,0x3f6ff573,0x3f748422,0x3f6b4b0c,0x3f70c501,0x3f756d97,0x3f7940c0
.long 0x3f710908,0x3f75dec6,0x3f79c79d,0x3f7cbfc9,0x3f75dec6,0x3f79f35e,0x3f7cfe73,0x3f7efcc9
.long 0x3f79c79d,0x3f7cfe73,0x3f7f0e58,0x3f7ff4e6,0x3f7cbfc9,0x3f7efcc9,0x3f7ff4e6,0x3f7fa6e3
.long 0x3f7ec46d,0x3f7fec43,0x3f7fb10f,0x3f7e1324,0x3f7fd397,0x3f7fcbe2,0x3f7e4323,0x3f7b3bab
.long 0x3f7fec43,0x3f7e9bc9,0x3f7baccd,0x3f772417,0x3f7f0e58,0x3f7c5d3a,0x3f77f110,0x3f71d19f
.long 0x3f7d3aac,0x3f791298,0x3f731447,0x3f6b4b0c,0x3f7a7302,0x3f74bf62,0x3f6d1c1d,0x3f6398ac
.long 0x3f76ba07,0x3f6f6830,0x3f660f88,0x3f5ac450,0x3f721352,0x3f6912ae,0x3f5df6be,0x3f50d937
.long 0x3f6c835e,0x3f710908,0x3f74fa0b,0x3f7853f8,0x3f731447,0x3f76ef5b,0x3f7a1e84,0x3f7c9f8a
.long 0x3f7853f8,0x3f7b61fc,0x3f7dabcc,0x3f7f2f9d,0x3f7c3b28,0x3f7e5a38,0x3f7f9c18,0x3f7fffb1
.long 0x3f7ec46d,0x3f7fd397,0x3f7fec43,0x3f7f0e58,0x3f7fec43,0x3f7fcbe2,0x3f7e9bc9,0x3f7c5d3a
.long 0x3f7fb10f,0x3f7e4323,0x3f7baccd,0x3f77f110,0x3f7e1324,0x3f7b3bab,0x3f772417,0x3f71d19f
.long 0x3f7b14be,0x3f76ba07,0x3f710908,0x3f6a09a7,0x3f76ba07,0x3f70c501,0x3f696591,0x3f60a6cf
.long 0x3f710908,0x3f696591,0x3f604621,0x3f55b993,0x3f6a09a7,0x3f60a6cf,0x3f55b993,0x3f495521
.long 0x3f61c598,0x3f5695e5,0x3f49d112,0x3f3b8f3b,0x3f584853,0x3f4b41fa,0x3f3ca003,0x3f2c800f
.long 0x3f4d9f02,0x3f3ebc1b,0x3f2e3bde,0x3f1c420c,0x3f41d870,0x3f311722,0x3f1ebc12,0x3f0af1b7
.long 0x3f7b14be,0x3f7d3aac,0x3f7ec46d,0x3f7fb10f,0x3f7e70b0,0x3f7f90b1,0x3f7ffec4,0x3f7fba9e
.long 0x3f7fec43,0x3f7fe129,0x3f7f0e58,0x3f7d7474,0x3f7f84ab,0x3f7e2b72,0x3f7bf531,0x3f78e3d6
.long 0x3f7d3aac,0x3f7a7302,0x3f76ba07,0x3f721352,0x3f791298,0x3f74bf62,0x3f6f6830,0x3f6912ae
.long 0x3f731447,0x3f6d1c1d,0x3f660f88,0x3f5df6be,0x3f6b4b0c,0x3f6398ac,0x3f5ac450,0x3f50d937
.long 0x3f61c598,0x3f584853,0x3f4d9f02,0x3f41d870,0x3f5695e5,0x3f4b41fa,0x3f3ebc1b,0x3f311722
.long 0x3f49d112,0x3f3ca003,0x3f2e3bde,0x3f1ebc12,0x3f3b8f3b,0x3f2c800f,0x3f1c420c,0x3f0af1b7
.long 0x3f2beb4a,0x3f1b02c6,0x3f08f59b,0x3eebcbbb,0x3f1b02c6,0x3f084b92,0x3ee900b7,0x3ebf926f
.long 0x3f08f59b,0x3ee900b7,0x3ebe1d4a,0x3e919ddd,0x3eebcbbb,0x3ebf926f,0x3e919ddd,0x3e44b0b9
.long 0x3f800000,0x3f7ec46d,0x3f7b14be,0x3f74fa0b,0x3f800000,0x3f7eb069,0x3f7ac516,0x3f74484b
.long 0x3f800000,0x3f7e9bc9,0x3f7a7302,0x3f73913f,0x3f800000,0x3f7e868b,0x3f7a1e84,0x3f72d4eb
.long 0x3f800000,0x3f7e70b0,0x3f79c79d,0x3f721352,0x3f800000,0x3f7e5a38,0x3f796e4e,0x3f714c7a
.long 0x3f800000,0x3f7e4323,0x3f791298,0x3f708066,0x3f800000,0x3f7e2b72,0x3f78b47b,0x3f6faf1b
.long 0x3f800000,0x3f7e1324,0x3f7853f8,0x3f6ed89e,0x3f800000,0x3f7dfa38,0x3f77f110,0x3f6dfcf2
.long 0x3f800000,0x3f7de0b1,0x3f778bc5,0x3f6d1c1d,0x3f800000,0x3f7dc68c,0x3f772417,0x3f6c3624
.long 0x3f800000,0x3f7dabcc,0x3f76ba07,0x3f6b4b0c,0x3f800000,0x3f7d906e,0x3f764d97,0x3f6a5ad9
.long 0x3f800000,0x3f7d7474,0x3f75dec6,0x3f696591,0x3f800000,0x3f7d57de,0x3f756d97,0x3f686b39
.long 0x3f6c835e,0x3f61c598,0x3f54db31,0x3f45e403,0x3f6b4b0c,0x3f5fe4e9,0x3f5233c6,0x3f425b89
.long 0x3f6a09a7,0x3f5df6be,0x3f4f7a1f,0x3f3ebc1b,0x3f68bf3c,0x3f5bfb34,0x3f4cae79,0x3f3b0629
.long 0x3f676bd8,0x3f59f26a,0x3f49d112,0x3f373a23,0x3f660f88,0x3f57dc7f,0x3f46e22a,0x3f33587a
.long 0x3f64aa59,0x3f55b993,0x3f43e200,0x3f2f61a5,0x3f633c5a,0x3f5389c7,0x3f40d0da,0x3f2b561b
.long 0x3f61c598,0x3f514d3d,0x3f3daef9,0x3f273656,0x3f604621,0x3f4f0417,0x3f3a7ca4,0x3f2302d3
.long 0x3f5ebe05,0x3f4cae79,0x3f373a23,0x3f1ebc12,0x3f5d2d53,0x3f4a4c87,0x3f33e7bc,0x3f1a6293
.long 0x3f5b941a,0x3f47de65,0x3f3085bb,0x3f15f6d9,0x3f59f26a,0x3f456439,0x3f2d1469,0x3f11796b
.long 0x3f584853,0x3f42de29,0x3f299415,0x3f0cead0,0x3f5695e5,0x3f404c5c,0x3f26050a,0x3f084b92
.long 0x3f3504f3,0x3f226799,0x3f0e39da,0x3ef15aea,0x3f3085bb,0x3f1ce11f,0x3f07a136,0x3ee1fb6a
.long 0x3f2beb4a,0x3f173c07,0x3f00e7e4,0x3ed25a09,0x3f273656,0x3f11796b,0x3ef41f07,0x3ec27b55
.long 0x3f226799,0x3f0b9a6b,0x3ee63375,0x3eb263ef,0x3f1d7fd1,0x3f05a02c,0x3ed8106b,0x3ea21887
.long 0x3f187fc0,0x3eff17b2,0x3ec9b953,0x3e919ddd,0x3f13682a,0x3ef2bd43,0x3ebb31a0,0x3e80f8c0
.long 0x3f0e39da,0x3ee63375,0x3eac7cd4,0x3e605c13,0x3f08f59b,0x3ed97cb9,0x3e9d9e78,0x3e3e853e
.long 0x3f039c3d,0x3ecc9b8b,0x3e8e9a22,0x3e1c76de,0x3efc5d27,0x3ebf926f,0x3e7ee6e1,0x3df475c0
.long 0x3ef15aea,0x3eb263ef,0x3e605c13,0x3dafb680,0x3ee63375,0x3ea5129f,0x3e419b37,0x3d55880e
.long 0x3edae880,0x3e97a117,0x3e22abb6,0x3c96c9b6,0x3ecf7bca,0x3e8a11f7,0x3e039502,0xbc7b514b
.long 0x3ec3ef15,0x3e94a031,0x3e47c5c2,0x3dc8bd36,0x3eb263ef,0x3e80f8c0,0x3e1c76de,0x3d55880e
.long 0x3ea09ae5,0x3e5a3997,0x3de1bc2e,0x3bc90f88,0x3e8e9a22,0x3e3228d4,0x3d8a200a,0xbd2351cb
.long 0x3e78cfcc,0x3e09cf86,0x3cc90ab0,0xbdafb680,0x3e541501,0x3dc27c39,0xbc96c9b6,0xbe06b26e
.long 0x3e2f10a2,0x3d621469,0xbd7b2b74,0xbe354098,0x3e09cf86,0x3c7b514b,0xbdd53db9,0xbe636c83
.long 0x3dc8bd36,0xbcc90ab0,0xbe164083,0xbe888e93,0x3d7b2b74,0xbd83db0a,0xbe419b37,0xbe9f1cdf
.long 0x3cc90ab0,0xbdd53db9,0xbe6c9a7f,0xbeb554ec,0xbc490e90,0xbe1324ca,0xbe8b9507,0xbecb2aae
.long 0xbd48fb30,0xbe3b6ecf,0xbea09ae5,0xbee0924f,0xbdafb680,0xbe636c83,0xbeb554ec,0xbef58035
.long 0xbdfab273,0xbe8586ce,0xbec9b953,0xbf04f484,0xbe22abb6,0xbe9920fe,0xbeddbe79,0xbf0ee0db
.long 0x0,0x3dc8bd36,0x3e47c5c2,0x3e94a031,0x0,0x3dcefdb7,0x3e4dee60,0x3e9920fe
.long 0x0,0x3dd53db9,0x3e541501,0x3e9d9e78,0x0,0x3ddb7d37,0x3e5a3997,0x3ea21887
.long 0x0,0x3de1bc2e,0x3e605c13,0x3ea68f12,0x0,0x3de7fa9a,0x3e667c66,0x3eab0201
.long 0x0,0x3dee3876,0x3e6c9a7f,0x3eaf713a,0x0,0x3df475c0,0x3e72b651,0x3eb3dca5
.long 0x0,0x3dfab273,0x3e78cfcc,0x3eb8442a,0x0,0x3e007745,0x3e7ee6e1,0x3ebca7af
.long 0x0,0x3e039502,0x3e827dc0,0x3ec1071e,0x0,0x3e06b26e,0x3e8586ce,0x3ec5625c
.long 0x0,0x3e09cf86,0x3e888e93,0x3ec9b953,0x0,0x3e0cec4a,0x3e8b9507,0x3ece0bea
.long 0x0,0x3e1008b7,0x3e8e9a22,0x3ed25a09,0x0,0x3e1324ca,0x3e919ddd,0x3ed6a399
.long 0x3ec3ef15,0x3ef15aea,0x3f0e39da,0x3f226799,0x3ec9b953,0x3ef840c8,0x3f121eb0,0x3f269de3
.long 0x3ecf7bca,0x3eff17b2,0x3f15f6d9,0x3f2ac082,0x3ed53641,0x3f02ef9f,0x3f19c200,0x3f2ecef7
.long 0x3edae880,0x3f064b82,0x3f1d7fd1,0x3f32c8c9,0x3ee0924f,0x3f099f4e,0x3f212ff9,0x3f36ad7f
.long 0x3ee63375,0x3f0cead0,0x3f24d225,0x3f3a7ca4,0x3eebcbbb,0x3f102dd5,0x3f286605,0x3f3e35c5
.long 0x3ef15aea,0x3f13682a,0x3f2beb4a,0x3f41d870,0x3ef6e0cb,0x3f16999f,0x3f2f61a5,0x3f456439
.long 0x3efc5d27,0x3f19c200,0x3f32c8c9,0x3f48d8b3,0x3f00e7e4,0x3f1ce11f,0x3f36206c,0x3f4c3578
.long 0x3f039c3d,0x3f1ff6cb,0x3f396842,0x3f4f7a1f,0x3f064b82,0x3f2302d3,0x3f3ca003,0x3f52a649
.long 0x3f08f59b,0x3f26050a,0x3f3fc767,0x3f55b993,0x3f0b9a6b,0x3f28fd41,0x3f42de29,0x3f58b3a1
.long 0x3f3504f3,0x3f45e403,0x3f54db31,0x3f61c598,0x3f396842,0x3f4a4c87,0x3f591e6a,0x3f65b710
.long 0x3f3daef9,0x3f4e8d90,0x3f5d2d53,0x3f696591,0x3f41d870,0x3f52a649,0x3f6106f2,0x3f6cd007
.long 0x3f45e403,0x3f5695e5,0x3f64aa59,0x3f6ff573,0x3f49d112,0x3f5a5ba0,0x3f6816a8,0x3f72d4eb
.long 0x3f4d9f02,0x3f5df6be,0x3f6b4b0c,0x3f756d97,0x3f514d3d,0x3f61668a,0x3f6e46be,0x3f77beb7
.long 0x3f54db31,0x3f64aa59,0x3f710908,0x3f79c79d,0x3f584853,0x3f67c187,0x3f73913f,0x3f7b87b2
.long 0x3f5b941a,0x3f6aab7b,0x3f75dec6,0x3f7cfe73,0x3f5ebe05,0x3f6d67a1,0x3f77f110,0x3f7e2b72
.long 0x3f61c598,0x3f6ff573,0x3f79c79d,0x3f7f0e58,0x3f64aa59,0x3f725470,0x3f7b61fc,0x3f7fa6e3
.long 0x3f676bd8,0x3f748422,0x3f7cbfc9,0x3f7ff4e6,0x3f6a09a7,0x3f76841b,0x3f7de0b1,0x3f7ff84a
.long 0x3f6c835e,0x3f74fa0b,0x3f7b14be,0x3f7ec46d,0x3f6ff573,0x3f77beb7,0x3f7cfe73,0x3f7fa6e3
.long 0x3f731447,0x3f7a1e84,0x3f7e70b0,0x3f7ffec4,0x3f75dec6,0x3f7c187a,0x3f7f6ac7,0x3f7fcbe2
.long 0x3f7853f8,0x3f7dabcc,0x3f7fec43,0x3f7f0e58,0x3f7a7302,0x3f7ed7d4,0x3f7ff4e6,0x3f7dc68c
.long 0x3f7c3b28,0x3f7f9c18,0x3f7f84ab,0x3f7bf531,0x3f7dabcc,0x3f7ff84a,0x3f7e9bc9,0x3f799b43
.long 0x3f7ec46d,0x3f7fec43,0x3f7d3aac,0x3f76ba07,0x3f7f84ab,0x3f7f7808,0x3f7b61fc,0x3f73530e
.long 0x3f7fec43,0x3f7e9bc9,0x3f791298,0x3f6f6830,0x3f7ffb11,0x3f7d57de,0x3f764d97,0x3f6afb8c
.long 0x3f7fb10f,0x3f7baccd,0x3f731447,0x3f660f88,0x3f7f0e58,0x3f799b43,0x3f6f6830,0x3f60a6cf
.long 0x3f7e1324,0x3f772417,0x3f6b4b0c,0x3f5ac450,0x3f7cbfc9,0x3f74484b,0x3f66becc,0x3f546b3b
.long 0x248d3132,0xbdc8bd36,0xbe47c5c2,0xbe94a031,0xbd48fb30,0xbe195be0,0xbe7ee6e1,0xbeb0eacb
.long 0xbdc8bd36,0xbe4dee60,0xbe9aa086,0xbecc9b8b,0xbe164083,0xbe80f8c0,0xbeb554ec,0xbee79a5d
.long 0xbe47c5c2,0xbe9aa086,0xbecf7bca,0xbf00e7e4,0xbe78cfcc,0xbeb3dca5,0xbee900b7,0xbf0d9281
.long 0xbe94a031,0xbecc9b8b,0xbf00e7e4,0xbf19c200,0xbeac7cd4,0xbee4cbfe,0xbf0cead0,0xbf256bcb
.long 0xbec3ef15,0xbefc5d27,0xbf187fc0,0xbf3085bb,0xbedae880,0xbf099f4e,0xbf239da9,0xbf3b0629
.long 0xbef15aea,0xbf14b039,0xbf2e3bde,0xbf44e3f5,0xbf039c3d,0xbf1f599f,0xbf385216,0xbf4e1689
.long 0xbf0e39da,0xbf299415,0xbf41d870,0xbf5695e5,0xbf187fc0,0xbf33587a,0xbf4ac77f,0xbf5e5aa6
.long 0xbf226799,0xbf3ca003,0xbf531849,0xbf655e0b,0xbf2beb4a,0xbf456439,0xbf5ac450,0xbf6b99fb
.long 0xbec3ef15,0xbef15aea,0xbf0e39da,0xbf226799,0xbee0924f,0xbf06f686,0xbf1c420c,0xbf2ff3e6
.long 0xbefc5d27,0xbf14b039,0xbf299415,0xbf3ca003,0xbf0b9a6b,0xbf21cbfb,0xbf36206c,0xbf485bca
.long 0xbf187fc0,0xbf2e3bde,0xbf41d870,0xbf531849,0xbf24d225,0xbf39f2ac,0xbf4cae79,0xbf5cc7d1
.long 0xbf3085bb,0xbf44e3f5,0xbf5695e5,0xbf655e0b,0xbf3b8f3b,0xbf4f0417,0xbf5f8327,0xbf6cd007
.long 0xbf45e403,0xbf584853,0xbf676bd8,0xbf731447,0xbf4f7a1f,0xbf60a6cf,0xbf6e46be,0xbf7822d1
.long 0xbf584853,0xbf6816a8,0xbf740bdd,0xbf7bf531,0xbf604621,0xbf6e8ff8,0xbf78b47b,0xbf7e868b
.long 0xbf676bd8,0xbf740bdd,0xbf7c3b28,0xbf7fd397,0xbf6db293,0xbf788486,0xbf7e9bc9,0xbf7fdaaf
.long 0xbf731447,0xbf7bf531,0xbf7fd397,0xbf7e9bc9,0xbf778bc5,0xbf7e5a38,0xbf7fe129,0xbf7c187a
.long 0xbf3504f3,0xbf45e403,0xbf54db31,0xbf61c598,0xbf41d870,0xbf51c0c2,0xbf5f8327,0xbf6afb8c
.long 0xbf4d9f02,0xbf5c61c7,0xbf68bf3c,0xbf7294f8,0xbf584853,0xbf65b710,0xbf708066,0xbf788486
.long 0xbf61c598,0xbf6db293,0xbf76ba07,0xbf7cbfc9,0xbf6a09a7,0xbf74484b,0xbf7b61fc,0xbf7f3f54
.long 0xbf710908,0xbf796e4e,0xbf7e70b0,0xbf7ffec4,0xbf76ba07,0xbf7d1cdd,0xbf7fe129,0xbf7efcc9
.long 0xbf7b14be,0xbf7f4e6d,0xbf7fb10f,0xbf7c3b28,0xbf7e1324,0xbf7fffb1,0xbf7de0b1,0xbf77beb7
.long 0xbf7fb10f,0xbf7f2f9d,0xbf7a7302,0xbf718f57,0xbf7fec43,0xbf7cdf6c,0xbf756d97,0xbf69b7e4
.long 0xbf7ec46d,0xbf791298,0xbf6ed89e,0xbf604621,0xbf7c3b28,0xbf73ced9,0xbf66becc,0xbf554aa4
.long 0xbf7853f8,0xbf6d1c1d,0xbf5d2d53,0xbf48d8b3,0xbf731447,0xbf650479,0xbf5233c6,0xbf3b0629
.long 0xbf6c835e,0xbf74fa0b,0xbf7b14be,0xbf7ec46d,0xbf740bdd,0xbf7a9c59,0xbf7e9bc9,0xbf7fffb1
.long 0xbf79c79d,0xbf7e4323,0xbf7ffb11,0xbf7eea9d,0xbf7dabcc,0xbf7fe705,0xbf7f2f9d,0xbf7b87b2
.long 0xbf7fb10f,0xbf7f84ab,0xbf7c3b28,0xbf75dec6,0xbf7fd397,0xbf7d1cdd,0xbf772417,0xbf6dfcf2
.long 0xbf7e1324,0xbf78b47b,0xbf6ff573,0xbf63f473,0xbf7a7302,0xbf725470,0xbf66becc,0xbf57dc7f
.long 0xbf74fa0b,0xbf6a09a7,0xbf5b941a,0xbf49d112,0xbf6db293,0xbf5fe4e9,0xbf4e8d90,0xbf39f2ac
.long 0xbf64aa59,0xbf53fac3,0xbf3fc767,0xbf286605,0xbf59f26a,0xbf466354,0xbf2f61a5,0xbf1553b7
.long 0xbf4d9f02,0xbf373a23,0xbf1d7fd1,0xbf00e7e4,0xbf3fc767,0xbf269de3,0xbf0a48ad,0xbed6a399
.long 0xbf3085bb,0xbf14b039,0xbeebcbbb,0xbea986c4,0xbf1ff6cb,0xbf019573,0xbec1071e,0xbe75c35a
.long 0x3f800000,0x3f7ec46d,0x3f7b14be,0x3f74fa0b,0x3f7fb10f,0x3f7d1cdd,0x3f77f110,0x3f703b37
.long 0x3f7ec46d,0x3f7ac516,0x3f740bdd,0x3f6aab7b,0x3f7d3aac,0x3f77beb7,0x3f6f6830,0x3f644fac
.long 0x3f7b14be,0x3f740bdd,0x3f6a09a7,0x3f5d2d53,0x3f7853f8,0x3f6faf1b,0x3f63f473,0x3f554aa4
.long 0x3f74fa0b,0x3f6aab7b,0x3f5d2d53,0x3f4cae79,0x3f710908,0x3f650479,0x3f55b993,0x3f436051
.long 0x3f6c835e,0x3f5ebe05,0x3f4d9f02,0x3f396842,0x3f676bd8,0x3f57dc7f,0x3f44e3f5,0x3f2ecef7
.long 0x3f61c598,0x3f5064af,0x3f3b8f3b,0x3f239da9,0x3f5b941a,0x3f485bca,0x3f31a81d,0x3f17de12
.long 0x3f54db31,0x3f3fc767,0x3f273656,0x3f0b9a6b,0x3f4d9f02,0x3f36ad7f,0x3f1c420c,0x3efdbabb
.long 0x3f45e403,0x3f2d1469,0x3f10d3cd,0x3ee363fa,0x3f3daef9,0x3f2302d3,0x3f04f484,0x3ec8477c
.long 0x3f6c835e,0x3f61c598,0x3f54db31,0x3f45e403,0x3f660f88,0x3f5988ad,0x3f4ac77f,0x3f39f2ac
.long 0x3f5ebe05,0x3f5064af,0x3f3fc767,0x3f2d1469,0x3f5695e5,0x3f466354,0x3f33e7bc,0x3f1f599f
.long 0x3f4d9f02,0x3f3b8f3b,0x3f273656,0x3f10d3cd,0x3f43e200,0x3f2ff3e6,0x3f19c200,0x3f019573
.long 0x3f396842,0x3f239da9,0x3f0b9a6b,0x3ee363fa,0x3f2e3bde,0x3f16999f,0x3ef9a02d,0x3ec27b55
.long 0x3f226799,0x3f08f59b,0x3edae880,0x3ea09ae5,0x3f15f6d9,0x3ef58035,0x3ebb31a0,0x3e7bdba4
.long 0x3f08f59b,0x3ed8106b,0x3e9aa086,0x3e354098,0x3ef6e0cb,0x3eb9bb1e,0x3e72b651,0x3ddb7d37
.long 0x3edae880,0x3e9aa086,0x3e2f10a2,0x3d16c32c,0x3ebe1d4a,0x3e75c35a,0x3dd53db9,0xbd0a342f
.long 0x3ea09ae5,0x3e354098,0x3d16c32c,0xbdd53db9,0x3e827dc0,0x3de7fa9a,0xbcfb49ba,0xbe3228d4
.long 0x3f3504f3,0x3f226799,0x3f0e39da,0x3ef15aea,0x3f273656,0x3f12c39a,0x3ef9a02d,0x3ecb2aae
.long 0x3f187fc0,0x3f0242b1,0x3ed53641,0x3ea395c5,0x3f08f59b,0x3ee1fb6a,0x3eaf713a,0x3e75c35a
.long 0x3ef15aea,0x3ebe1d4a,0x3e888e93,0x3e22abb6,0x3ecf7bca,0x3e9920fe,0x3e419b37,0x3d9cecf9
.long 0x3eac7cd4,0x3e667c66,0x3de1bc2e,0xbbc90f88,0x3e888e93,0x3e195be0,0x3cfb49ba,0xbdb5f8da
.long 0x3e47c5c2,0x3d96a905,0xbd48fb30,0xbe2f10a2,0x3dfab273,0xbb490fc6,0xbe039502,0xbe80f8c0
.long 0x3d48fb30,0xbda3308c,0xbe541501,0xbea986c4,0xbcc90ab0,0xbe1f917b,0xbe919ddd,0xbed0eb2a
.long 0xbdc8bd36,0xbe6c9a7f,0xbeb8442a,0xbef6e0cb,0xbe2f10a2,0xbe9c1faf,0xbeddbe79,0xbf0d9281
.long 0xbe78cfcc,0xbec1071e,0xbf00e7e4,0xbf1ebc12,0xbea09ae5,0xbee4cbfe,0xbf121eb0,0xbf2ecef7
.long 0x3ec3ef15,0x3e94a031,0x3e47c5c2,0x3dc8bd36,0x3e9aa086,0x3e5101f1,0x3dd53db9,0x3b490fc6
.long 0x3e605c13,0x3dee3876,0x3c490e90,0xbdbc3ac3,0x3e09cf86,0x3ce22a7a,0xbda3308c,0xbe3e853e
.long 0x3d48fb30,0xbd7b2b74,0xbe2f10a2,0xbe8e9a22,0xbd16c32c,0xbe195be0,0xbe8586ce,0xbebca7af
.long 0xbdfab273,0xbe72b651,0xbeb263ef,0xbee900b7,0xbe541501,0xbea5129f,0xbeddbe79,0xbf099f4e
.long 0xbe94a031,0xbecf7bca,0xbf039c3d,0xbf1d7fd1,0xbebe1d4a,0xbef840c8,0xbf173c07,0xbf2ff3e6
.long 0xbee63375,0xbf0f8784,0xbf299415,0xbf40d0da,0xbf064b82,0xbf21cbfb,0xbf3a7ca4,0xbf4fefa8
.long 0xbf187fc0,0xbf32c8c9,0xbf49d112,0xbf5d2d53,0xbf299415,0xbf425b89,0xbf577026,0xbf686b39
.long 0xbf396842,0xbf5064af,0xbf633c5a,0xbf718f57,0xbf47de65,0xbf5cc7d1,0xbf6d1c1d,0xbf788486
.long 0x3f800000,0x3f7d3aac,0x3f74fa0b,0x3f676bd8,0x3f800000,0x3f7d1cdd,0x3f748422,0x3f666771
.long 0x3f800000,0x3f7cfe73,0x3f740bdd,0x3f655e0b,0x3f800000,0x3f7cdf6c,0x3f73913f,0x3f644fac
.long 0x3f800000,0x3f7cbfc9,0x3f731447,0x3f633c5a,0x3f800000,0x3f7c9f8a,0x3f7294f8,0x3f62241a
.long 0x3f800000,0x3f7c7eb0,0x3f721352,0x3f6106f2,0x3f800000,0x3f7c5d3a,0x3f718f57,0x3f5fe4e9
.long 0x3f800000,0x3f7c3b28,0x3f710908,0x3f5ebe05,0x3f800000,0x3f7c187a,0x3f708066,0x3f5d924d
.long 0x3f800000,0x3f7bf531,0x3f6ff573,0x3f5c61c7,0x3f800000,0x3f7bd14d,0x3f6f6830,0x3f5b2c79
.long 0x3f800000,0x3f7baccd,0x3f6ed89e,0x3f59f26a,0x3f800000,0x3f7b87b2,0x3f6e46be,0x3f58b3a1
.long 0x3f800000,0x3f7b61fc,0x3f6db293,0x3f577026,0x3f800000,0x3f7b3bab,0x3f6d1c1d,0x3f5627fe
.long 0x3f54db31,0x3f3daef9,0x3f226799,0x3f039c3d,0x3f531849,0x3f3b0629,0x3f1ebc12,0x3efdbabb
.long 0x3f514d3d,0x3f385216,0x3f1b02c6,0x3ef41f07,0x3f4f7a1f,0x3f3592e7,0x3f173c07,0x3eea6681
.long 0x3f4d9f02,0x3f32c8c9,0x3f13682a,0x3ee0924f,0x3f4bbbf8,0x3f2ff3e6,0x3f0f8784,0x3ed6a399
.long 0x3f49d112,0x3f2d1469,0x3f0b9a6b,0x3ecc9b8b,0x3f47de65,0x3f2a2a80,0x3f07a136,0x3ec27b55
.long 0x3f45e403,0x3f273656,0x3f039c3d,0x3eb8442a,0x3f43e200,0x3f24381a,0x3eff17b2,0x3eadf73c
.long 0x3f41d870,0x3f212ff9,0x3ef6e0cb,0x3ea395c5,0x3f3fc767,0x3f1e1e22,0x3eee9479,0x3e9920fe
.long 0x3f3daef9,0x3f1b02c6,0x3ee63375,0x3e8e9a22,0x3f3b8f3b,0x3f17de12,0x3eddbe79,0x3e840270
.long 0x3f396842,0x3f14b039,0x3ed53641,0x3e72b651,0x3f373a23,0x3f11796b,0x3ecc9b8b,0x3e5d4b1a
.long 0x3ec3ef15,0x3e78cfcc,0x3dc8bd36,0xbd48fb30,0x3eb8442a,0x3e5d4b1a,0x3d8a200a,0xbda973ba
.long 0x3eac7cd4,0x3e419b37,0x3d16c32c,0xbdee3876,0x3ea09ae5,0x3e25c58c,0x3bc90f88,0xbe195be0
.long 0x3e94a031,0x3e09cf86,0xbcc90ab0,0xbe3b6ecf,0x3e888e93,0x3ddb7d37,0xbd621469,0xbe5d4b1a
.long 0x3e78cfcc,0x3da3308c,0xbdafb680,0xbe7ee6e1,0x3e605c13,0x3d55880e,0xbdee3876,0xbe901c2c
.long 0x3e47c5c2,0x3cc90ab0,0xbe164083,0xbea09ae5,0x3e2f10a2,0xbb490fc6,0xbe354098,0xbeb0eacb
.long 0x3e164083,0xbcfb49ba,0xbe541501,0xbec1071e,0x3dfab273,0xbd6ea038,0xbe72b651,0xbed0eb2a
.long 0x3dc8bd36,0xbdafb680,0xbe888e93,0xbee0924f,0x3d96a905,0xbde7fa9a,0xbe97a117,0xbeeff7fb
.long 0x3d48fb30,0xbe1008b7,0xbea68f12,0xbeff17b2,0x3cc90ab0,0xbe2bf804,0xbeb554ec,0xbf06f686
.long 0xbe47c5c2,0xbeac7cd4,0xbef15aea,0xbf187fc0,0xbe6c9a7f,0xbebf926f,0xbf0242b1,0xbf21cbfb
.long 0xbe888e93,0xbed25a09,0xbf0b9a6b,0xbf2ac082,0xbe9aa086,0xbee4cbfe,0xbf14b039,0xbf33587a
.long 0xbeac7cd4,0xbef6e0cb,0xbf1d7fd1,0xbf3b8f3b,0xbebe1d4a,0xbf044889,0xbf26050a,0xbf436051
.long 0xbecf7bca,0xbf0cead0,0xbf2e3bde,0xbf4ac77f,0xbee0924f,0xbf1553b7,0xbf36206c,0xbf51c0c2
.long 0xbef15aea,0xbf1d7fd1,0xbf3daef9,0xbf584853,0xbf00e7e4,0xbf256bcb,0xbf44e3f5,0xbf5e5aa6
.long 0xbf08f59b,0xbf2d1469,0xbf4bbbf8,0xbf63f473,0xbf10d3cd,0xbf34768f,0xbf5233c6,0xbf6912ae
.long 0xbf187fc0,0xbf3b8f3b,0xbf584853,0xbf6db293,0xbf1ff6cb,0xbf425b89,0xbf5df6be,0xbf71d19f
.long 0xbf273656,0xbf48d8b3,0xbf633c5a,0xbf756d97,0xbf2e3bde,0xbf4f0417,0xbf6816a8,0xbf788486
.long 0x0,0x3e164083,0x3e94a031,0x3edae880,0x0,0x3e195be0,0x3e97a117,0x3edf28a9
.long 0x0,0x3e1c76de,0x3e9aa086,0x3ee363fa,0x0,0x3e1f917b,0x3e9d9e78,0x3ee79a5d
.long 0x0,0x3e22abb6,0x3ea09ae5,0x3eebcbbb,0x0,0x3e25c58c,0x3ea395c5,0x3eeff7fb
.long 0x0,0x3e28defc,0x3ea68f12,0x3ef41f07,0x0,0x3e2bf804,0x3ea986c4,0x3ef840c8
.long 0x0,0x3e2f10a2,0x3eac7cd4,0x3efc5d27,0x0,0x3e3228d4,0x3eaf713a,0x3f003a06
.long 0x0,0x3e354098,0x3eb263ef,0x3f0242b1,0x0,0x3e3857ec,0x3eb554ec,0x3f044889
.long 0x0,0x3e3b6ecf,0x3eb8442a,0x3f064b82,0x0,0x3e3e853e,0x3ebb31a0,0x3f084b92
.long 0x0,0x3e419b37,0x3ebe1d4a,0x3f0a48ad,0x0,0x3e44b0b9,0x3ec1071e,0x3f0c42c9
.long 0x3f0e39da,0x3f2beb4a,0x3f45e403,0x3f5b941a,0x3f10d3cd,0x3f2ecef7,0x3f48d8b3,0x3f5e5aa6
.long 0x3f13682a,0x3f31a81d,0x3f4bbbf8,0x3f6106f2,0x3f15f6d9,0x3f34768f,0x3f4e8d90,0x3f6398ac
.long 0x3f187fc0,0x3f373a23,0x3f514d3d,0x3f660f88,0x3f1b02c6,0x3f39f2ac,0x3f53fac3,0x3f686b39
.long 0x3f1d7fd1,0x3f3ca003,0x3f5695e5,0x3f6aab7b,0x3f1ff6cb,0x3f3f41fc,0x3f591e6a,0x3f6cd007
.long 0x3f226799,0x3f41d870,0x3f5b941a,0x3f6ed89e,0x3f24d225,0x3f446337,0x3f5df6be,0x3f70c501
.long 0x3f273656,0x3f46e22a,0x3f604621,0x3f7294f8,0x3f299415,0x3f495521,0x3f628210,0x3f74484b
.long 0x3f2beb4a,0x3f4bbbf8,0x3f64aa59,0x3f75dec6,0x3f2e3bde,0x3f4e1689,0x3f66becc,0x3f77583a
.long 0x3f3085bb,0x3f5064af,0x3f68bf3c,0x3f78b47b,0x3f32c8c9,0x3f52a649,0x3f6aab7b,0x3f79f35e
.long 0x3f6c835e,0x3f7853f8,0x3f7ec46d,0x3f7fb10f,0x3f6ed89e,0x3f79f35e,0x3f7f6ac7,0x3f7f1f49
.long 0x3f710908,0x3f7b61fc,0x3f7fd397,0x3f7e4323,0x3f731447,0x3f7c9f8a,0x3f7ffec4,0x3f7d1cdd
.long 0x3f74fa0b,0x3f7dabcc,0x3f7fec43,0x3f7baccd,0x3f76ba07,0x3f7e868b,0x3f7f9c18,0x3f79f35e
.long 0x3f7853f8,0x3f7f2f9d,0x3f7f0e58,0x3f77f110,0x3f79c79d,0x3f7fa6e3,0x3f7e4323,0x3f75a67b
.long 0x3f7b14be,0x3f7fec43,0x3f7d3aac,0x3f731447,0x3f7c3b28,0x3f7fffb1,0x3f7bf531,0x3f703b37
.long 0x3f7d3aac,0x3f7fe129,0x3f7a7302,0x3f6d1c1d,0x3f7e1324,0x3f7f90b1,0x3f78b47b,0x3f69b7e4
.long 0x3f7ec46d,0x3f7f0e58,0x3f76ba07,0x3f660f88,0x3f7f4e6d,0x3f7e5a38,0x3f748422,0x3f62241a
.long 0x3f7fb10f,0x3f7d7474,0x3f721352,0x3f5df6be,0x3f7fec43,0x3f7c5d3a,0x3f6f6830,0x3f5988ad
.long 0x3f7b14be,0x3f710908,0x3f61c598,0x3f4d9f02,0x3f791298,0x3f6d67a1,0x3f5c61c7,0x3f466354
.long 0x3f76ba07,0x3f696591,0x3f5695e5,0x3f3ebc1b,0x3f740bdd,0x3f650479,0x3f5064af,0x3f36ad7f
.long 0x3f710908,0x3f604621,0x3f49d112,0x3f2e3bde,0x3f6db293,0x3f5b2c79,0x3f42de29,0x3f256bcb
.long 0x3f6a09a7,0x3f55b993,0x3f3b8f3b,0x3f1c420c,0x3f660f88,0x3f4fefa8,0x3f33e7bc,0x3f12c39a
.long 0x3f61c598,0x3f49d112,0x3f2beb4a,0x3f08f59b,0x3f5d2d53,0x3f436051,0x3f239da9,0x3efdbabb
.long 0x3f584853,0x3f3ca003,0x3f1b02c6,0x3ee900b7,0x3f531849,0x3f3592e7,0x3f121eb0,0x3ed3c867
.long 0x3f4d9f02,0x3f2e3bde,0x3f08f59b,0x3ebe1d4a,0x3f47de65,0x3f269de3,0x3eff17b2,0x3ea80b1f
.long 0x3f41d870,0x3f1ebc12,0x3eebcbbb,0x3e919ddd,0x3f3b8f3b,0x3f16999f,0x3ed8106b,0x3e75c35a
.long 0xbf3504f3,0xbf4d9f02,0xbf61c598,0xbf710908,0xbf3daef9,0xbf554aa4,0xbf6816a8,0xbf75a67b
.long 0xbf45e403,0xbf5c61c7,0xbf6db293,0xbf796e4e,0xbf4d9f02,0xbf62df7b,0xbf7294f8,0xbf7c5d3a
.long 0xbf54db31,0xbf68bf3c,0xbf76ba07,0xbf7e70b0,0xbf5b941a,0xbf6dfcf2,0xbf7a1e84,0xbf7fa6e3
.long 0xbf61c598,0xbf7294f8,0xbf7cbfc9,0xbf7ffec4,0xbf676bd8,0xbf76841b,0xbf7e9bc9,0xbf7f7808
.long 0xbf6c835e,0xbf79c79d,0xbf7fb10f,0xbf7e1324,0xbf710908,0xbf7c5d3a,0xbf7ffec4,0xbf7bd14d
.long 0xbf74fa0b,0xbf7e4323,0xbf7f84ab,0xbf78b47b,0xbf7853f8,0xbf7f7808,0xbf7e4323,0xbf74bf62
.long 0xbf7b14be,0xbf7ffb11,0xbf7c3b28,0xbf6ff573,0xbf7d3aac,0xbf7fcbe2,0xbf796e4e,0xbf6a5ad9
.long 0xbf7ec46d,0xbf7eea9d,0xbf75dec6,0xbf63f473,0xbf7fb10f,0xbf7d57de,0xbf718f57,0xbf5cc7d1
.long 0xbf7b14be,0xbf7fb10f,0xbf7ec46d,0xbf7853f8,0xbf7dabcc,0xbf7ff84a,0xbf7c7eb0,0xbf73530e
.long 0xbf7f4e6d,0xbf7f2f9d,0xbf791298,0xbf6d1c1d,0xbf7ffb11,0xbf7d57de,0xbf748422,0xbf65b710
.long 0xbf7fb10f,0xbf7a7302,0xbf6ed89e,0xbf5d2d53,0xbf7e70b0,0xbf76841b,0xbf6816a8,0xbf5389c7
.long 0xbf7c3b28,0xbf718f57,0xbf604621,0xbf48d8b3,0xbf791298,0xbf6b99fb,0xbf577026,0xbf3d27b8
.long 0xbf74fa0b,0xbf64aa59,0xbf4d9f02,0xbf3085bb,0xbf6ff573,0xbf5cc7d1,0xbf42de29,0xbf2302d3
.long 0xbf6a09a7,0xbf53fac3,0xbf373a23,0xbf14b039,0xbf633c5a,0xbf4a4c87,0xbf2ac082,0xbf05a02c
.long 0xbf5b941a,0xbf3fc767,0xbf1d7fd1,0xbeebcbbb,0xbf531849,0xbf34768f,0xbf0f8784,0xbecb2aae
.long 0xbf49d112,0xbf286605,0xbf00e7e4,0xbea986c4,0xbf3fc767,0xbf1ba299,0xbee363fa,0xbe870ada
.long 0xbf6c835e,0xbf5b941a,0xbf45e403,0xbf2beb4a,0xbf64aa59,0xbf50d937,0xbf385216,0xbf1ba299
.long 0xbf5b941a,0xbf44e3f5,0xbf299415,0xbf0a48ad,0xbf514d3d,0xbf37c655,0xbf19c200,0xbeeff7fb
.long 0xbf45e403,0xbf299415,0xbf08f59b,0xbec9b953,0xbf396842,0xbf1a6293,0xbeee9479,0xbea21887
.long 0xbf2beb4a,0xbf0a48ad,0xbec9b953,0xbe72b651,0xbf1d7fd1,0xbef2bd43,0xbea395c5,0xbe1f917b
.long 0xbf0e39da,0xbecf7bca,0xbe78cfcc,0xbd96a905,0xbefc5d27,0xbeab0201,0xbe28defc,0x3c16cb58
.long 0xbedae880,0xbe8586ce,0xbdafb680,0x3dbc3ac3,0xbeb8442a,0xbe3e853e,0xbbc90f88,0x3e3228d4
.long 0xbe94a031,0xbde1bc2e,0x3d96a905,0x3e827dc0,0xbe605c13,0xbd0a342f,0x3e1c76de,0x3eab0201
.long 0xbe164083,0x3d2fe007,0x3e6c9a7f,0x3ed25a09,0xbd96a905,0x3df475c0,0x3e9d9e78,0x3ef840c8
.long 0xbf0e39da,0xbedae880,0xbe94a031,0xbe164083,0xbef6e0cb,0xbeb0eacb,0xbe4dee60,0xbd55880e
.long 0xbecf7bca,0xbe8586ce,0xbde1bc2e,0x3d2fe007,0xbea68f12,0xbe3228d4,0xbc96c9b6,0x3e0cec4a
.long 0xbe78cfcc,0xbdafb680,0x3d96a905,0x3e6c9a7f,0xbe22abb6,0x3b490fc6,0x3e28defc,0x3ea5129f
.long 0xbd96a905,0x3dbc3ac3,0x3e827dc0,0x3ed25a09,0x3c490e90,0x3e3857ec,0x3eaf713a,0x3efdbabb
.long 0x3dc8bd36,0x3e888e93,0x3edae880,0x3f13682a,0x3e3b6ecf,0x3eb3dca5,0x3f0242b1,0x3f269de3
.long 0x3e888e93,0x3eddbe79,0x3f15f6d9,0x3f385216,0x3eb263ef,0x3f02ef9f,0x3f286605,0x3f485bca
.long 0x3edae880,0x3f15f6d9,0x3f396842,0x3f5695e5,0x3f00e7e4,0x3f27ce61,0x3f48d8b3,0x3f62df7b
.long 0x3f13682a,0x3f385216,0x3f5695e5,0x3f6d1c1d,0x3f24d225,0x3f476085,0x3f628210,0x3f75341d
.long 0x3f3504f3,0x3f187fc0,0x3ef15aea,0x3eac7cd4,0x3f2beb4a,0x3f0d9281,0x3ed8106b,0x3e901c2c
.long 0x3f226799,0x3f0242b1,0x3ebe1d4a,0x3e667c66,0x3f187fc0,0x3eed3063,0x3ea395c5,0x3e2bf804
.long 0x3f0e39da,0x3ed53641,0x3e888e93,0x3de1bc2e,0x3f039c3d,0x3ebca7af,0x3e5a3997,0x3d55880e
.long 0x3ef15aea,0x3ea395c5,0x3e22abb6,0xbbc90f88,0x3edae880,0x3e8a11f7,0x3dd53db9,0xbd83db0a
.long 0x3ec3ef15,0x3e605c13,0x3d48fb30,0xbdfab273,0x3eac7cd4,0x3e2bf804,0xbbc90f88,0xbe3857ec
.long 0x3e94a031,0x3dee3876,0xbd7b2b74,0xbe72b651,0x3e78cfcc,0x3d83db0a,0xbdee3876,0xbe9620d2
.long 0x3e47c5c2,0x3c490e90,0xbe2f10a2,0xbeb263ef,0x3e164083,0xbd2351cb,0xbe667c66,0xbece0bea
.long 0x3dc8bd36,0xbdbc3ac3,0xbe8e9a22,0xbee900b7,0x3d48fb30,0xbe1324ca,0xbea986c4,0xbf019573
.long 0x3e47c5c2,0x3d48fb30,0xbdc8bd36,0xbe78cfcc,0x3e09cf86,0xbc7b514b,0xbe28defc,0xbe9f1cdf
.long 0x3d96a905,0xbda3308c,0xbe6c9a7f,0xbec1071e,0x3c490e90,0xbe1324ca,0xbe97a117,0xbee1fb6a
.long 0xbd48fb30,0xbe541501,0xbeb8442a,0xbf00e7e4,0xbde1bc2e,0xbe8a11f7,0xbed8106b,0xbf102dd5
.long 0xbe2f10a2,0xbea986c4,0xbef6e0cb,0xbf1ebc12,0xbe6c9a7f,0xbec8477c,0xbf0a48ad,0xbf2c800f
.long 0xbe94a031,0xbee63375,0xbf187fc0,0xbf396842,0xbeb263ef,0xbf019573,0xbf26050a,0xbf456439
.long 0xbecf7bca,0xbf0f8784,0xbf32c8c9,0xbf5064af,0xbeebcbbb,0xbf1ce11f,0xbf3ebc1b,0xbf5a5ba0
.long 0xbf039c3d,0xbf299415,0xbf49d112,0xbf633c5a,0xbf10d3cd,0xbf3592e7,0xbf53fac3,0xbf6afb8c
.long 0xbf1d7fd1,0xbf40d0da,0xbf5d2d53,0xbf718f57,0xbf299415,0xbf4b41fa,0xbf655e0b,0xbf76ef5b
.long 0xbec3ef15,0xbf039c3d,0xbf226799,0xbf3daef9,0xbee63375,0xbf140c5f,0xbf31a81d,0xbf4b41fa
.long 0xbf039c3d,0xbf239da9,0xbf3fc767,0xbf577026,0xbf13682a,0xbf3238aa,0xbf4cae79,0xbf62241a
.long 0xbf226799,0xbf3fc767,0xbf584853,0xbf6b4b0c,0xbf3085bb,0xbf4c3578,0xbf628210,0xbf72d4eb
.long 0xbf3daef9,0xbf577026,0xbf6b4b0c,0xbf78b47b,0xbf49d112,0xbf61668a,0xbf7294f8,0xbf7cdf6c
.long 0xbf54db31,0xbf6a09a7,0xbf7853f8,0xbf7f4e6d,0xbf5ebe05,0xbf714c7a,0xbf7c7eb0,0xbf7ffd39
.long 0xbf676bd8,0xbf772417,0xbf7f0e58,0xbf7eea9d,0xbf6ed89e,0xbf7b87b2,0xbf7ffec4,0xbf7c187a
.long 0xbf74fa0b,0xbf7e70b0,0xbf7f4e6d,0xbf778bc5,0xbf79c79d,0xbf7fdaaf,0xbf7cfe73,0xbf714c7a
.long 0xbf7d3aac,0xbf7fc38f,0xbf791298,0xbf696591,0xbf7f4e6d,0xbf7e2b72,0xbf73913f,0xbf5fe4e9
.long 0xbf54db31,0xbf676bd8,0xbf74fa0b,0xbf7d3aac,0xbf604621,0xbf703b37,0xbf7ac516,0xbf7fa6e3
.long 0xbf6a09a7,0xbf772417,0xbf7e70b0,0xbf7fc38f,0xbf721352,0xbf7c187a,0xbf7ff4e6,0xbf7d906e
.long 0xbf7853f8,0xbf7f0e58,0xbf7f4e6d,0xbf791298,0xbf7cbfc9,0xbf7fffb1,0xbf7c7eb0,0xbf725470
.long 0xbf7f4e6d,0xbf7eea9d,0xbf778bc5,0xbf696591,0xbf7ffb11,0xbf7bd14d,0xbf708066,0xbf5e5aa6
.long 0xbf7ec46d,0xbf76ba07,0xbf676bd8,0xbf514d3d,0xbf7baccd,0xbf6faf1b,0xbf5c61c7,0xbf425b89
.long 0xbf76ba07,0xbf66becc,0xbf4f7a1f,0xbf31a81d,0xbf6ff573,0xbf5bfb34,0xbf40d0da,0xbf1f599f
.long 0xbf676bd8,0xbf4f7a1f,0xbf3085bb,0xbf0b9a6b,0xbf5d2d53,0xbf4154e1,0xbf1ebc12,0xbeed3063
.long 0xbf514d3d,0xbf31a81d,0xbf0b9a6b,0xbec1071e,0xbf43e200,0xbf209393,0xbeee9479,0xbe931f35
tab_end:
.p2align 6
.amdhsa_kernel k1_kernel
  .amdhsa_next_free_vgpr 168
  .amdhsa_next_free_sgpr 96
  .amdhsa_accum_offset 168
  .amdhsa_group_segment_fixed_size 0
  .amdhsa_kernarg_size 80
  .amdhsa_user_sgpr_count 2
  .amdhsa_user_sgpr_kernarg_segment_ptr 1
  .amdhsa_system_sgpr_workgroup_id_x 1
.end_amdhsa_kernel
.p2align 6
.amdhsa_kernel k2_kernel
  .amdhsa_next_free_vgpr 216
  .amdhsa_next_free_sgpr 96
  .amdhsa_accum_offset 216
  .amdhsa_group_segment_fixed_size 0
  .amdhsa_kernarg_size 80
  .amdhsa_user_sgpr_count 2
  .amdhsa_user_sgpr_kernarg_segment_ptr 1
  .amdhsa_system_sgpr_workgroup_id_x 1
.end_amdhsa_kernel
.p2align 6
.amdhsa_kernel k3_kernel
  .amdhsa_next_free_vgpr 120
  .amdhsa_next_free_sgpr 96
  .amdhsa_accum_offset 120
  .amdhsa_group_segment_fixed_size 0
  .amdhsa_kernarg_size 80
  .amdhsa_user_sgpr_count 2
  .amdhsa_user_sgpr_kernarg_segment_ptr 1
  .amdhsa_system_sgpr_workgroup_id_x 1
.end_amdhsa_kernel
```
